```python
import torch

def _softmax(x, axis=-1):
    return torch.softmax(x, dim=axis)
def _gelu(x):
    return torch.nn.functional.gelu(x, approximate="tanh")
def _silu(x):
    return torch.nn.functional.silu(x)
def _sigmoid(x):
    return torch.sigmoid(x)
def _layernorm(x, axis=-1, eps=1e-5):
    m = x.mean(dim=axis, keepdim=True)
    v = x.var(dim=axis, keepdim=True, unbiased=False)
    return (x - m) / torch.sqrt(v + eps)
def _scatter_add(tgt, idx, src, axis=0):
    return tgt.clone().index_add_(axis, idx, src)
def _segment_sum(src, seg, n):
    out = torch.zeros((n,) + src.shape[1:], dtype=src.dtype)
    return out.index_add_(0, seg, src)
def _pad(x, pw):
    flat = tuple(v for pair in reversed(pw) for v in pair)
    return torch.nn.functional.pad(x, flat)

kernel_name = 'sequential_preLN__sliding_block__glu_gated_bilinear__prompt'

def setup_inputs():

    _w = (lambda a: (lambda t: t.to(torch.bfloat16) if t.is_floating_point() else t)(torch.as_tensor(a)))
    def _A_setup():
        B, S, D = 1, 2048, 512
        return {
            "x": _w((lambda *s: torch.randn(*s, dtype=torch.bfloat16) * 0.05)(B, S, D)),
            "wqkv": _w((lambda *s: torch.randn(*s, dtype=torch.bfloat16) * 0.05)(D, 3 * D)),
            "wo": _w((lambda *s: torch.randn(*s, dtype=torch.bfloat16) * 0.05)(D, D)),
        }
    _A_in = _A_setup()

    def _B_setup():
        B, S, D, F = 1, 2048, 512, 1792
        return {
            "x": _w((lambda *s: torch.randn(*s, dtype=torch.bfloat16) * 0.05)(B, S, D)),
            "w_gate": _w((lambda *s: torch.randn(*s, dtype=torch.bfloat16) * 0.8)(D, F) * (D ** -0.5)),
            "w_up": _w((lambda *s: torch.randn(*s, dtype=torch.bfloat16) * 0.8)(D, F) * (D ** -0.5)),
            "w_down": _w((lambda *s: torch.randn(*s, dtype=torch.bfloat16) * 0.8)(F, D) * (F ** -0.5)),
        }
    _B_in = _B_setup()

    return {
        "A_x": _A_in["x"],
        "A_wqkv": _A_in["wqkv"],
        "A_wo": _A_in["wo"],
        "B_x": _B_in["x"],
        "B_w_gate": _B_in["w_gate"],
        "B_w_up": _B_in["w_up"],
        "B_w_down": _B_in["w_down"],
    }

def reference(A_x, A_wqkv, A_wo, B_x, B_w_gate, B_w_up, B_w_down):
    def _A_ref(x, wqkv, wo):
        B, S, D = x.shape
        H = 32; Dh = D // H; W = 256
        qkv = (lambda x, *d: x.permute(*d))((x @ wqkv).reshape(B, S, 3, H, Dh), 2, 0, 3, 1, 4)
        q, k, v = qkv[0], qkv[1], qkv[2]
        scores = torch.einsum("bhqd,bhkd->bhqk", q, k) * (Dh ** -0.5)
        idx = torch.arange(S)
        mask = (idx[:, None] - idx[None, :] >= 0) & (idx[:, None] - idx[None, :] < W)
        scores = torch.where(mask[None, None], scores, -1e9)
        p = _softmax(scores, axis=-1)
        o = torch.einsum("bhqk,bhkd->bhqd", p, v)
        return (lambda x, *d: x.permute(*d))(o, 0, 2, 1, 3).reshape(B, S, D) @ wo

    def _B_ref(x, w_gate, w_up, w_down):
        g = torch.einsum("bsd,df->bsf", x, w_gate)
        u = torch.einsum("bsd,df->bsf", x, w_up)
        h = g * u
        return torch.einsum("bsf,fd->bsd", h, w_down)

    x = A_x
    h = x + _A_ref(_layernorm(x, axis=-1), A_wqkv, A_wo)
    h2 = h + _B_ref(_layernorm(h, axis=-1), B_w_gate, B_w_up, B_w_down)
    return h2
```

```asm
; @launch grid=(256,1,1) block=(256,1,1) lds=163840
.amdgcn_target "amdgcn-amd-amdhsa--gfx950"
.text
.globl sequential_preLN__sliding_block__glu_gated_bilinear__prompt_kernel
.p2align 8
.type sequential_preLN__sliding_block__glu_gated_bilinear__prompt_kernel,@function
sequential_preLN__sliding_block__glu_gated_bilinear__prompt_kernel:
    s_cmp_ge_u32 s2, 256
    s_cbranch_scc1 L_end
    s_load_dwordx2 s[8:9], s[0:1], 0
    s_load_dwordx16 s[80:95], s[0:1], 0
    s_load_dwordx2 s[36:37], s[0:1], 72
    s_getpc_b64 s[96:97]
    v_lshrrev_b32 v4, 6, v0
    v_and_b32 v0, 63, v0
    v_readfirstlane_b32 s43, v4
    s_lshr_b32 s45, s2, 3
    s_lshl2_add_u32 s54, s45, s43
    s_mul_i32 s54, s54, 384
    v_min_u32 v48, 2, v0
    v_lshl_add_u32 v48, v48, 7, s54
    v_min_u32 v48, L_hot_end-sequential_preLN__sliding_block__glu_gated_bilinear__prompt_kernel, v48
    global_load_dword v255, v48, s[96:97]
    s_and_b32 s40, s2, 7
    s_lshr_b32 s41, s45, 3
    s_and_b32 s66, s45, 7
    s_lshl2_add_u32 s44, s40, s41
    s_lshl_b32 s53, s43, 12
    s_lshl2_add_u32 s65, s44, s43
    s_lshl_b32 s65, s65, 14
    s_mov_b32 s10, 0x200000
    s_mov_b32 s11, 0x20000
    v_lshrrev_b32 v16, 3, v0
    v_and_b32 v17, 7, v0
    v_lshrrev_b32 v18, 4, v0
    v_xor_b32 v4, v17, v18
    v_lshlrev_b32 v4, 4, v4
    v_lshl_add_u32 v4, v16, 10, v4
    v_xor_b32 v5, 64, v4
    v_add_u32 v5, 7168, v5
    s_add_u32 m0, s53, 0
    s_lshl_b32 s59, s66, 7
    s_add_u32 s59, s59, s65
    s_waitcnt lgkmcnt(0)
    buffer_load_dwordx4 v4, s[8:11], s59 offen nt lds
    buffer_load_dwordx4 v5, s[8:11], s59 offen offset:1024 nt lds
    s_add_u32 m0, s53, 2048
    s_mul_i32 s59, s66, 196608
    v_and_b32 v18, 1, v18
    v_lshlrev_b32 v18, 2, v18
    v_xor_b32 v6, v17, v18
    v_lshlrev_b32 v6, 4, v6
    v_mul_u32_u24 v16, 3072, v16
    v_add_u32 v6, v6, v16
    v_xor_b32 v7, 32, v6
    v_add_u32 v7, 23552, v7
    s_mul_i32 s64, s43, 49152
    s_lshl_b32 s54, s66, 7
    s_add_u32 s64, s64, s54
    s_add_u32 s64, s64, 1024
    s_mov_b32 s42, s66
    s_mov_b64 s[12:13], s[82:83]
    s_mov_b32 s14, 0x180000
    s_mov_b32 s15, 0x20000
    s_add_u32 s59, s59, s64
    buffer_load_dwordx4 v6, s[12:15], s59 offen lds
    buffer_load_dwordx4 v7, s[12:15], s59 offen offset:1024 lds
    s_add_u32 s66, s66, 1
    s_and_b32 s66, s66, 7
    s_lshl2_add_u32 s7, s2, s43
    s_lshr_b32 s55, s7, 1
    s_mul_i32 s55, s55, 3072
    s_and_b32 s56, s7, 1
    s_lshl_b32 s56, s56, 9
    s_add_u32 s55, s55, s56
    v_and_b32 v49, 3, v0
    v_lshlrev_b32 v49, 7, v49
    buffer_load_dword v254, v49, s[12:15], s55 offen offset:1024
    v_bfe_u32 v50, v0, 2, 1
    v_lshl_add_u32 v50, v50, 11, v49
    v_add_u32 v50, s55, v50
    v_lshl_add_u32 v49, s7, 9, v49
    s_lshl_b32 s57, s40, 7
    s_add_u32 s57, s57, 15798272
    s_sub_u32 s58, s57, 128
    s_max_u32 s58, s58, 15798272
    s_load_dwordx2 s[46:47], s[36:37], s57
    s_load_dwordx2 s[48:49], s[36:37], s58
    s_mov_b64 s[16:17], s[84:85]
    s_mov_b64 s[20:21], s[88:89]
    s_mov_b64 s[24:25], s[90:91]
    s_mov_b64 s[28:29], s[92:93]
    s_mov_b64 s[32:33], s[94:95]
    s_mov_b32 s18, 524288
    s_mov_b32 s19, 0x20000
    s_mov_b32 s22, 1835008
    s_mov_b32 s23, 0x20000
    s_mov_b32 s26, 1835008
    s_mov_b32 s27, 0x20000
    s_mov_b32 s30, 1835008
    s_mov_b32 s31, 0x20000
    s_mov_b32 s34, 2097152
    s_mov_b32 s35, 0x20000
    s_mov_b32 s38, 16777216
    s_mov_b32 s39, 0x20000
    s_lshl2_add_u32 s54, s45, s43
    s_mul_i32 s55, s54, 12288
    s_lshl_b32 s54, s54, 12
    v_min_u32 v51, 11, v0
    v_lshl_add_u32 v51, v51, 10, s55
    v_min_u32 v52, 3, v0
    v_lshl_add_u32 v52, v52, 10, s54
    buffer_load_dword v253, v50, s[12:15], 0 offen
    buffer_load_dword v252, v49, s[16:19], 0 offen
    buffer_load_dword v251, v51, s[12:15], 0 offen offset:384
    buffer_load_dword v250, v52, s[16:19], 0 offen offset:384
    v_lshlrev_b32 v1, 4, v0
    v_mov_b32 v2, 0
    v_add_u32 v8, 47104, v6
    v_add_u32 v9, 47104, v7
    s_add_u32 m0, s53, 16384
    s_lshl_b32 s59, s66, 7
    s_add_u32 s59, s59, s65
    buffer_load_dwordx4 v4, s[8:11], s59 offen nt lds
    buffer_load_dwordx4 v5, s[8:11], s59 offen offset:1024 nt lds
    s_add_u32 m0, s53, 18432
    s_mul_i32 s59, s66, 196608
    s_add_u32 s59, s59, s64
    buffer_load_dwordx4 v6, s[12:15], s59 offen lds
    buffer_load_dwordx4 v7, s[12:15], s59 offen offset:1024 lds
    s_add_u32 s66, s66, 1
    s_and_b32 s66, s66, 7
    s_and_b32 s54, s43, 1
    s_lshr_b32 s55, s43, 1
    s_lshl_b32 s56, s54, 1
    s_or_b32 s56, s56, s55
    s_lshl_b32 s54, s54, 13
    v_bfe_u32 v20, v0, 4, 1
    v_lshl_add_u32 v20, v20, 12, s54
    v_and_b32 v23, 15, v0
    v_lshl_add_u32 v20, v23, 7, v20
    v_bfe_u32 v21, v0, 1, 3
    v_lshrrev_b32 v22, 5, v0
    v_xor_b32 v18, v21, v22
    s_lshl_b32 s57, s56, 1
    v_xor_b32 v21, s57, v18
    v_lshl_add_u32 v10, v21, 4, v20
    v_xor_b32 v11, 32, v10
    v_xor_b32 v12, 64, v10
    v_xor_b32 v13, 96, v10
    s_lshl_b32 s54, s43, 1
    v_xor_b32 v21, s54, v18
    v_lshlrev_b32 v21, 4, v21
    v_lshl_add_u32 v19, v23, 7, v21
    v_bfe_u32 v22, v0, 4, 1
    v_lshl_add_u32 v19, v22, 3, v19
    v_bfe_u32 v20, v0, 2, 2
    v_lshrrev_b32 v21, 5, v0
    v_lshl_add_u32 v14, v21, 3, v20
    v_lshlrev_b32 v14, 7, v14
    v_lshrrev_b32 v20, 1, v20
    v_lshl_add_u32 v20, v20, 1, v21
    v_bfe_u32 v21, v0, 4, 1
    v_xor_b32 v20, v20, v21
    v_lshl_add_u32 v14, v20, 5, v14
    v_and_b32 v20, 1, v0
    v_bfe_u32 v21, v0, 1, 1
    v_lshl_add_u32 v20, v20, 1, v21
    v_lshl_add_u32 v14, v20, 3, v14
    s_lshl_b32 s55, s55, 6
    s_lshl_b32 s57, s56, 12
    s_or_b32 s57, s57, s55
    v_xor_b32 v14, s57, v14
    v_xor_b32 v15, 4096, v14
    v_xor_b32 v16, 8192, v14
    v_xor_b32 v17, 12288, v14
    v_bfe_u32 v120, v0, 2, 1
    v_bfe_u32 v121, v0, 4, 1
    v_cmp_eq_u32 vcc, v120, v121
    v_mov_b32 v121, 0x3f803f80
    s_nop 0
    v_cndmask_b32 v120, 0, v121, vcc
    v_mov_b32 v121, v120
    v_mov_b32 v122, v120
    v_mov_b32 v123, v120
    v_mov_b32 v124, 0
    v_mov_b32 v125, 0
    s_getreg_b32 s50, hwreg(HW_REG_XCC_ID)
    s_and_b32 s50, s50, 15
    s_mov_b32 s52, 0x80000
    s_and_b32 s56, s43, 1
    s_lshr_b32 s57, s43, 1
    s_lshl_b32 s70, s42, 1
    s_add_u32 s70, s70, s57
    s_lshl_b32 s71, s70, 6
    s_lshl_b32 s70, s70, 7
    s_lshl_b32 s58, s44, 1
    s_add_u32 s58, s58, s56
    s_add_u32 s70, s70, s58
    s_lshl_b32 s70, s70, 10
    s_add_u32 s71, s71, s58
    s_lshl_b32 s71, s71, 8
    s_add_u32 s71, s71, 15859712
    s_lshl_b32 s85, s57, 2
    s_add_u32 s85, s85, s56
    s_lshl_b32 s85, s85, 10
    s_add_u32 s85, s85, 131072
    s_lshl_b32 s84, s43, 13
    v_and_b32 v64, 15, v0
    v_lshlrev_b32 v64, 4, v64
    v_lshrrev_b32 v65, 5, v0
    v_lshl_add_u32 v65, v65, 8, v64
    v_accvgpr_write_b32 a16, v65
    v_bfe_u32 v66, v0, 4, 1
    v_lshl_add_u32 v67, v66, 11, v65
    v_add_u32 v67, s85, v67
    v_accvgpr_write_b32 a17, v67
    v_lshl_add_u32 v67, v66, 16, v65
    v_add_u32 v67, 2097152, v67
    v_accvgpr_write_b32 a18, v67
    v_lshrrev_b32 v66, 4, v0
    v_lshl_add_u32 v67, v66, 9, v64
    v_accvgpr_write_b32 a19, v67
    v_bfe_u32 v64, v0, 2, 2
    v_lshl_add_u32 v67, v66, 3, v64
    v_lshlrev_b32 v67, 7, v67
    v_lshrrev_b32 v64, 1, v64
    v_and_b32 v66, 1, v66
    v_lshl_add_u32 v64, v64, 1, v66
    v_xor_b32 v64, s43, v64
    v_lshl_add_u32 v67, v64, 5, v67
    v_and_b32 v64, 3, v0
    v_lshl_add_u32 v67, v64, 3, v67
    v_accvgpr_write_b32 a20, v67
    v_bfe_u32 v65, v0, 2, 1
    v_lshl_add_u32 v64, v65, 4, v64
    s_lshl_b32 s54, s43, 2
    v_add_lshl_u32 v64, s54, v64, 3
    v_accvgpr_write_b32 a21, v64
    v_lshrrev_b32 v64, 3, v0
    v_lshlrev_b32 v65, 11, v64
    v_sub_u32 v66, v6, v65
    v_accvgpr_write_b32 a22, v66
    v_sub_u32 v66, v7, v65
    v_subrev_u32 v66, 16384, v66
    v_accvgpr_write_b32 a23, v66
    v_sub_u32 v66, v8, v65
    v_subrev_u32 v66, 32768, v66
    v_accvgpr_write_b32 a24, v66
    v_sub_u32 v66, v9, v65
    v_subrev_u32 v66, 49152, v66
    v_accvgpr_write_b32 a25, v66
    v_lshl_add_u32 v66, v64, 9, v6
    v_accvgpr_write_b32 a26, v66
    v_lshl_add_u32 v66, v64, 9, v7
    v_add_u32 v66, 4096, v66
    v_accvgpr_write_b32 a27, v66
    v_and_b32 v64, 0x7ff, v14
    s_lshl_b32 s54, s56, 11
    v_xor_b32 v65, s54, v64
    v_accvgpr_write_b32 a28, v65
    s_lshl_b32 s54, s56, 5
    v_xor_b32 v65, s54, v64
    v_add_u32 v65, s53, v65
    v_accvgpr_write_b32 a29, v65
    s_lshl_b32 s55, s42, 2
    s_add_u32 s55, s55, s43
    s_lshl_b32 s77, s44, 11
    s_add_u32 s77, s77, 15728640
    s_lshl_b32 s73, s55, 3
    s_add_u32 s73, s73, s77
    s_lshl_b32 s79, s44, 16
    s_lshl_b32 s54, s55, 5
    s_add_u32 s6, s79, s54
    s_add_u32 s79, s79, 4194304
    s_lshl_b32 s72, s55, 10
    s_add_u32 s72, s72, s79
    s_add_u32 s79, s79, s53
    s_and_b32 s54, s55, 15
    s_lshl_b32 s54, s54, 7
    s_add_u32 s54, s54, s77
    v_mov_b32 v65, s54
    s_lshl_b32 s54, s40, 7
    s_add_u32 s54, s54, 15794176
    v_mov_b32 v66, s54
    v_cmp_lt_u32 vcc, 31, v0
    s_nop 1
    v_cndmask_b32 v64, v65, v66, vcc
    v_accvgpr_write_b32 a30, v64
    s_lshl_b32 s54, s55, 6
    s_lshl_b32 s58, s44, 1
    s_sub_u32 s58, s58, 8
    s_add_u32 s54, s54, s58
    s_lshl_b32 s54, s54, 10
    s_add_u32 s60, s54, 0
    s_cmp_ge_u32 s44, 4
    s_cselect_b32 s60, s60, 1073741824
    s_cselect_b32 s80, 0x3f803f80, 0
    s_add_u32 s61, s54, 2048
    s_cmp_ge_u32 s44, 3
    s_cselect_b32 s61, s61, 1073741824
    s_cselect_b32 s81, 0x3f803f80, 0
    s_add_u32 s62, s54, 4096
    s_cmp_ge_u32 s44, 2
    s_cselect_b32 s62, s62, 1073741824
    s_cselect_b32 s82, 0x3f803f80, 0
    s_add_u32 s63, s54, 6144
    s_cmp_ge_u32 s44, 1
    s_cselect_b32 s63, s63, 1073741824
    s_cselect_b32 s83, 0x3f803f80, 0
    s_mov_b32 s68, 0x0000ffff
    s_mov_b32 s69, 0x0000ffff
    v_min_u32 v64, 7, v0
    v_add_u32 v64, s58, v64
    v_max_i32 v64, 0, v64
    s_lshl_b32 s58, s40, 3
    v_cmp_gt_u32 s[86:87], s58, v64
    s_lshr_b32 s54, s55, 1
    s_lshl_b32 s54, s54, 6
    v_add_lshl_u32 v64, s54, v64, 8
    v_add_u32 v64, 15859712, v64
    s_mov_b32 s87, 0
    v_mov_b32 v65, s71
    v_and_b32 v66, 7, v0
    v_lshlrev_b32 v66, 6, v66
    v_bfe_u32 v67, v0, 3, 2
    v_add_lshl_u32 v66, v66, v67, 1
    v_add_lshl_u32 v66, s58, v66, 8
    v_add_u32 v66, 15859584, v66
    v_cmp_lt_u32 vcc, 31, v0
    s_nop 1
    v_cndmask_b32 v65, v64, v65, vcc
    v_cndmask_b32 v66, v64, v66, vcc
    v_accvgpr_write_b32 a31, v65
    v_accvgpr_write_b32 a32, v66
    s_lshl_b32 s54, s40, 2
    s_add_u32 s54, s54, s43
    s_lshl_b32 s78, s54, 11
    s_add_u32 s78, s78, 15728640
    s_lshl_b32 s3, s54, 16
    s_add_u32 s3, s3, 6291456
    s_mul_i32 s4, s54, 229376
    s_lshl_b32 s54, s45, 12
    s_add_u32 s4, s4, s54
    s_lshl_b32 s54, s57, 11
    s_add_u32 s4, s4, s54
    s_add_u32 s4, s4, 8388608
    s_lshl_b32 s5, s45, 3
    s_add_u32 s5, s5, s78
    s_min_u32 s54, s45, 27
    s_lshl_b32 s74, s54, 7
    s_mul_i32 s54, s43, 57344
    s_add_u32 s74, s74, s54
    s_lshl_b32 s88, s40, 12
    s_cmp_eq_u32 s40, 7
    s_cselect_b32 s89, 0, s88
    s_mul_i32 s75, s43, 458752
    s_lshl_b32 s54, s42, 7
    s_add_u32 s75, s75, s54
    s_mul_i32 s76, s44, 229376
    s_mul_i32 s54, s43, 28672
    s_add_u32 s76, s76, s54
    s_add_u32 s76, s76, 8388608
    s_mul_i32 s7, s7, 1792
    v_min_u32 v64, 1, v0
    v_lshlrev_b32 v64, 7, v64
    v_accvgpr_write_b32 a33, v64
    v_and_b32 v64, 31, v0
    v_lshrrev_b32 v65, 5, v0
    v_lshlrev_b32 v65, 2, v65
    v_sub_u32 v64, v64, v65
    v_subrev_u32 v66, 0, v64
    v_ashrrev_i32 v66, 31, v66
    v_and_b32 v66, 0xf149f2ca, v66
    v_accvgpr_write_b32 a0, v66
    v_subrev_u32 v67, 1, v64
    v_ashrrev_i32 v67, 31, v67
    v_and_b32 v67, 0xf149f2ca, v67
    v_accvgpr_write_b32 a1, v67
    v_subrev_u32 v68, 2, v64
    v_ashrrev_i32 v68, 31, v68
    v_and_b32 v68, 0xf149f2ca, v68
    v_accvgpr_write_b32 a2, v68
    v_subrev_u32 v69, 3, v64
    v_ashrrev_i32 v69, 31, v69
    v_and_b32 v69, 0xf149f2ca, v69
    v_accvgpr_write_b32 a3, v69
    v_subrev_u32 v66, 8, v64
    v_ashrrev_i32 v66, 31, v66
    v_and_b32 v66, 0xf149f2ca, v66
    v_accvgpr_write_b32 a4, v66
    v_subrev_u32 v67, 9, v64
    v_ashrrev_i32 v67, 31, v67
    v_and_b32 v67, 0xf149f2ca, v67
    v_accvgpr_write_b32 a5, v67
    v_subrev_u32 v68, 10, v64
    v_ashrrev_i32 v68, 31, v68
    v_and_b32 v68, 0xf149f2ca, v68
    v_accvgpr_write_b32 a6, v68
    v_subrev_u32 v69, 11, v64
    v_ashrrev_i32 v69, 31, v69
    v_and_b32 v69, 0xf149f2ca, v69
    v_accvgpr_write_b32 a7, v69
    v_subrev_u32 v66, 16, v64
    v_ashrrev_i32 v66, 31, v66
    v_and_b32 v66, 0xf149f2ca, v66
    v_accvgpr_write_b32 a8, v66
    v_subrev_u32 v67, 17, v64
    v_ashrrev_i32 v67, 31, v67
    v_and_b32 v67, 0xf149f2ca, v67
    v_accvgpr_write_b32 a9, v67
    v_subrev_u32 v68, 18, v64
    v_ashrrev_i32 v68, 31, v68
    v_and_b32 v68, 0xf149f2ca, v68
    v_accvgpr_write_b32 a10, v68
    v_subrev_u32 v69, 19, v64
    v_ashrrev_i32 v69, 31, v69
    v_and_b32 v69, 0xf149f2ca, v69
    v_accvgpr_write_b32 a11, v69
    v_subrev_u32 v66, 24, v64
    v_ashrrev_i32 v66, 31, v66
    v_and_b32 v66, 0xf149f2ca, v66
    v_accvgpr_write_b32 a12, v66
    v_subrev_u32 v67, 25, v64
    v_ashrrev_i32 v67, 31, v67
    v_and_b32 v67, 0xf149f2ca, v67
    v_accvgpr_write_b32 a13, v67
    v_subrev_u32 v68, 26, v64
    v_ashrrev_i32 v68, 31, v68
    v_and_b32 v68, 0xf149f2ca, v68
    v_accvgpr_write_b32 a14, v68
    v_subrev_u32 v69, 27, v64
    v_ashrrev_i32 v69, 31, v69
    v_and_b32 v69, 0xf149f2ca, v69
    v_accvgpr_write_b32 a15, v69
    v_mov_b32 v64, s80
    v_accvgpr_write_b32 a104, v64
    v_accvgpr_write_b32 a105, v64
    v_accvgpr_write_b32 a106, v64
    v_accvgpr_write_b32 a107, v64
    v_accvgpr_write_b32 a108, v64
    v_accvgpr_write_b32 a109, v64
    v_accvgpr_write_b32 a110, v64
    v_accvgpr_write_b32 a111, v64
    v_accvgpr_write_b32 a112, v64
    v_accvgpr_write_b32 a113, v64
    v_accvgpr_write_b32 a114, v64
    v_accvgpr_write_b32 a115, v64
    v_accvgpr_write_b32 a116, v64
    v_accvgpr_write_b32 a117, v64
    v_accvgpr_write_b32 a118, v64
    v_accvgpr_write_b32 a119, v64
    v_mov_b32 v64, s81
    v_accvgpr_write_b32 a120, v64
    v_accvgpr_write_b32 a121, v64
    v_accvgpr_write_b32 a122, v64
    v_accvgpr_write_b32 a123, v64
    v_accvgpr_write_b32 a124, v64
    v_accvgpr_write_b32 a125, v64
    v_accvgpr_write_b32 a126, v64
    v_accvgpr_write_b32 a127, v64
    s_add_u32 m0, s53, 32768
    s_lshl_b32 s59, s66, 7
    s_add_u32 s59, s59, s65
    buffer_load_dwordx4 v4, s[8:11], s59 offen nt lds
    buffer_load_dwordx4 v5, s[8:11], s59 offen offset:1024 nt lds
    s_add_u32 m0, s53, 34816
    s_mul_i32 s59, s66, 196608
    s_add_u32 s59, s59, s64
    buffer_load_dwordx4 v6, s[12:15], s59 offen lds
    buffer_load_dwordx4 v7, s[12:15], s59 offen offset:1024 lds
    s_add_u32 s66, s66, 1
    s_and_b32 s66, s66, 7
    s_waitcnt lgkmcnt(0)
    s_waitcnt vmcnt(13)
    s_barrier
    ds_read_b128 v[128:131], v10 offset:0
    ds_read_b64_tr_b16 v[80:81], v14 offset:2048
    s_add_u32 m0, s53, 49152
    s_lshl_b32 s59, s66, 7
    s_add_u32 s59, s59, s65
    buffer_load_dwordx4 v4, s[8:11], s59 offen nt lds
    ds_read_b64_tr_b16 v[82:83], v14 offset:2560
    ds_read_b128 v[132:135], v11 offset:0
    ds_read_b64_tr_b16 v[84:85], v15 offset:2048
    ds_read_b64_tr_b16 v[86:87], v15 offset:2560
    buffer_load_dwordx4 v5, s[8:11], s59 offen offset:1024 nt lds
    s_add_u32 m0, s53, 51200
    s_mul_i32 s59, s66, 196608
    ds_read_b128 v[136:139], v12 offset:0
    ds_read_b64_tr_b16 v[88:89], v16 offset:2048
    ds_read_b64_tr_b16 v[90:91], v16 offset:2560
    ds_read_b128 v[140:143], v13 offset:0
    s_add_u32 s59, s59, s64
    buffer_load_dwordx4 v6, s[12:15], s59 offen lds
    ds_read_b64_tr_b16 v[92:93], v17 offset:2048
    ds_read_b64_tr_b16 v[94:95], v17 offset:2560
    ds_read_b64 v[24:25], v19 offset:0
    ds_read_b64 v[26:27], v19 offset:4096
    buffer_load_dwordx4 v7, s[12:15], s59 offen offset:1024 lds
    s_add_u32 s66, s66, 1
    s_and_b32 s66, s66, 7
    ds_read_b64 v[28:29], v19 offset:8192
    ds_read_b64 v[30:31], v19 offset:12288
    s_waitcnt lgkmcnt(10)
    v_mfma_f32_32x32x16_bf16 v[32:47], v[80:83], v[128:131], 0
    s_waitcnt vmcnt(8)
    s_barrier
    ds_read_b128 v[144:147], v10 offset:16384
    s_add_u32 m0, s53, 65536
    s_lshl_b32 s59, s66, 7
    s_add_u32 s59, s59, s65
    ds_read_b64_tr_b16 v[96:97], v14 offset:18432
    buffer_load_dwordx4 v4, s[8:11], s59 offen nt lds
    ds_read_b64_tr_b16 v[98:99], v14 offset:18944
    v_mfma_f32_16x16x32_bf16 v[112:115], v[120:123], v[128:131], 0
    ds_read_b128 v[148:151], v11 offset:16384
    ds_read_b64_tr_b16 v[100:101], v15 offset:18432
    v_mfma_f32_16x16x32_bf16 v[116:119], v[120:123], v[80:83], 0
    ds_read_b64_tr_b16 v[102:103], v15 offset:18944
    ds_read_b128 v[152:155], v12 offset:16384
    v_mfma_f32_32x32x16_bf16 v[32:47], v[84:87], v[132:135], v[32:47]
    ds_read_b64_tr_b16 v[104:105], v16 offset:18432
    ds_read_b64_tr_b16 v[106:107], v16 offset:18944
    buffer_load_dwordx4 v5, s[8:11], s59 offen offset:1024 nt lds
    ds_read_b128 v[156:159], v13 offset:16384
    s_add_u32 m0, s53, 67584
    s_mul_i32 s59, s66, 196608
    v_mfma_f32_16x16x32_bf16 v[116:119], v[120:123], v[84:87], v[116:119]
    ds_read_b64_tr_b16 v[108:109], v17 offset:18432
    s_waitcnt lgkmcnt(10)
    ds_read_b64_tr_b16 v[110:111], v17 offset:18944
    v_accvgpr_write_b32 a128, v64
    v_mfma_f32_32x32x16_bf16 v[32:47], v[88:91], v[136:139], v[32:47]
    s_add_u32 s59, s59, s64
    buffer_load_dwordx4 v6, s[12:15], s59 offen lds
    v_accvgpr_write_b32 a129, v64
    v_accvgpr_write_b32 a130, v64
    v_accvgpr_write_b32 a131, v64
    v_accvgpr_write_b32 a132, v64
    v_mfma_f32_16x16x32_bf16 v[112:115], v[120:123], v[136:139], v[112:115]
    v_accvgpr_write_b32 a133, v64
    v_accvgpr_write_b32 a134, v64
    v_accvgpr_write_b32 a135, v64
    v_mov_b32 v64, s82
    v_mfma_f32_32x32x16_bf16 v[32:47], v[92:95], v[140:143], v[32:47]
    buffer_load_dwordx4 v7, s[12:15], s59 offen offset:1024 lds
    s_add_u32 s66, s66, 1
    s_and_b32 s66, s66, 7
    v_accvgpr_write_b32 a136, v64
    v_accvgpr_write_b32 a137, v64
    v_dot2c_f32_bf16 v124, v128, v128
    v_dot2c_f32_bf16 v125, v129, v129
    v_dot2c_f32_bf16 v124, v130, v130
    v_dot2c_f32_bf16 v125, v131, v131
    v_dot2c_f32_bf16 v124, v136, v136
    v_dot2c_f32_bf16 v125, v137, v137
    v_dot2c_f32_bf16 v124, v138, v138
    v_dot2c_f32_bf16 v125, v139, v139
    s_waitcnt lgkmcnt(0)
    v_mfma_f32_32x32x16_bf16 v[32:47], v[96:99], v[144:147], v[32:47]
    s_waitcnt vmcnt(8)
    s_barrier
    ds_read_b128 v[160:163], v10 offset:32768
    s_add_u32 m0, s53, 81920
    s_lshl_b32 s59, s66, 7
    s_add_u32 s59, s59, s65
    ds_read_b64_tr_b16 v[80:81], v14 offset:34816
    buffer_load_dwordx4 v4, s[8:11], s59 offen nt lds
    ds_read_b64_tr_b16 v[82:83], v14 offset:35328
    ds_read_b128 v[164:167], v11 offset:32768
    v_mfma_f32_16x16x32_bf16 v[112:115], v[120:123], v[144:147], v[112:115]
    ds_read_b64_tr_b16 v[84:85], v15 offset:34816
    ds_read_b64_tr_b16 v[86:87], v15 offset:35328
    ds_read_b128 v[168:171], v12 offset:32768
    v_mfma_f32_16x16x32_bf16 v[116:119], v[120:123], v[96:99], v[116:119]
    ds_read_b64_tr_b16 v[88:89], v16 offset:34816
    ds_read_b64_tr_b16 v[90:91], v16 offset:35328
    ds_read_b128 v[172:175], v13 offset:32768
    v_mfma_f32_32x32x16_bf16 v[32:47], v[100:103], v[148:151], v[32:47]
    ds_read_b64_tr_b16 v[92:93], v17 offset:34816
    ds_read_b64_tr_b16 v[94:95], v17 offset:35328
    buffer_load_dwordx4 v5, s[8:11], s59 offen offset:1024 nt lds
    v_accvgpr_write_b32 a138, v64
    v_accvgpr_write_b32 a139, v64
    v_accvgpr_write_b32 a140, v64
    s_add_u32 m0, s53, 83968
    s_mul_i32 s59, s66, 196608
    v_mfma_f32_16x16x32_bf16 v[116:119], v[120:123], v[100:103], v[116:119]
    v_accvgpr_write_b32 a141, v64
    v_accvgpr_write_b32 a142, v64
    v_accvgpr_write_b32 a143, v64
    v_accvgpr_write_b32 a144, v64
    v_accvgpr_write_b32 a145, v64
    v_mfma_f32_32x32x16_bf16 v[32:47], v[104:107], v[152:155], v[32:47]
    s_add_u32 s59, s59, s64
    buffer_load_dwordx4 v6, s[12:15], s59 offen lds
    s_add_u32 s66, s66, 1
    buffer_load_dwordx4 v7, s[12:15], s59 offen offset:1024 lds
    v_accvgpr_write_b32 a146, v64
    v_accvgpr_write_b32 a147, v64
    v_accvgpr_write_b32 a148, v64
    s_and_b32 s66, s66, 7
    v_mfma_f32_16x16x32_bf16 v[112:115], v[120:123], v[152:155], v[112:115]
    v_mfma_f32_32x32x16_bf16 v[32:47], v[108:111], v[156:159], v[32:47]
    v_accvgpr_read_b32 v18, a30
    buffer_load_dword a187, v18, s[36:39], 0 offen sc1
    v_dot2c_f32_bf16 v124, v144, v144
    v_dot2c_f32_bf16 v125, v145, v145
    v_dot2c_f32_bf16 v124, v146, v146
    v_dot2c_f32_bf16 v125, v147, v147
    v_dot2c_f32_bf16 v124, v152, v152
    v_dot2c_f32_bf16 v125, v153, v153
    v_dot2c_f32_bf16 v124, v154, v154
    v_dot2c_f32_bf16 v125, v155, v155
    s_waitcnt lgkmcnt(0)
    v_mfma_f32_32x32x16_bf16 v[32:47], v[80:83], v[160:163], v[32:47]
    s_waitcnt vmcnt(9)
    s_barrier
    ds_read_b128 v[176:179], v10 offset:49152
    s_add_u32 m0, s53, 0
    s_lshl_b32 s59, s66, 7
    s_add_u32 s59, s59, s65
    ds_read_b64_tr_b16 v[96:97], v14 offset:51200
    buffer_load_dwordx4 v4, s[8:11], s59 offen nt lds
    ds_read_b64_tr_b16 v[98:99], v14 offset:51712
    ds_read_b128 v[180:183], v11 offset:49152
    v_mfma_f32_16x16x32_bf16 v[112:115], v[120:123], v[160:163], v[112:115]
    ds_read_b64_tr_b16 v[100:101], v15 offset:51200
    ds_read_b64_tr_b16 v[102:103], v15 offset:51712
    ds_read_b128 v[184:187], v12 offset:49152
    v_mfma_f32_16x16x32_bf16 v[116:119], v[120:123], v[80:83], v[116:119]
    ds_read_b64_tr_b16 v[104:105], v16 offset:51200
    ds_read_b64_tr_b16 v[106:107], v16 offset:51712
    ds_read_b128 v[188:191], v13 offset:49152
    v_mfma_f32_32x32x16_bf16 v[32:47], v[84:87], v[164:167], v[32:47]
    ds_read_b64_tr_b16 v[108:109], v17 offset:51200
    ds_read_b64_tr_b16 v[110:111], v17 offset:51712
    buffer_load_dwordx4 v5, s[8:11], s59 offen offset:1024 nt lds
    v_lshl_add_u32 v19, s43, 10, v1
    v_add_u32 v19, 155648, v19
    v_accvgpr_write_b32 a149, v64
    s_add_u32 m0, s53, 2048
    s_mul_i32 s59, s66, 196608
    v_mfma_f32_16x16x32_bf16 v[116:119], v[120:123], v[84:87], v[116:119]
    v_accvgpr_write_b32 a150, v64
    v_accvgpr_write_b32 a151, v64
    v_mov_b32 v64, s83
    v_accvgpr_write_b32 a152, v64
    v_accvgpr_write_b32 a153, v64
    v_mfma_f32_32x32x16_bf16 v[32:47], v[88:91], v[168:171], v[32:47]
    s_add_u32 s59, s59, s64
    buffer_load_dwordx4 v6, s[12:15], s59 offen lds
    v_accvgpr_write_b32 a154, v64
    v_accvgpr_write_b32 a155, v64
    v_accvgpr_write_b32 a156, v64
    v_accvgpr_write_b32 a157, v64
    v_accvgpr_write_b32 a158, v64
    v_mfma_f32_16x16x32_bf16 v[112:115], v[120:123], v[168:171], v[112:115]
    v_xor_b32 v10, 0x10000, v10
    v_xor_b32 v11, 0x10000, v11
    v_xor_b32 v12, 0x10000, v12
    v_xor_b32 v13, 0x10000, v13
    v_xor_b32 v14, 0x10000, v14
    v_mfma_f32_32x32x16_bf16 v[32:47], v[92:95], v[172:175], v[32:47]
    buffer_load_dwordx4 v7, s[12:15], s59 offen offset:1024 lds
    s_add_u32 s66, s66, 1
    s_and_b32 s66, s66, 7
    v_xor_b32 v15, 0x10000, v15
    v_xor_b32 v16, 0x10000, v16
    v_xor_b32 v17, 0x10000, v17
    v_dot2c_f32_bf16 v124, v160, v160
    v_dot2c_f32_bf16 v125, v161, v161
    v_dot2c_f32_bf16 v124, v162, v162
    v_dot2c_f32_bf16 v125, v163, v163
    v_dot2c_f32_bf16 v124, v168, v168
    v_dot2c_f32_bf16 v125, v169, v169
    v_dot2c_f32_bf16 v124, v170, v170
    v_dot2c_f32_bf16 v125, v171, v171
    s_waitcnt lgkmcnt(0)
    v_mfma_f32_32x32x16_bf16 v[32:47], v[96:99], v[176:179], v[32:47]
    s_waitcnt vmcnt(9)
    s_barrier
    ds_read_b128 v[192:195], v10 offset:0
    s_add_u32 m0, s53, 16384
    s_lshl_b32 s59, s66, 7
    s_add_u32 s59, s59, s65
    ds_read_b64_tr_b16 v[80:81], v14 offset:2048
    buffer_load_dwordx4 v4, s[8:11], s59 offen nt lds
    ds_read_b64_tr_b16 v[82:83], v14 offset:2560
    v_mfma_f32_16x16x32_bf16 v[112:115], v[120:123], v[176:179], v[112:115]
    ds_read_b128 v[196:199], v11 offset:0
    ds_read_b64_tr_b16 v[84:85], v15 offset:2048
    v_mfma_f32_16x16x32_bf16 v[116:119], v[120:123], v[96:99], v[116:119]
    ds_read_b64_tr_b16 v[86:87], v15 offset:2560
    ds_read_b128 v[200:203], v12 offset:0
    v_mfma_f32_32x32x16_bf16 v[32:47], v[100:103], v[180:183], v[32:47]
    ds_read_b64_tr_b16 v[88:89], v16 offset:2048
    ds_read_b64_tr_b16 v[90:91], v16 offset:2560
    buffer_load_dwordx4 v5, s[8:11], s59 offen offset:1024 nt lds
    ds_read_b128 v[204:207], v13 offset:0
    s_add_u32 m0, s53, 18432
    s_mul_i32 s59, s66, 196608
    v_mfma_f32_16x16x32_bf16 v[116:119], v[120:123], v[100:103], v[116:119]
    ds_read_b64_tr_b16 v[92:93], v17 offset:2048
    ds_read_b64_tr_b16 v[94:95], v17 offset:2560
    v_accvgpr_write_b32 a159, v64
    v_mfma_f32_32x32x16_bf16 v[32:47], v[104:107], v[184:187], v[32:47]
    s_add_u32 s59, s59, s64
    buffer_load_dwordx4 v6, s[12:15], s59 offen lds
    v_accvgpr_write_b32 a160, v64
    v_accvgpr_write_b32 a161, v64
    v_accvgpr_write_b32 a162, v64
    v_accvgpr_write_b32 a163, v64
    v_mfma_f32_16x16x32_bf16 v[112:115], v[120:123], v[184:187], v[112:115]
    v_accvgpr_write_b32 a164, v64
    v_accvgpr_write_b32 a165, v64
    v_accvgpr_write_b32 a166, v64
    v_accvgpr_write_b32 a167, v64
    v_mfma_f32_32x32x16_bf16 v[32:47], v[108:111], v[188:191], v[32:47]
    buffer_load_dwordx4 v7, s[12:15], s59 offen offset:1024 lds
    s_add_u32 s66, s66, 1
    s_and_b32 s66, s66, 7
    v_mov_b32 v64, 0x3f803f80
    v_accvgpr_write_b32 a168, v64
    v_dot2c_f32_bf16 v124, v176, v176
    v_dot2c_f32_bf16 v125, v177, v177
    v_dot2c_f32_bf16 v124, v178, v178
    v_dot2c_f32_bf16 v125, v179, v179
    v_dot2c_f32_bf16 v124, v184, v184
    v_dot2c_f32_bf16 v125, v185, v185
    v_dot2c_f32_bf16 v124, v186, v186
    v_dot2c_f32_bf16 v125, v187, v187
    s_waitcnt lgkmcnt(0)
    v_mfma_f32_32x32x16_bf16 v[32:47], v[80:83], v[192:195], v[32:47]
    s_lshr_b32 s59, s43, 1
    s_add_u32 s66, s42, s59
    s_and_b32 s66, s66, 7
    s_and_b32 s59, s43, 1
    s_mul_i32 s64, s59, 98304
    s_lshl_b32 s59, s42, 7
    s_add_u32 s64, s64, s59
    s_add_u32 s64, s64, 2048
    s_add_u32 m0, s53, 32768
    s_mul_i32 s59, s66, 196608
    s_add_u32 s59, s59, s64
    buffer_load_dwordx4 v6, s[12:15], s59 offen lds
    v_mfma_f32_16x16x32_bf16 v[112:115], v[120:123], v[192:195], v[112:115]
    s_waitcnt vmcnt(10)
    s_barrier
    ds_read_b128 v[208:211], v10 offset:16384
    ds_read_b64_tr_b16 v[96:97], v14 offset:18432
    v_mfma_f32_16x16x32_bf16 v[116:119], v[120:123], v[80:83], v[116:119]
    ds_read_b64_tr_b16 v[98:99], v14 offset:18944
    ds_read_b128 v[212:215], v11 offset:16384
    v_mfma_f32_32x32x16_bf16 v[32:47], v[84:87], v[196:199], v[32:47]
    ds_read_b64_tr_b16 v[100:101], v15 offset:18432
    ds_read_b64_tr_b16 v[102:103], v15 offset:18944
    buffer_load_dwordx4 v7, s[12:15], s59 offen offset:1024 lds
    ds_read_b128 v[216:219], v12 offset:16384
    ds_read_b64_tr_b16 v[104:105], v16 offset:18432
    v_mfma_f32_16x16x32_bf16 v[116:119], v[120:123], v[84:87], v[116:119]
    ds_read_b64_tr_b16 v[106:107], v16 offset:18944
    ds_read_b128 v[220:223], v13 offset:16384
    v_mfma_f32_32x32x16_bf16 v[32:47], v[88:91], v[200:203], v[32:47]
    ds_read_b64_tr_b16 v[108:109], v17 offset:18432
    ds_read_b64_tr_b16 v[110:111], v17 offset:18944
    buffer_load_dwordx4 v8, s[12:15], s59 offen offset:2048 lds
    v_accvgpr_write_b32 a169, v64
    v_accvgpr_write_b32 a170, v64
    v_accvgpr_write_b32 a171, v64
    v_accvgpr_write_b32 a172, v64
    v_accvgpr_write_b32 a173, v64
    v_accvgpr_write_b32 a174, v64
    v_mfma_f32_16x16x32_bf16 v[112:115], v[120:123], v[200:203], v[112:115]
    v_accvgpr_write_b32 a175, v64
    v_accvgpr_write_b32 a176, v64
    v_accvgpr_write_b32 a177, v64
    v_accvgpr_write_b32 a178, v64
    v_accvgpr_write_b32 a179, v64
    v_xor_b32 v10, 0x10000, v10
    v_mfma_f32_32x32x16_bf16 v[32:47], v[92:95], v[204:207], v[32:47]
    buffer_load_dwordx4 v9, s[12:15], s59 offen offset:3072 lds
    s_add_u32 s66, s66, 2
    s_and_b32 s66, s66, 7
    v_xor_b32 v11, 0x10000, v11
    v_xor_b32 v12, 0x10000, v12
    v_xor_b32 v13, 0x10000, v13
    v_xor_b32 v14, 0x10000, v14
    v_xor_b32 v15, 0x10000, v15
    v_xor_b32 v16, 0x10000, v16
    v_xor_b32 v17, 0x10000, v17
    v_dot2c_f32_bf16 v124, v192, v192
    v_dot2c_f32_bf16 v125, v193, v193
    v_dot2c_f32_bf16 v124, v194, v194
    v_dot2c_f32_bf16 v125, v195, v195
    v_dot2c_f32_bf16 v124, v200, v200
    v_dot2c_f32_bf16 v125, v201, v201
    v_dot2c_f32_bf16 v124, v202, v202
    v_dot2c_f32_bf16 v125, v203, v203
    s_waitcnt lgkmcnt(0)
    v_mfma_f32_32x32x16_bf16 v[32:47], v[96:99], v[208:211], v[32:47]
    s_waitcnt vmcnt(8)
    s_barrier
    ds_read_b128 v[224:227], v10 offset:0
    s_add_u32 m0, s53, 49152
    s_mul_i32 s59, s66, 196608
    s_add_u32 s59, s59, s64
    ds_read_b64_tr_b16 v[80:81], v14 offset:2048
    buffer_load_dwordx4 v6, s[12:15], s59 offen lds
    ds_read_b64_tr_b16 v[82:83], v14 offset:2560
    v_mfma_f32_16x16x32_bf16 v[112:115], v[120:123], v[208:211], v[112:115]
    ds_read_b128 v[228:231], v11 offset:0
    v_mfma_f32_16x16x32_bf16 v[116:119], v[120:123], v[96:99], v[116:119]
    ds_read_b64_tr_b16 v[84:85], v15 offset:2048
    ds_read_b64_tr_b16 v[86:87], v15 offset:2560
    v_mfma_f32_32x32x16_bf16 v[32:47], v[100:103], v[212:215], v[32:47]
    ds_read_b128 v[232:235], v12 offset:0
    buffer_load_dwordx4 v7, s[12:15], s59 offen offset:1024 lds
    ds_read_b64_tr_b16 v[88:89], v16 offset:2048
    ds_read_b64_tr_b16 v[90:91], v16 offset:2560
    v_mfma_f32_16x16x32_bf16 v[116:119], v[120:123], v[100:103], v[116:119]
    ds_read_b128 v[236:239], v13 offset:0
    v_mfma_f32_32x32x16_bf16 v[32:47], v[104:107], v[216:219], v[32:47]
    ds_read_b64_tr_b16 v[92:93], v17 offset:2048
    ds_read_b64_tr_b16 v[94:95], v17 offset:2560
    buffer_load_dwordx4 v8, s[12:15], s59 offen offset:2048 lds
    v_accvgpr_write_b32 a180, v64
    v_accvgpr_write_b32 a181, v64
    v_accvgpr_write_b32 a182, v64
    v_mfma_f32_16x16x32_bf16 v[112:115], v[120:123], v[216:219], v[112:115]
    s_mul_i32 s46, s46, 1664525
    v_accvgpr_write_b32 a183, v64
    s_add_u32 s46, s46, 1013904223
    s_mul_i32 s47, s47, 22695477
    v_mfma_f32_32x32x16_bf16 v[32:47], v[108:111], v[220:223], v[32:47]
    s_add_u32 s47, s47, 0x9e3779b1
    s_mul_i32 s48, s48, 1664525
    s_add_u32 s48, s48, 1013904223
    buffer_load_dwordx4 v9, s[12:15], s59 offen offset:3072 lds
    s_mul_i32 s49, s49, 22695477
    s_add_u32 s66, s66, 2
    s_and_b32 s66, s66, 7
    v_dot2c_f32_bf16 v124, v208, v208
    v_dot2c_f32_bf16 v125, v209, v209
    v_dot2c_f32_bf16 v124, v210, v210
    v_dot2c_f32_bf16 v125, v211, v211
    v_dot2c_f32_bf16 v124, v216, v216
    v_dot2c_f32_bf16 v125, v217, v217
    v_dot2c_f32_bf16 v124, v218, v218
    v_dot2c_f32_bf16 v125, v219, v219
    s_waitcnt lgkmcnt(0)
    v_mfma_f32_32x32x16_bf16 v[32:47], v[80:83], v[224:227], v[32:47]
    s_waitcnt vmcnt(8)
    s_barrier
    ds_read_b128 v[240:243], v10 offset:16384
    s_add_u32 m0, s53, 65536
    s_mul_i32 s59, s66, 196608
    s_add_u32 s59, s59, s64
    ds_read_b64_tr_b16 v[96:97], v14 offset:18432
    buffer_load_dwordx4 v6, s[12:15], s59 offen lds
    ds_read_b64_tr_b16 v[98:99], v14 offset:18944
    v_mfma_f32_16x16x32_bf16 v[112:115], v[120:123], v[224:227], v[112:115]
    ds_read_b128 v[244:247], v11 offset:16384
    ds_read_b64_tr_b16 v[100:101], v15 offset:18432
    v_mfma_f32_16x16x32_bf16 v[116:119], v[120:123], v[80:83], v[116:119]
    ds_read_b64_tr_b16 v[102:103], v15 offset:18944
    ds_read_b128 v[248:251], v12 offset:16384
    v_mfma_f32_32x32x16_bf16 v[32:47], v[84:87], v[228:231], v[32:47]
    ds_read_b64_tr_b16 v[104:105], v16 offset:18432
    ds_read_b64_tr_b16 v[106:107], v16 offset:18944
    buffer_load_dwordx4 v7, s[12:15], s59 offen offset:1024 lds
    ds_read_b128 v[252:255], v13 offset:16384
    v_mfma_f32_16x16x32_bf16 v[116:119], v[120:123], v[84:87], v[116:119]
    ds_read_b64_tr_b16 v[108:109], v17 offset:18432
    s_add_u32 s49, s49, 0x9e3779b1
    ds_read_b64_tr_b16 v[110:111], v17 offset:18944
    v_mov_b32 v64, s46
    v_mfma_f32_32x32x16_bf16 v[32:47], v[88:91], v[232:235], v[32:47]
    buffer_load_dwordx4 v8, s[12:15], s59 offen offset:2048 lds
    v_mov_b32 v65, s48
    v_cndmask_b32 v64, v64, v65, s[86:87]
    v_accvgpr_write_b32 a34, v64
    v_mov_b32 v64, s47
    v_mov_b32 v65, s49
    v_mfma_f32_16x16x32_bf16 v[112:115], v[120:123], v[232:235], v[112:115]
    v_cndmask_b32 v64, v64, v65, s[86:87]
    v_or_b32 v64, 15, v64
    v_accvgpr_write_b32 a35, v64
    v_bfe_u32 v18, v14, 12, 2
    v_mfma_f32_32x32x16_bf16 v[32:47], v[92:95], v[236:239], v[32:47]
    buffer_load_dwordx4 v9, s[12:15], s59 offen offset:3072 lds
    s_add_u32 s66, s66, 2
    s_and_b32 s66, s66, 7
    v_and_b32 v14, 0x7ff, v14
    v_lshl_add_u32 v14, v18, 11, v14
    v_xor_b32 v15, 2048, v14
    v_xor_b32 v16, 4096, v14
    v_xor_b32 v17, 6144, v14
    v_dot2c_f32_bf16 v124, v224, v224
    v_dot2c_f32_bf16 v125, v225, v225
    v_dot2c_f32_bf16 v124, v226, v226
    v_dot2c_f32_bf16 v125, v227, v227
    v_dot2c_f32_bf16 v124, v232, v232
    v_dot2c_f32_bf16 v125, v233, v233
    v_dot2c_f32_bf16 v124, v234, v234
    v_dot2c_f32_bf16 v125, v235, v235
    s_waitcnt lgkmcnt(0)
    v_mfma_f32_32x32x16_bf16 v[32:47], v[96:99], v[240:243], v[32:47]
    s_waitcnt vmcnt(8)
    s_barrier
    ds_read_b64_tr_b16 v[80:81], v14 offset:32768
    s_add_u32 m0, s53, 81920
    s_mul_i32 s59, s66, 196608
    ds_read_b64_tr_b16 v[82:83], v14 offset:33280
    s_add_u32 s59, s59, s64
    buffer_load_dwordx4 v6, s[12:15], s59 offen lds
    v_mfma_f32_16x16x32_bf16 v[112:115], v[120:123], v[240:243], v[112:115]
    ds_read_b64_tr_b16 v[84:85], v15 offset:32768
    v_mfma_f32_16x16x32_bf16 v[116:119], v[120:123], v[96:99], v[116:119]
    ds_read_b64_tr_b16 v[86:87], v15 offset:33280
    v_mfma_f32_32x32x16_bf16 v[32:47], v[100:103], v[244:247], v[32:47]
    ds_read_b64_tr_b16 v[88:89], v16 offset:32768
    ds_read_b64_tr_b16 v[90:91], v16 offset:33280
    ds_read_b64_tr_b16 v[92:93], v17 offset:32768
    v_mfma_f32_16x16x32_bf16 v[116:119], v[120:123], v[100:103], v[116:119]
    ds_read_b64_tr_b16 v[94:95], v17 offset:33280
    v_mfma_f32_32x32x16_bf16 v[32:47], v[104:107], v[248:251], v[32:47]
    buffer_load_dwordx4 v7, s[12:15], s59 offen offset:1024 lds
    v_add_u32 v10, s85, v1
    v_accvgpr_read_b32 v11, a16
    v_accvgpr_read_b32 v12, a17
    v_mfma_f32_16x16x32_bf16 v[112:115], v[120:123], v[248:251], v[112:115]
    v_accvgpr_read_b32 v13, a18
    v_accvgpr_read_b32 v4, a34
    v_mfma_f32_32x32x16_bf16 v[32:47], v[108:111], v[252:255], v[32:47]
    v_accvgpr_read_b32 v5, a35
    v_xor_b32 v22, 2048, v19
    v_xor_b32 v23, 1024, v19
    v_dot2c_f32_bf16 v124, v240, v240
    v_dot2c_f32_bf16 v125, v241, v241
    v_dot2c_f32_bf16 v124, v242, v242
    v_dot2c_f32_bf16 v125, v243, v243
    v_dot2c_f32_bf16 v124, v248, v248
    v_dot2c_f32_bf16 v125, v249, v249
    v_dot2c_f32_bf16 v124, v250, v250
    v_dot2c_f32_bf16 v125, v251, v251
    v_mov_b32 v114, v116
    s_nop 1
    v_add_f32 v113, v124, v125
    ds_write_b96 v19, v[112:114]
    s_waitcnt lgkmcnt(1)
    v_mfma_f32_32x32x16_bf16 v[48:63], v[128:131], v[80:83], 0
    ds_read_b64_tr_b16 v[96:97], v14 offset:40960
    ds_read_b64_tr_b16 v[98:99], v14 offset:41472
    buffer_load_dwordx4 v8, s[12:15], s59 offen offset:2048 lds
    ds_read_b64_tr_b16 v[100:101], v15 offset:40960
    v_mfma_f32_16x16x32_bf16 v[116:119], v[120:123], v[80:83], 0
    ds_read_b64_tr_b16 v[102:103], v15 offset:41472
    v_mfma_f32_32x32x16_bf16 v[48:63], v[132:135], v[84:87], v[48:63]
    ds_read_b64_tr_b16 v[104:105], v16 offset:40960
    s_add_u32 s66, s66, 2
    ds_read_b64_tr_b16 v[106:107], v16 offset:41472
    buffer_load_dwordx4 v9, s[12:15], s59 offen offset:3072 lds
    ds_read_b64_tr_b16 v[108:109], v17 offset:40960
    s_and_b32 s66, s66, 7
    v_mfma_f32_16x16x32_bf16 v[116:119], v[120:123], v[84:87], v[116:119]
    ds_read_b64_tr_b16 v[110:111], v17 offset:41472
    s_waitcnt lgkmcnt(8)
    s_barrier
    v_mfma_f32_32x32x16_bf16 v[48:63], v[136:139], v[88:91], v[48:63]
    ds_read_b64 v[20:21], v22
    ds_read_b32 v127, v23 offset:8
    v_mfma_f32_32x32x16_bf16 v[48:63], v[140:143], v[92:95], v[48:63]
    s_add_u32 m0, s53, 98304
    v_accvgpr_read_b32 v18, a22
    s_lshl_b32 s65, s43, 8
    s_add_u32 s65, s65, s42
    s_lshl_b32 s65, s65, 7
    buffer_load_dwordx4 v18, s[16:19], s65 offen lds
    s_waitcnt lgkmcnt(5)
    v_mfma_f32_32x32x16_bf16 v[48:63], v[144:147], v[96:99], v[48:63]
    s_waitcnt vmcnt(9)
    s_barrier
    ds_read_b64_tr_b16 v[80:81], v14 offset:49152
    s_sub_u32 s64, s64, 2048
    s_add_u32 m0, s53, 0
    ds_read_b64_tr_b16 v[82:83], v14 offset:49664
    s_mul_i32 s59, s66, 196608
    ds_read_b64_tr_b16 v[84:85], v15 offset:49152
    s_add_u32 s59, s59, s64
    ds_read_b64_tr_b16 v[86:87], v15 offset:49664
    buffer_load_dwordx4 v6, s[12:15], s59 offen lds
    ds_read_b64_tr_b16 v[88:89], v16 offset:49152
    v_mfma_f32_16x16x32_bf16 v[116:119], v[120:123], v[96:99], v[116:119]
    ds_read_b64_tr_b16 v[90:91], v16 offset:49664
    ds_read_b64_tr_b16 v[92:93], v17 offset:49152
    ds_read_b64_tr_b16 v[94:95], v17 offset:49664
    v_mfma_f32_32x32x16_bf16 v[48:63], v[148:151], v[100:103], v[48:63]
    s_waitcnt lgkmcnt(8)
    v_add_f32 v124, v113, v21
    v_add_f32 v20, v112, v20
    v_mov_b32 v125, v124
    v_add_f32 v127, v127, v114
    v_mul_f32 v23, 0.001953125, v20
    v_permlane32_swap_b32 v124, v125
    v_add_f32 v124, v124, v125
    v_mul_f32 v124, 0.001953125, v124
    v_fma_f32 v124, -v23, v23, v124
    v_max_f32 v124, 0, v124
    v_mfma_f32_16x16x32_bf16 v[116:119], v[120:123], v[100:103], v[116:119]
    v_add_f32 v124, 0x3727c5ac, v124
    v_rsq_f32 v126, v124
    v_mul_f32 v23, -0.5, v23
    v_cvt_pk_bf16_f32 v21, v23, 0
    v_lshlrev_b32 v18, 16, v21
    v_mfma_f32_32x32x16_bf16 v[48:63], v[152:155], v[104:107], v[48:63]
    buffer_load_dwordx4 v7, s[12:15], s59 offen offset:1024 lds
    v_sub_f32 v18, v23, v18
    v_cvt_pk_bf16_f32 v20, v23, v18
    v_mov_b32 v22, 0
    v_mov_b32 v23, 0
    v_mov_b32 v114, 0
    v_mov_b32 v115, 0
    v_cvt_pk_bf16_f32 v112, v127, v127
    v_mfma_f32_32x32x16_bf16 v[48:63], v[156:159], v[108:111], v[48:63]
    v_and_b32 v18, 0xffff0000, v112
    v_sub_f32 v18, v127, v18
    v_cvt_pk_bf16_f32 v113, v18, 0
    s_nop 1
    v_mfma_f32_32x32x16_bf16 v[32:47], v[112:115], v[20:23], v[32:47]
    s_waitcnt lgkmcnt(0)
    v_mfma_f32_32x32x16_bf16 v[48:63], v[160:163], v[80:83], v[48:63]
    ds_read_b64_tr_b16 v[96:97], v14 offset:57344
    ds_read_b64_tr_b16 v[98:99], v14 offset:57856
    buffer_load_dwordx4 v8, s[12:15], s59 offen offset:2048 lds
    ds_read_b64_tr_b16 v[100:101], v15 offset:57344
    ds_read_b64_tr_b16 v[102:103], v15 offset:57856
    ds_read_b64_tr_b16 v[104:105], v16 offset:57344
    ds_read_b64_tr_b16 v[106:107], v16 offset:57856
    v_mfma_f32_16x16x32_bf16 v[116:119], v[120:123], v[80:83], v[116:119]
    ds_read_b64_tr_b16 v[108:109], v17 offset:57344
    ds_read_b64_tr_b16 v[110:111], v17 offset:57856
    v_mul_f32 v32, v126, v32
    v_mul_f32 v33, v126, v33
    v_cvt_pk_bf16_f32 v32, v32, v33
    v_mul_f32 v34, v126, v34
    v_mfma_f32_32x32x16_bf16 v[48:63], v[164:167], v[84:87], v[48:63]
    buffer_load_dwordx4 v9, s[12:15], s59 offen offset:3072 lds
    s_add_u32 s66, s66, 2
    s_and_b32 s66, s66, 7
    v_mul_f32 v35, v126, v35
    v_cvt_pk_bf16_f32 v33, v34, v35
    v_mul_f32 v36, v126, v36
    v_mul_f32 v37, v126, v37
    v_cvt_pk_bf16_f32 v34, v36, v37
    v_mul_f32 v38, v126, v38
    v_mul_f32 v39, v126, v39
    v_cvt_pk_bf16_f32 v35, v38, v39
    v_mfma_f32_16x16x32_bf16 v[116:119], v[120:123], v[84:87], v[116:119]
    buffer_store_dwordx4 v[32:35], v1, s[36:39], s70 offen sc1
    s_add_u32 s58, s70, 0x10000
    v_mul_f32 v40, v126, v40
    v_mul_f32 v41, v126, v41
    v_cvt_pk_bf16_f32 v36, v40, v41
    v_mul_f32 v42, v126, v42
    v_mul_f32 v43, v126, v43
    v_mfma_f32_32x32x16_bf16 v[48:63], v[168:171], v[88:91], v[48:63]
    v_cvt_pk_bf16_f32 v37, v42, v43
    v_mul_f32 v44, v126, v44
    v_mul_f32 v45, v126, v45
    v_cvt_pk_bf16_f32 v38, v44, v45
    v_mul_f32 v46, v126, v46
    v_mul_f32 v47, v126, v47
    v_cvt_pk_bf16_f32 v39, v46, v47
    buffer_store_dwordx4 v[36:39], v1, s[36:39], s58 offen sc1
    v_mfma_f32_32x32x16_bf16 v[48:63], v[172:175], v[92:95], v[48:63]
    s_add_u32 m0, s53, 98304
    v_accvgpr_read_b32 v18, a23
    buffer_load_dwordx4 v18, s[16:19], s65 offen offset:1024 lds
    v_xor_b32 v14, 0x10000, v14
    v_xor_b32 v15, 0x10000, v15
    v_xor_b32 v16, 0x10000, v16
    v_xor_b32 v17, 0x10000, v17
    s_waitcnt lgkmcnt(0)
    v_mfma_f32_32x32x16_bf16 v[48:63], v[176:179], v[96:99], v[48:63]
    s_waitcnt vmcnt(12)
    s_barrier
    ds_read_b64_tr_b16 v[80:81], v14 offset:0
    s_add_u32 m0, s53, 16384
    s_mul_i32 s59, s66, 196608
    ds_read_b64_tr_b16 v[82:83], v14 offset:512
    s_add_u32 s59, s59, s64
    buffer_load_dwordx4 v6, s[12:15], s59 offen lds
    v_mfma_f32_16x16x32_bf16 v[116:119], v[120:123], v[96:99], v[116:119]
    ds_read_b64_tr_b16 v[84:85], v15 offset:0
    v_mfma_f32_32x32x16_bf16 v[48:63], v[180:183], v[100:103], v[48:63]
    ds_read_b64_tr_b16 v[86:87], v15 offset:512
    ds_read_b64_tr_b16 v[88:89], v16 offset:0
    buffer_load_dwordx4 v7, s[12:15], s59 offen offset:1024 lds
    ds_read_b64_tr_b16 v[90:91], v16 offset:512
    v_mfma_f32_16x16x32_bf16 v[116:119], v[120:123], v[100:103], v[116:119]
    ds_read_b64_tr_b16 v[92:93], v17 offset:0
    v_mfma_f32_32x32x16_bf16 v[48:63], v[184:187], v[104:107], v[48:63]
    ds_read_b64_tr_b16 v[94:95], v17 offset:512
    s_and_b32 s58, s47, -16
    s_or_b32 s58, s58, s50
    ds_write_b128 v10, v[32:35] offset:8192
    v_mov_b32 v124, s46
    v_mov_b32 v125, s58
    v_mfma_f32_32x32x16_bf16 v[48:63], v[188:191], v[108:111], v[48:63]
    s_add_u32 m0, s53, 98304
    v_accvgpr_read_b32 v18, a24
    buffer_load_dwordx4 v18, s[16:19], s65 offen offset:2048 lds
    s_waitcnt lgkmcnt(6)
    v_mfma_f32_32x32x16_bf16 v[48:63], v[192:195], v[80:83], v[48:63]
    ds_read_b64_tr_b16 v[96:97], v14 offset:8192
    s_add_u32 m0, s53, 16384
    ds_read_b64_tr_b16 v[98:99], v14 offset:8704
    buffer_load_dwordx4 v8, s[12:15], s59 offen offset:2048 lds
    ds_read_b64_tr_b16 v[100:101], v15 offset:8192
    v_mfma_f32_16x16x32_bf16 v[116:119], v[120:123], v[80:83], v[116:119]
    ds_read_b64_tr_b16 v[102:103], v15 offset:8704
    s_waitcnt lgkmcnt(6)
    v_mfma_f32_32x32x16_bf16 v[48:63], v[196:199], v[84:87], v[48:63]
    ds_read_b64_tr_b16 v[104:105], v16 offset:8192
    ds_read_b64_tr_b16 v[106:107], v16 offset:8704
    ds_read_b64_tr_b16 v[108:109], v17 offset:8192
    v_mfma_f32_16x16x32_bf16 v[116:119], v[120:123], v[84:87], v[116:119]
    ds_read_b64_tr_b16 v[110:111], v17 offset:8704
    v_mfma_f32_32x32x16_bf16 v[48:63], v[200:203], v[88:91], v[48:63]
    ds_write_b128 v10, v[36:39] offset:10240
    s_add_u32 s66, s66, 2
    buffer_load_dwordx4 v9, s[12:15], s59 offen offset:3072 lds
    v_mul_f32 v127, 0.5, v126
    v_cvt_pk_bf16_f32 v65, v127, 0
    s_and_b32 s66, s66, 7
    s_waitcnt lgkmcnt(8)
    v_mfma_f32_32x32x16_bf16 v[48:63], v[204:207], v[92:95], v[48:63]
    v_lshlrev_b32 v18, 16, v65
    v_sub_f32 v18, v127, v18
    v_cvt_pk_bf16_f32 v64, v127, v18
    s_waitcnt lgkmcnt(5)
    v_mfma_f32_32x32x16_bf16 v[48:63], v[208:211], v[96:99], v[48:63]
    s_waitcnt vmcnt(13)
    s_barrier
    ds_read_b64_tr_b16 v[80:81], v14 offset:16384
    s_add_u32 m0, s53, 32768
    s_mul_i32 s59, s66, 196608
    ds_read_b64_tr_b16 v[82:83], v14 offset:16896
    s_add_u32 s59, s59, s64
    ds_read_b64_tr_b16 v[84:85], v15 offset:16384
    buffer_load_dwordx4 v6, s[12:15], s59 offen lds
    v_mfma_f32_16x16x32_bf16 v[116:119], v[120:123], v[96:99], v[116:119]
    ds_read_b64_tr_b16 v[86:87], v15 offset:16896
    ds_read_b64_tr_b16 v[88:89], v16 offset:16384
    v_mfma_f32_32x32x16_bf16 v[48:63], v[212:215], v[100:103], v[48:63]
    ds_read_b64_tr_b16 v[90:91], v16 offset:16896
    ds_read_b64_tr_b16 v[92:93], v17 offset:16384
    buffer_load_dwordx4 v7, s[12:15], s59 offen offset:1024 lds
    ds_read_b64_tr_b16 v[94:95], v17 offset:16896
    v_mov_b32 v65, 0
    v_mov_b32 v66, 0
    v_mfma_f32_16x16x32_bf16 v[116:119], v[120:123], v[100:103], v[116:119]
    v_mov_b32 v67, 0
    v_mov_b32 v69, 0
    v_mov_b32 v70, 0
    s_waitcnt lgkmcnt(8)
    v_mfma_f32_32x32x16_bf16 v[48:63], v[216:219], v[104:107], v[48:63]
    v_mov_b32 v71, 0
    v_mov_b32 v68, 0x3f803f80
    v_mul_f32 v126, 0.36067376022224085, v126
    v_accvgpr_write_b32 a188, v126
    v_and_b32 v126, 15, v0
    v_lshlrev_b32 v126, 3, v126
    v_mfma_f32_32x32x16_bf16 v[48:63], v[220:223], v[108:111], v[48:63]
    s_add_u32 m0, s53, 98304
    v_accvgpr_read_b32 v18, a25
    buffer_load_dwordx4 v18, s[16:19], s65 offen offset:3072 lds
    s_waitcnt lgkmcnt(2)
    v_mfma_f32_32x32x16_bf16 v[48:63], v[224:227], v[80:83], v[48:63]
    ds_read_b64_tr_b16 v[96:97], v14 offset:24576
    s_add_u32 m0, s53, 32768
    ds_read_b64_tr_b16 v[98:99], v14 offset:25088
    buffer_load_dwordx4 v8, s[12:15], s59 offen offset:2048 lds
    ds_read_b64_tr_b16 v[100:101], v15 offset:24576
    v_mfma_f32_16x16x32_bf16 v[116:119], v[120:123], v[80:83], v[116:119]
    ds_read_b64_tr_b16 v[102:103], v15 offset:25088
    v_mfma_f32_32x32x16_bf16 v[48:63], v[228:231], v[84:87], v[48:63]
    ds_read_b64_tr_b16 v[104:105], v16 offset:24576
    s_add_u32 s66, s66, 2
    ds_read_b64_tr_b16 v[106:107], v16 offset:25088
    buffer_load_dwordx4 v9, s[12:15], s59 offen offset:3072 lds
    ds_read_b64_tr_b16 v[108:109], v17 offset:24576
    s_and_b32 s66, s66, 7
    v_mfma_f32_16x16x32_bf16 v[116:119], v[120:123], v[84:87], v[116:119]
    ds_read_b64_tr_b16 v[110:111], v17 offset:25088
    v_mfma_f32_32x32x16_bf16 v[48:63], v[232:235], v[88:91], v[48:63]
    v_mfma_f32_32x32x16_bf16 v[32:47], v[64:67], v[68:71], 0
    v_xor_b32 v14, 0x10000, v14
    v_xor_b32 v15, 0x10000, v15
    v_xor_b32 v16, 0x10000, v16
    v_xor_b32 v17, 0x10000, v17
    s_waitcnt lgkmcnt(4)
    v_mfma_f32_32x32x16_bf16 v[48:63], v[236:239], v[92:95], v[48:63]
    s_add_u32 m0, s53, 114688
    v_accvgpr_read_b32 v18, a22
    s_add_u32 s65, s65, 131072
    buffer_load_dwordx4 v18, s[16:19], s65 offen lds
    v_mfma_f32_32x32x16_bf16 v[48:63], v[240:243], v[96:99], v[48:63]
    s_waitcnt vmcnt(14)
    s_barrier
    ds_read_b64_tr_b16 v[80:81], v14 offset:0
    s_add_u32 m0, s53, 49152
    s_mul_i32 s59, s66, 196608
    ds_read_b64_tr_b16 v[82:83], v14 offset:512
    s_add_u32 s59, s59, s64
    buffer_load_dwordx4 v6, s[12:15], s59 offen lds
    v_mfma_f32_16x16x32_bf16 v[116:119], v[120:123], v[96:99], v[116:119]
    ds_read_b64_tr_b16 v[84:85], v15 offset:0
    v_mfma_f32_32x32x16_bf16 v[48:63], v[244:247], v[100:103], v[48:63]
    ds_read_b64_tr_b16 v[86:87], v15 offset:512
    ds_read_b64_tr_b16 v[88:89], v16 offset:0
    buffer_load_dwordx4 v7, s[12:15], s59 offen offset:1024 lds
    ds_read_b64_tr_b16 v[90:91], v16 offset:512
    v_mfma_f32_16x16x32_bf16 v[116:119], v[120:123], v[100:103], v[116:119]
    ds_read_b64_tr_b16 v[92:93], v17 offset:0
    s_waitcnt lgkmcnt(7)
    v_mfma_f32_32x32x16_bf16 v[48:63], v[248:251], v[104:107], v[48:63]
    ds_read_b64_tr_b16 v[94:95], v17 offset:512
    s_waitcnt vmcnt(14)
    buffer_store_dwordx2 v[124:125], v126, s[36:39], s71 offen sc1
    v_mfma_f32_32x32x16_bf16 v[48:63], v[252:255], v[108:111], v[48:63]
    s_add_u32 m0, s53, 114688
    v_accvgpr_read_b32 v18, a23
    buffer_load_dwordx4 v18, s[16:19], s65 offen offset:1024 lds
    v_mov_b32 v112, v116
    ds_write_b32 v19, v112 offset:12
    v_xor_b32 v19, 1024, v19
    s_waitcnt lgkmcnt(5)
    v_mfma_f32_32x32x16_bf16 v[64:79], v[80:83], v[128:131], 0
    ds_read_b64_tr_b16 v[96:97], v14 offset:8192
    s_add_u32 m0, s53, 49152
    ds_read_b64_tr_b16 v[98:99], v14 offset:8704
    buffer_load_dwordx4 v8, s[12:15], s59 offen offset:2048 lds
    ds_read_b64_tr_b16 v[100:101], v15 offset:8192
    v_mfma_f32_16x16x32_bf16 v[116:119], v[120:123], v[80:83], 0
    ds_read_b64_tr_b16 v[102:103], v15 offset:8704
    v_mfma_f32_32x32x16_bf16 v[64:79], v[84:87], v[132:135], v[64:79]
    ds_read_b64_tr_b16 v[104:105], v16 offset:8192
    s_add_u32 s66, s66, 2
    ds_read_b64_tr_b16 v[106:107], v16 offset:8704
    buffer_load_dwordx4 v9, s[12:15], s59 offen offset:3072 lds
    ds_read_b64_tr_b16 v[108:109], v17 offset:8192
    s_and_b32 s66, s66, 7
    v_mfma_f32_16x16x32_bf16 v[116:119], v[120:123], v[84:87], v[116:119]
    ds_read_b64_tr_b16 v[110:111], v17 offset:8704
    s_waitcnt lgkmcnt(8)
    s_barrier
    v_mfma_f32_32x32x16_bf16 v[64:79], v[88:91], v[136:139], v[64:79]
    s_add_u32 m0, s53, 114688
    v_accvgpr_read_b32 v18, a24
    buffer_load_dwordx4 v18, s[16:19], s65 offen offset:2048 lds
    v_mfma_f32_16x16x32_bf16 v[116:119], v[120:123], v[88:91], v[116:119]
    ds_read_b32 v127, v19 offset:12
    v_mfma_f32_32x32x16_bf16 v[64:79], v[92:95], v[140:143], v[64:79]
    v_accvgpr_read_b32 v18, a25
    buffer_load_dwordx4 v18, s[16:19], s65 offen offset:3072 lds
    v_mfma_f32_16x16x32_bf16 v[116:119], v[120:123], v[92:95], v[116:119]
    s_waitcnt lgkmcnt(2)
    v_mfma_f32_32x32x16_bf16 v[64:79], v[96:99], v[144:147], v[64:79]
    s_waitcnt vmcnt(14)
    s_barrier
    ds_read_b64_tr_b16 v[80:81], v14 offset:16384
    ds_read_b64_tr_b16 v[82:83], v14 offset:16896
    ds_read_b64_tr_b16 v[84:85], v15 offset:16384
    v_mfma_f32_16x16x32_bf16 v[116:119], v[120:123], v[96:99], v[116:119]
    ds_read_b64_tr_b16 v[86:87], v15 offset:16896
    v_mfma_f32_32x32x16_bf16 v[64:79], v[100:103], v[148:151], v[64:79]
    ds_read_b64_tr_b16 v[88:89], v16 offset:16384
    ds_read_b64_tr_b16 v[90:91], v16 offset:16896
    ds_read_b64_tr_b16 v[92:93], v17 offset:16384
    v_mfma_f32_16x16x32_bf16 v[116:119], v[120:123], v[100:103], v[116:119]
    ds_read_b64_tr_b16 v[94:95], v17 offset:16896
    v_mfma_f32_32x32x16_bf16 v[64:79], v[104:107], v[152:155], v[64:79]
    s_waitcnt lgkmcnt(8)
    v_add_f32 v127, v127, v112
    v_cvt_pk_bf16_f32 v112, v127, v127
    v_and_b32 v18, 0xffff0000, v112
    v_sub_f32 v18, v127, v18
    v_cvt_pk_bf16_f32 v113, v18, 0
    v_mfma_f32_16x16x32_bf16 v[116:119], v[120:123], v[104:107], v[116:119]
    s_nop 0
    v_mfma_f32_32x32x16_bf16 v[48:63], v[20:23], v[112:115], v[48:63]
    v_mfma_f32_32x32x16_bf16 v[64:79], v[108:111], v[156:159], v[64:79]
    v_accvgpr_read_b32 v19, a31
    v_accvgpr_read_b32 v6, a22
    v_accvgpr_read_b32 v7, a23
    v_accvgpr_read_b32 v8, a24
    v_accvgpr_read_b32 v9, a25
    v_mfma_f32_16x16x32_bf16 v[116:119], v[120:123], v[108:111], v[116:119]
    s_waitcnt lgkmcnt(0)
    v_mfma_f32_32x32x16_bf16 v[64:79], v[80:83], v[160:163], v[64:79]
    ds_read_b64_tr_b16 v[96:97], v14 offset:24576
    ds_read_b64_tr_b16 v[98:99], v14 offset:25088
    ds_read_b64_tr_b16 v[100:101], v15 offset:24576
    ds_read_b64_tr_b16 v[102:103], v15 offset:25088
    ds_read_b64_tr_b16 v[104:105], v16 offset:24576
    v_mfma_f32_16x16x32_bf16 v[116:119], v[120:123], v[80:83], v[116:119]
    ds_read_b64_tr_b16 v[106:107], v16 offset:25088
    ds_read_b64_tr_b16 v[108:109], v17 offset:24576
    ds_read_b64_tr_b16 v[110:111], v17 offset:25088
    v_mfma_f32_32x32x16_bf16 v[64:79], v[84:87], v[164:167], v[64:79]
    s_add_u32 m0, s53, 65536
    s_add_u32 s65, s65, 131072
    buffer_load_dwordx4 v6, s[16:19], s65 offen lds
    v_mul_f32 v48, v32, v48
    v_mul_f32 v49, v33, v49
    v_cvt_pk_bf16_f32 v48, v48, v49
    v_mul_f32 v50, v34, v50
    v_mul_f32 v51, v35, v51
    v_mfma_f32_16x16x32_bf16 v[116:119], v[120:123], v[84:87], v[116:119]
    v_cvt_pk_bf16_f32 v49, v50, v51
    v_mul_f32 v52, v36, v52
    v_mul_f32 v53, v37, v53
    v_cvt_pk_bf16_f32 v50, v52, v53
    v_mul_f32 v54, v38, v54
    v_mfma_f32_32x32x16_bf16 v[64:79], v[88:91], v[168:171], v[64:79]
    v_mul_f32 v55, v39, v55
    v_cvt_pk_bf16_f32 v51, v54, v55
    buffer_store_dwordx4 v[48:51], v13, s[36:39], s70 offen sc1
    v_mul_f32 v56, v40, v56
    v_mul_f32 v57, v41, v57
    v_cvt_pk_bf16_f32 v52, v56, v57
    v_mfma_f32_16x16x32_bf16 v[116:119], v[120:123], v[88:91], v[116:119]
    v_mul_f32 v58, v42, v58
    v_mul_f32 v59, v43, v59
    v_cvt_pk_bf16_f32 v53, v58, v59
    v_mul_f32 v60, v44, v60
    v_mul_f32 v61, v45, v61
    v_mfma_f32_32x32x16_bf16 v[64:79], v[92:95], v[172:175], v[64:79]
    v_cvt_pk_bf16_f32 v54, v60, v61
    v_mul_f32 v62, v46, v62
    v_mul_f32 v63, v47, v63
    v_cvt_pk_bf16_f32 v55, v62, v63
    buffer_store_dwordx4 v[52:55], v13, s[36:39], s70 offen offset:512 sc1
    buffer_load_dwordx4 v7, s[16:19], s65 offen offset:1024 lds
    v_mfma_f32_16x16x32_bf16 v[116:119], v[120:123], v[92:95], v[116:119]
    s_waitcnt lgkmcnt(0)
    v_mfma_f32_32x32x16_bf16 v[64:79], v[96:99], v[176:179], v[64:79]
    s_waitcnt vmcnt(13)
    s_barrier
    ds_read_b64_tr_b16 v[80:81], v14 offset:32768
    ds_read_b64_tr_b16 v[82:83], v14 offset:33280
    ds_read_b64_tr_b16 v[84:85], v15 offset:32768
    v_mfma_f32_16x16x32_bf16 v[116:119], v[120:123], v[96:99], v[116:119]
    ds_read_b64_tr_b16 v[86:87], v15 offset:33280
    v_mfma_f32_32x32x16_bf16 v[64:79], v[100:103], v[180:183], v[64:79]
    ds_read_b64_tr_b16 v[88:89], v16 offset:32768
    ds_read_b64_tr_b16 v[90:91], v16 offset:33280
    buffer_load_dwordx4 v8, s[16:19], s65 offen offset:2048 lds
    ds_read_b64_tr_b16 v[92:93], v17 offset:32768
    v_mfma_f32_16x16x32_bf16 v[116:119], v[120:123], v[100:103], v[116:119]
    ds_read_b64_tr_b16 v[94:95], v17 offset:33280
    v_mfma_f32_32x32x16_bf16 v[64:79], v[104:107], v[184:187], v[64:79]
    buffer_load_dwordx2 v[128:129], v19, s[36:39], 0 offen sc1
    ds_write_b128 v12, v[48:51] offset:16384
    v_mfma_f32_16x16x32_bf16 v[116:119], v[120:123], v[104:107], v[116:119]
    v_mfma_f32_32x32x16_bf16 v[64:79], v[108:111], v[188:191], v[64:79]
    buffer_load_dwordx4 v9, s[16:19], s65 offen offset:3072 lds
    v_mfma_f32_16x16x32_bf16 v[116:119], v[120:123], v[108:111], v[116:119]
    s_waitcnt lgkmcnt(2)
    v_mfma_f32_32x32x16_bf16 v[64:79], v[80:83], v[192:195], v[64:79]
    ds_read_b64_tr_b16 v[96:97], v14 offset:40960
    ds_read_b64_tr_b16 v[98:99], v14 offset:41472
    ds_read_b64_tr_b16 v[100:101], v15 offset:40960
    ds_read_b64_tr_b16 v[102:103], v15 offset:41472
    v_mfma_f32_16x16x32_bf16 v[116:119], v[120:123], v[80:83], v[116:119]
    ds_read_b64_tr_b16 v[104:105], v16 offset:40960
    ds_read_b64_tr_b16 v[106:107], v16 offset:41472
    v_mfma_f32_32x32x16_bf16 v[64:79], v[84:87], v[196:199], v[64:79]
    ds_read_b64_tr_b16 v[108:109], v17 offset:40960
    s_add_u32 m0, s53, 81920
    s_add_u32 s65, s65, 131072
    ds_read_b64_tr_b16 v[110:111], v17 offset:41472
    buffer_load_dwordx4 v6, s[16:19], s65 offen lds
    ds_write_b128 v12, v[52:55] offset:16896
    v_accvgpr_read_b32 v32, a0
    v_accvgpr_read_b32 v33, a1
    v_mfma_f32_16x16x32_bf16 v[116:119], v[120:123], v[84:87], v[116:119]
    v_accvgpr_read_b32 v34, a2
    v_accvgpr_read_b32 v35, a3
    v_accvgpr_read_b32 v36, a4
    v_mfma_f32_32x32x16_bf16 v[64:79], v[88:91], v[200:203], v[64:79]
    v_accvgpr_read_b32 v37, a5
    v_accvgpr_read_b32 v38, a6
    v_accvgpr_read_b32 v39, a7
    v_accvgpr_read_b32 v40, a8
    v_accvgpr_read_b32 v41, a9
    v_accvgpr_read_b32 v42, a10
    v_accvgpr_read_b32 v43, a11
    v_mfma_f32_16x16x32_bf16 v[116:119], v[120:123], v[88:91], v[116:119]
    v_accvgpr_read_b32 v44, a12
    v_accvgpr_read_b32 v45, a13
    v_accvgpr_read_b32 v46, a14
    s_waitcnt lgkmcnt(3)
    v_mfma_f32_32x32x16_bf16 v[64:79], v[92:95], v[204:207], v[64:79]
    buffer_load_dwordx4 v7, s[16:19], s65 offen offset:1024 lds
    v_accvgpr_read_b32 v47, a15
    v_mfma_f32_16x16x32_bf16 v[116:119], v[120:123], v[92:95], v[116:119]
    v_mfma_f32_32x32x16_bf16 v[64:79], v[96:99], v[208:211], v[64:79]
    s_waitcnt vmcnt(11)
    s_barrier
    ds_read_b64_tr_b16 v[80:81], v14 offset:49152
    ds_read_b64_tr_b16 v[82:83], v14 offset:49664
    ds_read_b64_tr_b16 v[84:85], v15 offset:49152
    v_mfma_f32_16x16x32_bf16 v[116:119], v[120:123], v[96:99], v[116:119]
    ds_read_b64_tr_b16 v[86:87], v15 offset:49664
    ds_read_b64_tr_b16 v[88:89], v16 offset:49152
    v_mfma_f32_32x32x16_bf16 v[64:79], v[100:103], v[212:215], v[64:79]
    ds_read_b64_tr_b16 v[90:91], v16 offset:49664
    ds_read_b64_tr_b16 v[92:93], v17 offset:49152
    buffer_load_dwordx4 v8, s[16:19], s65 offen offset:2048 lds
    ds_read_b64_tr_b16 v[94:95], v17 offset:49664
    v_sub_f32 v63, 0xf149f2ca, v47
    v_sub_f32 v62, 0xf149f2ca, v46
    v_mfma_f32_16x16x32_bf16 v[116:119], v[120:123], v[100:103], v[116:119]
    v_sub_f32 v61, 0xf149f2ca, v45
    v_sub_f32 v60, 0xf149f2ca, v44
    v_sub_f32 v59, 0xf149f2ca, v43
    v_mfma_f32_32x32x16_bf16 v[64:79], v[104:107], v[216:219], v[64:79]
    v_sub_f32 v58, 0xf149f2ca, v42
    v_sub_f32 v57, 0xf149f2ca, v41
    v_sub_f32 v56, 0xf149f2ca, v40
    v_sub_f32 v55, 0xf149f2ca, v39
    v_sub_f32 v54, 0xf149f2ca, v38
    v_sub_f32 v53, 0xf149f2ca, v37
    v_sub_f32 v52, 0xf149f2ca, v36
    v_mfma_f32_16x16x32_bf16 v[116:119], v[120:123], v[104:107], v[116:119]
    v_sub_f32 v51, 0xf149f2ca, v35
    v_sub_f32 v50, 0xf149f2ca, v34
    v_sub_f32 v49, 0xf149f2ca, v33
    s_waitcnt lgkmcnt(3)
    v_mfma_f32_32x32x16_bf16 v[64:79], v[108:111], v[220:223], v[64:79]
    buffer_load_dwordx4 v9, s[16:19], s65 offen offset:3072 lds
    v_sub_f32 v48, 0xf149f2ca, v32
    v_mfma_f32_16x16x32_bf16 v[116:119], v[120:123], v[108:111], v[116:119]
    v_mfma_f32_32x32x16_bf16 v[64:79], v[80:83], v[224:227], v[64:79]
    ds_read_b64_tr_b16 v[96:97], v14 offset:57344
    ds_read_b64_tr_b16 v[98:99], v14 offset:57856
    ds_read_b64_tr_b16 v[100:101], v15 offset:57344
    ds_read_b64_tr_b16 v[102:103], v15 offset:57856
    v_mfma_f32_16x16x32_bf16 v[116:119], v[120:123], v[80:83], v[116:119]
    ds_read_b64_tr_b16 v[104:105], v16 offset:57344
    ds_read_b64_tr_b16 v[106:107], v16 offset:57856
    v_mfma_f32_32x32x16_bf16 v[64:79], v[84:87], v[228:231], v[64:79]
    ds_read_b64_tr_b16 v[108:109], v17 offset:57344
    ds_read_b64_tr_b16 v[110:111], v17 offset:57856
    s_waitcnt vmcnt(8)
    buffer_store_dwordx2 v[124:125], v126, s[36:39], s71 offen offset:128 sc1
    v_mfma_f32_16x16x32_bf16 v[116:119], v[120:123], v[84:87], v[116:119]
    s_waitcnt lgkmcnt(8)
    v_mfma_f32_32x32x16_bf16 v[64:79], v[88:91], v[232:235], v[64:79]
    s_waitcnt vmcnt(6)
    v_or_b32 v131, 15, v129
    v_mov_b32 v130, v128
    v_cmp_ne_u64 vcc, v[130:131], v[4:5]
    s_nop 0
    s_cbranch_vccz L_ok_1
L_spin_2:
    buffer_load_dwordx2 v[128:129], v19, s[36:39], 0 offen sc1
    s_sub_u32 s52, s52, 1
    s_cbranch_scc1 L_abort
    s_waitcnt vmcnt(0)
    v_or_b32 v131, 15, v129
    v_mov_b32 v130, v128
    v_cmp_ne_u64 vcc, v[130:131], v[4:5]
    s_nop 0
    s_cbranch_vccnz L_spin_2
L_ok_1:
    v_accvgpr_read_b32 v19, a32
    v_accvgpr_read_b32 v127, a188
    v_accvgpr_read_b32 v13, a20
    v_mfma_f32_16x16x32_bf16 v[116:119], v[120:123], v[88:91], v[116:119]
    v_accvgpr_read_b32 v210, a19
    v_accvgpr_read_b32 v214, a28
    v_lshl_add_u32 v215, s43, 11, v1
    v_mfma_f32_32x32x16_bf16 v[64:79], v[92:95], v[236:239], v[64:79]
    v_add_u32 v215, 131072, v215
    v_lshl_add_u32 v12, s43, 11, v11
    v_add_u32 v12, 131072, v12
    v_add_u32 v11, 2097152, v11
    v_add_u32 v211, 131072, v210
    v_add_u32 v210, 98304, v210
    v_mfma_f32_16x16x32_bf16 v[116:119], v[120:123], v[92:95], v[116:119]
    s_waitcnt lgkmcnt(0)
    v_mfma_f32_32x32x16_bf16 v[64:79], v[96:99], v[240:243], v[64:79]
    buffer_load_dwordx4 a[92:95], v1, s[36:39], s63 offen offset:1024 sc1
    v_accvgpr_read_b32 v14, a26
    v_accvgpr_read_b32 v15, a27
    v_accvgpr_read_b32 v16, a21
    v_accvgpr_read_b32 v17, a29
    v_mfma_f32_16x16x32_bf16 v[116:119], v[120:123], v[96:99], v[116:119]
    v_mfma_f32_32x32x16_bf16 v[64:79], v[100:103], v[244:247], v[64:79]
    v_mfma_f32_16x16x32_bf16 v[116:119], v[120:123], v[100:103], v[116:119]
    v_mfma_f32_32x32x16_bf16 v[64:79], v[104:107], v[248:251], v[64:79]
    buffer_load_dwordx4 a[88:91], v1, s[36:39], s63 offen sc1
    v_mfma_f32_16x16x32_bf16 v[116:119], v[120:123], v[104:107], v[116:119]
    v_mfma_f32_16x16x32_bf16 v[116:119], v[120:123], v[108:111], v[116:119]
    v_mfma_f32_32x32x16_bf16 v[64:79], v[108:111], v[252:255], v[64:79]
    buffer_load_dwordx4 a[84:87], v1, s[36:39], s62 offen offset:1024 sc1
    s_nop 5
    v_cvt_pk_bf16_f32 v112, v116, v116
    v_and_b32 v18, 0xffff0000, v112
    v_sub_f32 v18, v116, v18
    v_cvt_pk_bf16_f32 v113, v18, 0
    s_nop 1
    v_mfma_f32_32x32x16_bf16 v[64:79], v[112:115], v[20:23], v[64:79]
    buffer_load_dwordx4 a[80:83], v1, s[36:39], s62 offen sc1
    buffer_load_dwordx4 a[76:79], v1, s[36:39], s61 offen offset:1024 sc1
    v_xor_b32 v18, 64, v17
    s_nop 8
    v_mul_f32 v64, v127, v64
    v_mul_f32 v65, v127, v65
    v_cvt_pk_bf16_f32 v64, v64, v65
    v_mul_f32 v66, v127, v66
    v_mul_f32 v67, v127, v67
    v_cvt_pk_bf16_f32 v65, v66, v67
    v_mul_f32 v68, v127, v68
    v_mul_f32 v69, v127, v69
    v_cvt_pk_bf16_f32 v66, v68, v69
    v_mul_f32 v70, v127, v70
    v_mul_f32 v71, v127, v71
    v_cvt_pk_bf16_f32 v67, v70, v71
    ds_write_b128 v10, v[64:67]
    v_mul_f32 v72, v127, v72
    v_mul_f32 v73, v127, v73
    v_cvt_pk_bf16_f32 v68, v72, v73
    v_mul_f32 v74, v127, v74
    v_mul_f32 v75, v127, v75
    v_cvt_pk_bf16_f32 v69, v74, v75
    v_mul_f32 v76, v127, v76
    v_mul_f32 v77, v127, v77
    v_cvt_pk_bf16_f32 v70, v76, v77
    v_mul_f32 v78, v127, v78
    v_mul_f32 v79, v127, v79
    v_cvt_pk_bf16_f32 v71, v78, v79
    ds_write_b128 v10, v[68:71] offset:2048
    buffer_load_dwordx4 a[72:75], v1, s[36:39], s61 offen sc1
    buffer_load_dwordx4 a[68:71], v1, s[36:39], s60 offen offset:1024 sc1
    buffer_load_dwordx4 a[64:67], v1, s[36:39], s60 offen sc1
    s_waitcnt lgkmcnt(0)
    s_barrier
    ds_read_b128 v[200:203], v215
    ds_read_b128 a[96:99], v215 offset:8192
    ds_read_b128 v[204:207], v215 offset:1024
    s_mov_b64 exec, s[68:69]
    ds_read_b128 a[168:171], v12 offset:16384
    ds_read_b128 a[172:175], v12 offset:16896
    ds_read_b128 a[176:179], v12 offset:17408
    ds_read_b128 a[180:183], v12 offset:17920
    s_mov_b64 exec, -1
    ds_read_b128 a[100:103], v215 offset:9216
    s_waitcnt lgkmcnt(6)
    v_mfma_f32_32x32x16_bf16 v[128:143], a[96:99], v[200:203], v[32:47]
    v_lshlrev_b32 v112, 16, v24
    v_and_b32 v113, 0xffff0000, v24
    v_lshlrev_b32 v114, 16, v25
    v_and_b32 v115, 0xffff0000, v25
    v_lshlrev_b32 v116, 16, v26
    v_and_b32 v117, 0xffff0000, v26
    v_lshlrev_b32 v118, 16, v27
    v_and_b32 v119, 0xffff0000, v27
    v_add_u32 v12, 0x10000, v13
    s_waitcnt lgkmcnt(4)
    v_mfma_f32_32x32x16_bf16 v[144:159], a[96:99], v[204:207], 0
    buffer_load_dwordx2 v[108:109], v19, s[36:39], 0 offen offset:128 sc1
    v_exp_f32 v128, v128
    v_exp_f32 v129, v129
    v_exp_f32 v130, v130
    v_exp_f32 v131, v131
    v_exp_f32 v132, v132
    v_exp_f32 v133, v133
    v_exp_f32 v134, v134
    v_exp_f32 v135, v135
    v_cvt_pk_bf16_f32 v64, v128, v129
    v_cvt_pk_bf16_f32 v65, v130, v131
    v_cvt_pk_bf16_f32 v66, v132, v133
    v_cvt_pk_bf16_f32 v67, v134, v135
    v_exp_f32 v136, v136
    v_exp_f32 v137, v137
    v_mfma_f32_32x32x16_bf16 v[160:175], a[168:171], v[64:67], 0
    v_exp_f32 v138, v138
    v_exp_f32 v139, v139
    v_exp_f32 v140, v140
    v_exp_f32 v141, v141
    v_exp_f32 v142, v142
    v_exp_f32 v143, v143
    v_cvt_pk_bf16_f32 v68, v136, v137
    v_cvt_pk_bf16_f32 v69, v138, v139
    v_cvt_pk_bf16_f32 v70, v140, v141
    v_cvt_pk_bf16_f32 v71, v142, v143
    s_waitcnt lgkmcnt(0)
    v_mfma_f32_32x32x16_bf16 v[128:143], a[100:103], v[204:207], v[32:47]
    v_exp_f32 v144, v144
    v_exp_f32 v145, v145
    v_exp_f32 v146, v146
    v_exp_f32 v147, v147
    v_mfma_f32_32x32x16_bf16 v[160:175], a[172:175], v[68:71], v[160:175]
    v_exp_f32 v148, v148
    v_exp_f32 v149, v149
    v_exp_f32 v150, v150
    v_exp_f32 v151, v151
    v_cvt_pk_bf16_f32 v72, v144, v145
    v_cvt_pk_bf16_f32 v73, v146, v147
    v_cvt_pk_bf16_f32 v74, v148, v149
    v_cvt_pk_bf16_f32 v75, v150, v151
    v_exp_f32 v152, v152
    v_exp_f32 v153, v153
    v_mfma_f32_32x32x16_bf16 v[176:191], a[168:171], v[72:75], 0
    v_exp_f32 v154, v154
    v_exp_f32 v155, v155
    v_exp_f32 v156, v156
    v_exp_f32 v157, v157
    v_exp_f32 v158, v158
    v_exp_f32 v159, v159
    v_cvt_pk_bf16_f32 v76, v152, v153
    v_cvt_pk_bf16_f32 v77, v154, v155
    v_cvt_pk_bf16_f32 v78, v156, v157
    v_cvt_pk_bf16_f32 v79, v158, v159
    s_waitcnt vmcnt(8)
    v_mfma_f32_32x32x16_bf16 v[144:159], a[92:95], v[200:203], 0
    v_exp_f32 v128, v128
    v_exp_f32 v129, v129
    v_exp_f32 v130, v130
    v_exp_f32 v131, v131
    v_mfma_f32_32x32x16_bf16 v[176:191], a[172:175], v[76:79], v[176:191]
    v_exp_f32 v132, v132
    v_exp_f32 v133, v133
    v_exp_f32 v134, v134
    v_exp_f32 v135, v135
    v_cvt_pk_bf16_f32 v80, v128, v129
    v_cvt_pk_bf16_f32 v81, v130, v131
    v_cvt_pk_bf16_f32 v82, v132, v133
    v_cvt_pk_bf16_f32 v83, v134, v135
    v_exp_f32 v136, v136
    v_exp_f32 v137, v137
    v_mfma_f32_32x32x16_bf16 v[176:191], a[176:179], v[80:83], v[176:191]
    v_exp_f32 v138, v138
    v_exp_f32 v139, v139
    v_exp_f32 v140, v140
    v_exp_f32 v141, v141
    v_exp_f32 v142, v142
    v_exp_f32 v143, v143
    v_cvt_pk_bf16_f32 v84, v136, v137
    v_cvt_pk_bf16_f32 v85, v138, v139
    v_cvt_pk_bf16_f32 v86, v140, v141
    v_cvt_pk_bf16_f32 v87, v142, v143
    s_waitcnt vmcnt(7)
    v_mfma_f32_32x32x16_bf16 v[128:143], a[88:91], v[200:203], 0
    s_waitcnt vmcnt(0)
    v_or_b32 v111, 15, v109
    v_mov_b32 v110, v108
    v_cmp_ne_u64 vcc, v[110:111], v[4:5]
    s_nop 0
    s_cbranch_vccz L_ok_3
L_spin_4:
    buffer_load_dwordx2 v[108:109], v19, s[36:39], 0 offen offset:128 sc1
    s_sub_u32 s52, s52, 1
    s_cbranch_scc1 L_abort
    s_waitcnt vmcnt(0)
    v_or_b32 v111, 15, v109
    v_mov_b32 v110, v108
    v_cmp_ne_u64 vcc, v[110:111], v[4:5]
    s_nop 0
    s_cbranch_vccnz L_spin_4
L_ok_3:
    v_and_b32 v109, 15, v109
    v_cmp_ne_u32 vcc, s50, v109
    v_mov_b32 v125, s47
    s_or_b32 s51, vcc_hi, 0
    s_mov_b64 exec, s[68:69]
    buffer_load_dwordx4 a[160:163], v11, s[36:39], s63 offen offset:1024 sc1
    buffer_load_dwordx4 a[164:167], v11, s[36:39], s63 offen offset:1536 sc1
    buffer_load_dwordx4 a[152:155], v11, s[36:39], s63 offen sc1
    buffer_load_dwordx4 a[156:159], v11, s[36:39], s63 offen offset:512 sc1
    s_mov_b64 exec, -1
    v_exp_f32 v144, v144
    v_exp_f32 v145, v145
    v_exp_f32 v146, v146
    v_exp_f32 v147, v147
    v_mfma_f32_32x32x16_bf16 v[176:191], a[180:183], v[84:87], v[176:191]
    s_mov_b64 exec, s[68:69]
    buffer_load_dwordx4 a[144:147], v11, s[36:39], s62 offen offset:1024 sc1
    buffer_load_dwordx4 a[148:151], v11, s[36:39], s62 offen offset:1536 sc1
    buffer_load_dwordx4 a[136:139], v11, s[36:39], s62 offen sc1
    buffer_load_dwordx4 a[140:143], v11, s[36:39], s62 offen offset:512 sc1
    s_mov_b64 exec, -1
    v_exp_f32 v148, v148
    v_exp_f32 v149, v149
    v_exp_f32 v150, v150
    v_exp_f32 v151, v151
    v_cvt_pk_bf16_f32 v88, v144, v145
    v_cvt_pk_bf16_f32 v89, v146, v147
    v_cvt_pk_bf16_f32 v90, v148, v149
    v_cvt_pk_bf16_f32 v91, v150, v151
    v_exp_f32 v152, v152
    v_exp_f32 v153, v153
    v_exp_f32 v154, v154
    v_exp_f32 v155, v155
    s_mov_b64 exec, s[68:69]
    buffer_load_dwordx4 a[128:131], v11, s[36:39], s61 offen offset:1024 sc1
    buffer_load_dwordx4 a[132:135], v11, s[36:39], s61 offen offset:1536 sc1
    buffer_load_dwordx4 a[120:123], v11, s[36:39], s61 offen sc1
    buffer_load_dwordx4 a[124:127], v11, s[36:39], s61 offen offset:512 sc1
    s_mov_b64 exec, -1
    s_mov_b64 exec, s[68:69]
    buffer_load_dwordx4 a[112:115], v11, s[36:39], s60 offen offset:1024 sc1
    buffer_load_dwordx4 a[116:119], v11, s[36:39], s60 offen offset:1536 sc1
    buffer_load_dwordx4 a[104:107], v11, s[36:39], s60 offen sc1
    buffer_load_dwordx4 a[108:111], v11, s[36:39], s60 offen offset:512 sc1
    s_mov_b64 exec, -1
    v_exp_f32 v156, v156
    v_exp_f32 v157, v157
    v_exp_f32 v158, v158
    v_exp_f32 v159, v159
    v_cvt_pk_bf16_f32 v92, v152, v153
    v_cvt_pk_bf16_f32 v93, v154, v155
    v_cvt_pk_bf16_f32 v94, v156, v157
    v_cvt_pk_bf16_f32 v95, v158, v159
    v_mfma_f32_32x32x16_bf16 v[144:159], a[84:87], v[200:203], 0
    s_barrier
    s_add_u32 m0, s53, 0
    s_add_u32 s41, s88, 0
    s_and_b32 s41, s41, 0x7000
    s_mul_i32 s41, s41, 56
    s_add_u32 s41, s41, s74
    buffer_load_dwordx4 v14, s[20:23], s41 offen lds
    buffer_load_dwordx4 v15, s[20:23], s41 offen offset:1024 lds
    v_exp_f32 v128, v128
    v_exp_f32 v129, v129
    v_exp_f32 v130, v130
    v_exp_f32 v131, v131
    v_exp_f32 v132, v132
    v_exp_f32 v133, v133
    v_exp_f32 v134, v134
    v_exp_f32 v135, v135
    v_cvt_pk_bf16_f32 v96, v128, v129
    v_cvt_pk_bf16_f32 v97, v130, v131
    v_cvt_pk_bf16_f32 v98, v132, v133
    v_cvt_pk_bf16_f32 v99, v134, v135
    v_exp_f32 v136, v136
    v_exp_f32 v137, v137
    v_exp_f32 v138, v138
    v_exp_f32 v139, v139
    s_add_u32 m0, s53, 2048
    s_nop 0
    buffer_load_dwordx4 v14, s[24:27], s41 offen lds
    buffer_load_dwordx4 v15, s[24:27], s41 offen offset:1024 lds
    v_exp_f32 v140, v140
    v_exp_f32 v141, v141
    v_exp_f32 v142, v142
    v_exp_f32 v143, v143
    v_cvt_pk_bf16_f32 v100, v136, v137
    v_cvt_pk_bf16_f32 v101, v138, v139
    v_cvt_pk_bf16_f32 v102, v140, v141
    v_cvt_pk_bf16_f32 v103, v142, v143
    v_mfma_f32_32x32x16_bf16 v[128:143], a[80:83], v[200:203], 0
    v_exp_f32 v144, v144
    v_exp_f32 v145, v145
    v_exp_f32 v146, v146
    v_exp_f32 v147, v147
    v_exp_f32 v148, v148
    v_exp_f32 v149, v149
    v_exp_f32 v150, v150
    v_exp_f32 v151, v151
    v_cvt_pk_bf16_f32 v64, v144, v145
    v_cvt_pk_bf16_f32 v65, v146, v147
    v_cvt_pk_bf16_f32 v66, v148, v149
    v_cvt_pk_bf16_f32 v67, v150, v151
    v_exp_f32 v152, v152
    v_exp_f32 v153, v153
    v_exp_f32 v154, v154
    v_exp_f32 v155, v155
    v_exp_f32 v156, v156
    v_exp_f32 v157, v157
    v_exp_f32 v158, v158
    v_exp_f32 v159, v159
    v_cvt_pk_bf16_f32 v68, v152, v153
    v_cvt_pk_bf16_f32 v69, v154, v155
    v_cvt_pk_bf16_f32 v70, v156, v157
    v_cvt_pk_bf16_f32 v71, v158, v159
    v_mfma_f32_32x32x16_bf16 v[144:159], a[76:79], v[200:203], 0
    v_exp_f32 v128, v128
    v_exp_f32 v129, v129
    v_exp_f32 v130, v130
    v_exp_f32 v131, v131
    v_exp_f32 v132, v132
    v_exp_f32 v133, v133
    v_exp_f32 v134, v134
    v_exp_f32 v135, v135
    v_cvt_pk_bf16_f32 v72, v128, v129
    v_cvt_pk_bf16_f32 v73, v130, v131
    v_cvt_pk_bf16_f32 v74, v132, v133
    v_cvt_pk_bf16_f32 v75, v134, v135
    v_exp_f32 v136, v136
    v_exp_f32 v137, v137
    v_exp_f32 v138, v138
    v_exp_f32 v139, v139
    v_exp_f32 v140, v140
    v_exp_f32 v141, v141
    v_exp_f32 v142, v142
    v_exp_f32 v143, v143
    v_cvt_pk_bf16_f32 v76, v136, v137
    v_cvt_pk_bf16_f32 v77, v138, v139
    v_cvt_pk_bf16_f32 v78, v140, v141
    v_cvt_pk_bf16_f32 v79, v142, v143
    v_mfma_f32_32x32x16_bf16 v[128:143], a[72:75], v[200:203], 0
    v_exp_f32 v144, v144
    v_exp_f32 v145, v145
    v_exp_f32 v146, v146
    v_exp_f32 v147, v147
    s_waitcnt vmcnt(19)
    v_mfma_f32_32x32x16_bf16 v[160:175], a[160:163], v[88:91], v[160:175]
    v_exp_f32 v148, v148
    v_exp_f32 v149, v149
    v_exp_f32 v150, v150
    v_exp_f32 v151, v151
    s_waitcnt vmcnt(18)
    v_mfma_f32_32x32x16_bf16 v[160:175], a[164:167], v[92:95], v[160:175]
    v_cvt_pk_bf16_f32 v80, v144, v145
    v_cvt_pk_bf16_f32 v81, v146, v147
    v_cvt_pk_bf16_f32 v82, v148, v149
    v_cvt_pk_bf16_f32 v83, v150, v151
    v_exp_f32 v152, v152
    v_exp_f32 v153, v153
    s_waitcnt vmcnt(17)
    v_mfma_f32_32x32x16_bf16 v[160:175], a[152:155], v[96:99], v[160:175]
    v_exp_f32 v154, v154
    v_exp_f32 v155, v155
    v_exp_f32 v156, v156
    v_exp_f32 v157, v157
    s_waitcnt vmcnt(16)
    v_mfma_f32_32x32x16_bf16 v[160:175], a[156:159], v[100:103], v[160:175]
    v_exp_f32 v158, v158
    v_exp_f32 v159, v159
    v_cvt_pk_bf16_f32 v84, v152, v153
    v_cvt_pk_bf16_f32 v85, v154, v155
    v_cvt_pk_bf16_f32 v86, v156, v157
    v_cvt_pk_bf16_f32 v87, v158, v159
    v_mfma_f32_32x32x16_bf16 v[144:159], a[68:71], v[200:203], 0
    v_exp_f32 v128, v128
    v_exp_f32 v129, v129
    v_exp_f32 v130, v130
    v_exp_f32 v131, v131
    s_waitcnt vmcnt(15)
    v_mfma_f32_32x32x16_bf16 v[160:175], a[144:147], v[64:67], v[160:175]
    v_exp_f32 v132, v132
    v_exp_f32 v133, v133
    v_exp_f32 v134, v134
    v_exp_f32 v135, v135
    s_waitcnt vmcnt(14)
    v_mfma_f32_32x32x16_bf16 v[160:175], a[148:151], v[68:71], v[160:175]
    v_cvt_pk_bf16_f32 v88, v128, v129
    v_cvt_pk_bf16_f32 v89, v130, v131
    v_cvt_pk_bf16_f32 v90, v132, v133
    v_cvt_pk_bf16_f32 v91, v134, v135
    v_exp_f32 v136, v136
    v_exp_f32 v137, v137
    s_waitcnt vmcnt(13)
    v_mfma_f32_32x32x16_bf16 v[160:175], a[136:139], v[72:75], v[160:175]
    v_exp_f32 v138, v138
    v_exp_f32 v139, v139
    v_exp_f32 v140, v140
    v_exp_f32 v141, v141
    s_waitcnt vmcnt(12)
    v_mfma_f32_32x32x16_bf16 v[160:175], a[140:143], v[76:79], v[160:175]
    v_exp_f32 v142, v142
    v_exp_f32 v143, v143
    v_cvt_pk_bf16_f32 v92, v136, v137
    v_cvt_pk_bf16_f32 v93, v138, v139
    v_cvt_pk_bf16_f32 v94, v140, v141
    v_cvt_pk_bf16_f32 v95, v142, v143
    v_mfma_f32_32x32x16_bf16 v[128:143], a[64:67], v[200:203], v[48:63]
    v_exp_f32 v144, v144
    v_exp_f32 v145, v145
    v_exp_f32 v146, v146
    v_exp_f32 v147, v147
    s_waitcnt vmcnt(11)
    v_mfma_f32_32x32x16_bf16 v[160:175], a[128:131], v[80:83], v[160:175]
    v_exp_f32 v148, v148
    v_exp_f32 v149, v149
    v_exp_f32 v150, v150
    v_exp_f32 v151, v151
    s_waitcnt vmcnt(10)
    v_mfma_f32_32x32x16_bf16 v[160:175], a[132:135], v[84:87], v[160:175]
    v_cvt_pk_bf16_f32 v96, v144, v145
    v_cvt_pk_bf16_f32 v97, v146, v147
    v_cvt_pk_bf16_f32 v98, v148, v149
    v_cvt_pk_bf16_f32 v99, v150, v151
    v_exp_f32 v152, v152
    v_exp_f32 v153, v153
    s_waitcnt vmcnt(9)
    v_mfma_f32_32x32x16_bf16 v[160:175], a[120:123], v[88:91], v[160:175]
    v_exp_f32 v154, v154
    v_exp_f32 v155, v155
    v_exp_f32 v156, v156
    v_exp_f32 v157, v157
    s_waitcnt vmcnt(8)
    v_mfma_f32_32x32x16_bf16 v[160:175], a[124:127], v[92:95], v[160:175]
    v_exp_f32 v158, v158
    v_exp_f32 v159, v159
    v_cvt_pk_bf16_f32 v100, v152, v153
    v_cvt_pk_bf16_f32 v101, v154, v155
    v_cvt_pk_bf16_f32 v102, v156, v157
    v_cvt_pk_bf16_f32 v103, v158, v159
    v_mfma_f32_32x32x16_bf16 v[144:159], a[92:95], v[204:207], 0
    v_exp_f32 v128, v128
    v_exp_f32 v129, v129
    v_exp_f32 v130, v130
    v_exp_f32 v131, v131
    s_waitcnt vmcnt(7)
    v_mfma_f32_32x32x16_bf16 v[160:175], a[112:115], v[96:99], v[160:175]
    v_exp_f32 v132, v132
    v_exp_f32 v133, v133
    v_exp_f32 v134, v134
    v_exp_f32 v135, v135
    s_waitcnt vmcnt(6)
    v_mfma_f32_32x32x16_bf16 v[160:175], a[116:119], v[100:103], v[160:175]
    v_cvt_pk_bf16_f32 v64, v128, v129
    v_cvt_pk_bf16_f32 v65, v130, v131
    v_cvt_pk_bf16_f32 v66, v132, v133
    v_cvt_pk_bf16_f32 v67, v134, v135
    v_exp_f32 v136, v136
    v_exp_f32 v137, v137
    s_waitcnt vmcnt(5)
    v_mfma_f32_32x32x16_bf16 v[160:175], a[104:107], v[64:67], v[160:175]
    v_exp_f32 v138, v138
    v_exp_f32 v139, v139
    v_exp_f32 v140, v140
    v_exp_f32 v141, v141
    v_exp_f32 v142, v142
    v_exp_f32 v143, v143
    v_cvt_pk_bf16_f32 v68, v136, v137
    v_cvt_pk_bf16_f32 v69, v138, v139
    v_cvt_pk_bf16_f32 v70, v140, v141
    v_cvt_pk_bf16_f32 v71, v142, v143
    v_mfma_f32_32x32x16_bf16 v[128:143], a[88:91], v[204:207], 0
    v_exp_f32 v144, v144
    v_exp_f32 v145, v145
    v_exp_f32 v146, v146
    v_exp_f32 v147, v147
    s_waitcnt vmcnt(4)
    v_mfma_f32_32x32x16_bf16 v[160:175], a[108:111], v[68:71], v[160:175]
    v_exp_f32 v148, v148
    v_exp_f32 v149, v149
    v_exp_f32 v150, v150
    v_exp_f32 v151, v151
    v_cvt_pk_bf16_f32 v72, v144, v145
    v_cvt_pk_bf16_f32 v73, v146, v147
    v_cvt_pk_bf16_f32 v74, v148, v149
    v_cvt_pk_bf16_f32 v75, v150, v151
    s_nop 3
    v_subrev_u32 v208, 0x2b800000, v168
    v_cmp_lt_u32 vcc, 0x28000000, v208
    s_nop 0
    s_cbranch_vccnz L_slow_10
L_att_9:
    v_rcp_f32 v168, v168
    s_nop 0
    v_mul_f32 v160, v168, v160
    v_mul_f32 v161, v168, v161
    v_cvt_pk_bf16_f32 v160, v160, v161
    v_mul_f32 v162, v168, v162
    v_mul_f32 v163, v168, v163
    v_cvt_pk_bf16_f32 v161, v162, v163
    v_mul_f32 v164, v168, v164
    v_mul_f32 v165, v168, v165
    v_cvt_pk_bf16_f32 v162, v164, v165
    v_mul_f32 v166, v168, v166
    v_mul_f32 v167, v168, v167
    v_cvt_pk_bf16_f32 v163, v166, v167
    buffer_store_dwordx4 v[160:163], v1, s[36:39], s72 offen sc1
    v_exp_f32 v152, v152
    v_exp_f32 v153, v153
    v_mfma_f32_32x32x16_bf16 v[176:191], a[160:163], v[72:75], v[176:191]
    v_exp_f32 v154, v154
    v_exp_f32 v155, v155
    v_exp_f32 v156, v156
    v_exp_f32 v157, v157
    v_exp_f32 v158, v158
    v_exp_f32 v159, v159
    v_cvt_pk_bf16_f32 v76, v152, v153
    v_cvt_pk_bf16_f32 v77, v154, v155
    v_cvt_pk_bf16_f32 v78, v156, v157
    v_cvt_pk_bf16_f32 v79, v158, v159
    v_mfma_f32_32x32x16_bf16 v[144:159], a[84:87], v[204:207], 0
    s_add_u32 m0, s53, 16384
    s_add_u32 s41, s88, 4096
    s_and_b32 s41, s41, 0x7000
    s_mul_i32 s41, s41, 56
    s_add_u32 s41, s41, s74
    buffer_load_dwordx4 v14, s[20:23], s41 offen lds
    v_exp_f32 v128, v128
    v_exp_f32 v129, v129
    v_exp_f32 v130, v130
    v_exp_f32 v131, v131
    v_mfma_f32_32x32x16_bf16 v[176:191], a[164:167], v[76:79], v[176:191]
    v_exp_f32 v132, v132
    v_exp_f32 v133, v133
    v_exp_f32 v134, v134
    v_exp_f32 v135, v135
    v_cvt_pk_bf16_f32 v80, v128, v129
    v_cvt_pk_bf16_f32 v81, v130, v131
    v_cvt_pk_bf16_f32 v82, v132, v133
    v_cvt_pk_bf16_f32 v83, v134, v135
    v_exp_f32 v136, v136
    v_exp_f32 v137, v137
    v_mfma_f32_32x32x16_bf16 v[176:191], a[152:155], v[80:83], v[176:191]
    buffer_load_dwordx4 v15, s[20:23], s41 offen offset:1024 lds
    v_exp_f32 v138, v138
    v_exp_f32 v139, v139
    v_exp_f32 v140, v140
    v_exp_f32 v141, v141
    v_exp_f32 v142, v142
    v_exp_f32 v143, v143
    v_cvt_pk_bf16_f32 v84, v136, v137
    v_cvt_pk_bf16_f32 v85, v138, v139
    v_cvt_pk_bf16_f32 v86, v140, v141
    v_cvt_pk_bf16_f32 v87, v142, v143
    v_mfma_f32_32x32x16_bf16 v[128:143], a[80:83], v[204:207], 0
    s_add_u32 m0, s53, 18432
    s_nop 0
    buffer_load_dwordx4 v14, s[24:27], s41 offen lds
    v_exp_f32 v144, v144
    v_exp_f32 v145, v145
    v_exp_f32 v146, v146
    v_exp_f32 v147, v147
    v_mfma_f32_32x32x16_bf16 v[176:191], a[156:159], v[84:87], v[176:191]
    v_exp_f32 v148, v148
    v_exp_f32 v149, v149
    v_exp_f32 v150, v150
    v_exp_f32 v151, v151
    v_cvt_pk_bf16_f32 v88, v144, v145
    v_cvt_pk_bf16_f32 v89, v146, v147
    v_cvt_pk_bf16_f32 v90, v148, v149
    v_cvt_pk_bf16_f32 v91, v150, v151
    v_exp_f32 v152, v152
    v_exp_f32 v153, v153
    v_mfma_f32_32x32x16_bf16 v[176:191], a[144:147], v[88:91], v[176:191]
    s_waitcnt vmcnt(3)
    s_cmp_lg_u32 s51, 0
    s_cbranch_scc1 L_rel_5
    buffer_store_dwordx2 v[124:125], v2, s[36:39], s73 offen
L_reld_6:
    v_exp_f32 v154, v154
    v_exp_f32 v155, v155
    v_exp_f32 v156, v156
    v_exp_f32 v157, v157
    v_exp_f32 v158, v158
    v_exp_f32 v159, v159
    v_cvt_pk_bf16_f32 v92, v152, v153
    v_cvt_pk_bf16_f32 v93, v154, v155
    v_cvt_pk_bf16_f32 v94, v156, v157
    v_cvt_pk_bf16_f32 v95, v158, v159
    v_mfma_f32_32x32x16_bf16 v[144:159], a[76:79], v[204:207], 0
    buffer_load_dwordx4 v15, s[24:27], s41 offen offset:1024 lds
    v_exp_f32 v128, v128
    v_exp_f32 v129, v129
    v_exp_f32 v130, v130
    v_exp_f32 v131, v131
    v_mfma_f32_32x32x16_bf16 v[176:191], a[148:151], v[92:95], v[176:191]
    v_exp_f32 v132, v132
    v_exp_f32 v133, v133
    v_exp_f32 v134, v134
    v_exp_f32 v135, v135
    v_cvt_pk_bf16_f32 v96, v128, v129
    v_cvt_pk_bf16_f32 v97, v130, v131
    v_cvt_pk_bf16_f32 v98, v132, v133
    v_cvt_pk_bf16_f32 v99, v134, v135
    v_exp_f32 v136, v136
    v_exp_f32 v137, v137
    v_mfma_f32_32x32x16_bf16 v[176:191], a[136:139], v[96:99], v[176:191]
    v_exp_f32 v138, v138
    v_exp_f32 v139, v139
    v_exp_f32 v140, v140
    v_exp_f32 v141, v141
    v_exp_f32 v142, v142
    v_exp_f32 v143, v143
    v_cvt_pk_bf16_f32 v100, v136, v137
    v_cvt_pk_bf16_f32 v101, v138, v139
    v_cvt_pk_bf16_f32 v102, v140, v141
    v_cvt_pk_bf16_f32 v103, v142, v143
    v_mfma_f32_32x32x16_bf16 v[128:143], a[72:75], v[204:207], 0
    buffer_load_dwordx2 v[22:23], v16, s[36:39], s77 offen sc1
    v_exp_f32 v144, v144
    v_exp_f32 v145, v145
    v_exp_f32 v146, v146
    v_exp_f32 v147, v147
    v_mfma_f32_32x32x16_bf16 v[176:191], a[140:143], v[100:103], v[176:191]
    v_exp_f32 v148, v148
    v_exp_f32 v149, v149
    v_exp_f32 v150, v150
    v_exp_f32 v151, v151
    v_cvt_pk_bf16_f32 v64, v144, v145
    v_cvt_pk_bf16_f32 v65, v146, v147
    v_cvt_pk_bf16_f32 v66, v148, v149
    v_cvt_pk_bf16_f32 v67, v150, v151
    v_exp_f32 v152, v152
    v_exp_f32 v153, v153
    v_mfma_f32_32x32x16_bf16 v[176:191], a[128:131], v[64:67], v[176:191]
    v_exp_f32 v154, v154
    v_exp_f32 v155, v155
    v_exp_f32 v156, v156
    v_exp_f32 v157, v157
    v_exp_f32 v158, v158
    v_exp_f32 v159, v159
    v_cvt_pk_bf16_f32 v68, v152, v153
    v_cvt_pk_bf16_f32 v69, v154, v155
    v_cvt_pk_bf16_f32 v70, v156, v157
    v_cvt_pk_bf16_f32 v71, v158, v159
    v_mfma_f32_32x32x16_bf16 v[144:159], a[68:71], v[204:207], v[48:63]
    v_exp_f32 v128, v128
    v_exp_f32 v129, v129
    v_exp_f32 v130, v130
    v_exp_f32 v131, v131
    v_mfma_f32_32x32x16_bf16 v[176:191], a[132:135], v[68:71], v[176:191]
    v_exp_f32 v132, v132
    v_exp_f32 v133, v133
    v_exp_f32 v134, v134
    v_exp_f32 v135, v135
    v_cvt_pk_bf16_f32 v72, v128, v129
    v_cvt_pk_bf16_f32 v73, v130, v131
    v_cvt_pk_bf16_f32 v74, v132, v133
    v_cvt_pk_bf16_f32 v75, v134, v135
    v_exp_f32 v136, v136
    v_exp_f32 v137, v137
    v_mfma_f32_32x32x16_bf16 v[176:191], a[120:123], v[72:75], v[176:191]
    s_waitcnt vmcnt(0)
    v_cmp_ne_u64 vcc, s[46:47], v[22:23]
    s_nop 0
    s_cbranch_vccz L_ok_7
L_spin_8:
    buffer_load_dwordx2 v[22:23], v16, s[36:39], s77 offen sc1
    s_sub_u32 s52, s52, 1
    s_cbranch_scc1 L_abort
    s_waitcnt vmcnt(0)
    v_cmp_ne_u64 vcc, s[46:47], v[22:23]
    s_nop 0
    s_cbranch_vccnz L_spin_8
L_ok_7:
    s_add_u32 m0, s53, 131072
    s_nop 0
    buffer_load_dwordx4 v1, s[36:39], s79 offen sc1 lds
    buffer_load_dwordx4 v1, s[36:39], s79 offen offset:1024 sc1 lds
    v_exp_f32 v138, v138
    v_exp_f32 v139, v139
    v_exp_f32 v140, v140
    v_exp_f32 v141, v141
    v_exp_f32 v142, v142
    v_exp_f32 v143, v143
    v_cvt_pk_bf16_f32 v76, v136, v137
    v_cvt_pk_bf16_f32 v77, v138, v139
    v_cvt_pk_bf16_f32 v78, v140, v141
    v_cvt_pk_bf16_f32 v79, v142, v143
    v_exp_f32 v144, v144
    v_exp_f32 v145, v145
    v_exp_f32 v146, v146
    v_exp_f32 v147, v147
    v_mfma_f32_32x32x16_bf16 v[176:191], a[124:127], v[76:79], v[176:191]
    buffer_load_dwordx4 v1, s[36:39], s79 offen offset:2048 sc1 lds
    buffer_load_dwordx4 v1, s[36:39], s79 offen offset:3072 sc1 lds
    v_exp_f32 v148, v148
    v_exp_f32 v149, v149
    v_exp_f32 v150, v150
    v_exp_f32 v151, v151
    v_cvt_pk_bf16_f32 v80, v144, v145
    v_cvt_pk_bf16_f32 v81, v146, v147
    v_cvt_pk_bf16_f32 v82, v148, v149
    v_cvt_pk_bf16_f32 v83, v150, v151
    v_exp_f32 v152, v152
    v_exp_f32 v153, v153
    v_mfma_f32_32x32x16_bf16 v[176:191], a[112:115], v[80:83], v[176:191]
    s_add_u32 m0, s53, 147456
    s_add_u32 s79, s79, 16384
    buffer_load_dwordx4 v1, s[36:39], s79 offen sc1 lds
    buffer_load_dwordx4 v1, s[36:39], s79 offen offset:1024 sc1 lds
    v_exp_f32 v154, v154
    v_exp_f32 v155, v155
    v_exp_f32 v156, v156
    v_exp_f32 v157, v157
    v_exp_f32 v158, v158
    v_exp_f32 v159, v159
    v_cvt_pk_bf16_f32 v84, v152, v153
    v_cvt_pk_bf16_f32 v85, v154, v155
    v_cvt_pk_bf16_f32 v86, v156, v157
    v_cvt_pk_bf16_f32 v87, v158, v159
    s_nop 1
    v_mfma_f32_32x32x16_bf16 v[176:191], a[116:119], v[84:87], v[176:191]
    buffer_load_dwordx4 v1, s[36:39], s79 offen offset:2048 sc1 lds
    buffer_load_dwordx4 v1, s[36:39], s79 offen offset:3072 sc1 lds
    s_add_u32 s55, s72, 32768
    s_nop 8
    v_subrev_u32 v208, 0x2b800000, v184
    v_cmp_lt_u32 vcc, 0x28000000, v208
    s_nop 0
    s_cbranch_vccnz L_slow_28
L_att_27:
    v_rcp_f32 v184, v184
    s_nop 0
    v_mul_f32 v176, v184, v176
    v_mul_f32 v177, v184, v177
    v_cvt_pk_bf16_f32 v176, v176, v177
    v_mul_f32 v178, v184, v178
    v_mul_f32 v179, v184, v179
    v_cvt_pk_bf16_f32 v177, v178, v179
    v_mul_f32 v180, v184, v180
    v_mul_f32 v181, v184, v181
    v_cvt_pk_bf16_f32 v178, v180, v181
    v_mul_f32 v182, v184, v182
    v_mul_f32 v183, v184, v183
    v_cvt_pk_bf16_f32 v179, v182, v183
    buffer_store_dwordx4 v[176:179], v1, s[36:39], s55 offen sc1
    ds_read_b64_tr_b16 a[128:129], v12 offset:32768
    ds_read_b64_tr_b16 a[130:131], v12 offset:33280
    ds_read_b64_tr_b16 a[132:133], v12 offset:36864
    ds_read_b64_tr_b16 a[134:135], v12 offset:37376
    s_add_u32 m0, s53, 32768
    s_add_u32 s41, s88, 8192
    s_and_b32 s41, s41, 0x7000
    s_mul_i32 s41, s41, 56
    s_add_u32 s41, s41, s74
    buffer_load_dwordx4 v14, s[20:23], s41 offen lds
    ds_read_b64_tr_b16 a[136:137], v12 offset:40960
    ds_read_b64_tr_b16 a[138:139], v12 offset:41472
    ds_read_b64_tr_b16 a[140:141], v12 offset:45056
    ds_read_b64_tr_b16 a[142:143], v12 offset:45568
    ds_read_b64_tr_b16 a[144:145], v12 offset:49152
    ds_read_b64_tr_b16 a[146:147], v12 offset:49664
    ds_read_b64_tr_b16 a[148:149], v12 offset:53248
    ds_read_b64_tr_b16 a[150:151], v12 offset:53760
    buffer_load_dwordx4 v15, s[20:23], s41 offen offset:1024 lds
    ds_read_b64_tr_b16 a[152:153], v12 offset:57344
    ds_read_b64_tr_b16 a[154:155], v12 offset:57856
    ds_read_b64_tr_b16 a[156:157], v12 offset:61440
    ds_read_b64_tr_b16 a[158:159], v12 offset:61952
    ds_read_b64_tr_b16 a[160:161], v12 offset:0
    ds_read_b64_tr_b16 a[162:163], v12 offset:512
    ds_read_b64_tr_b16 a[164:165], v12 offset:4096
    ds_read_b64_tr_b16 a[166:167], v12 offset:4608
    s_add_u32 m0, s53, 34816
    s_nop 0
    buffer_load_dwordx4 v14, s[24:27], s41 offen lds
    ds_read_b64_tr_b16 a[168:169], v12 offset:8192
    ds_read_b64_tr_b16 a[170:171], v12 offset:8704
    ds_read_b64_tr_b16 a[172:173], v12 offset:12288
    ds_read_b64_tr_b16 a[174:175], v12 offset:12800
    ds_read_b64_tr_b16 a[176:177], v12 offset:16384
    ds_read_b64_tr_b16 a[178:179], v12 offset:16896
    ds_read_b64_tr_b16 a[180:181], v12 offset:20480
    ds_read_b64_tr_b16 a[182:183], v12 offset:20992
    buffer_load_dwordx4 v15, s[24:27], s41 offen offset:1024 lds
    ds_read_b64_tr_b16 a[184:185], v12 offset:24576
    ds_read_b64_tr_b16 a[186:187], v12 offset:25088
    ds_read_b64_tr_b16 a[188:189], v12 offset:28672
    ds_read_b64_tr_b16 a[190:191], v12 offset:29184
    s_waitcnt vmcnt(9)
    s_barrier
    ds_read_b128 v[128:131], v211 offset:0
    ds_read_b128 v[132:135], v211 offset:256
    ds_read_b128 v[136:139], v211 offset:2048
    ds_read_b128 v[140:143], v211 offset:2304
    ds_read_b128 v[144:147], v211 offset:4096
    ds_read_b128 v[148:151], v211 offset:4352
    ds_read_b128 v[152:155], v211 offset:6144
    ds_read_b128 v[156:159], v211 offset:6400
    s_waitcnt lgkmcnt(7)
    v_mfma_f32_16x16x32_bf16 v[112:115], a[128:131], v[128:131], v[112:115]
    ds_read_b128 v[160:163], v211 offset:8192
    s_waitcnt lgkmcnt(7)
    v_mfma_f32_16x16x32_bf16 v[116:119], a[128:131], v[132:135], v[116:119]
    ds_read_b128 v[164:167], v211 offset:8448
    s_waitcnt lgkmcnt(7)
    v_mfma_f32_16x16x32_bf16 v[112:115], a[132:135], v[136:139], v[112:115]
    ds_read_b128 v[168:171], v211 offset:10240
    s_waitcnt lgkmcnt(7)
    v_mfma_f32_16x16x32_bf16 v[116:119], a[132:135], v[140:143], v[116:119]
    ds_read_b128 v[172:175], v211 offset:10496
    s_waitcnt lgkmcnt(7)
    v_mfma_f32_16x16x32_bf16 v[112:115], a[136:139], v[144:147], v[112:115]
    ds_read_b128 v[176:179], v211 offset:12288
    s_waitcnt lgkmcnt(7)
    v_mfma_f32_16x16x32_bf16 v[116:119], a[136:139], v[148:151], v[116:119]
    ds_read_b128 v[180:183], v211 offset:12544
    s_waitcnt lgkmcnt(7)
    v_mfma_f32_16x16x32_bf16 v[112:115], a[140:143], v[152:155], v[112:115]
    ds_read_b128 v[184:187], v211 offset:14336
    s_waitcnt lgkmcnt(7)
    v_mfma_f32_16x16x32_bf16 v[116:119], a[140:143], v[156:159], v[116:119]
    ds_read_b128 v[188:191], v211 offset:14592
    s_waitcnt lgkmcnt(7)
    v_mfma_f32_16x16x32_bf16 v[112:115], a[144:147], v[160:163], v[112:115]
    s_waitcnt vmcnt(5)
    s_barrier
    ds_read_b128 v[128:131], v211 offset:16384
    s_waitcnt vmcnt(4)
    s_cmp_lg_u32 s51, 0
    s_cbranch_scc1 L_rel_43
    buffer_store_dwordx2 v[124:125], v2, s[36:39], s73 offen offset:256
L_reld_44:
    s_waitcnt lgkmcnt(6)
    v_mfma_f32_16x16x32_bf16 v[116:119], a[144:147], v[164:167], v[116:119]
    ds_read_b128 v[132:135], v211 offset:16640
    v_mfma_f32_16x16x32_bf16 v[112:115], a[148:151], v[168:171], v[112:115]
    ds_read_b128 v[136:139], v211 offset:18432
    s_waitcnt lgkmcnt(6)
    v_mfma_f32_16x16x32_bf16 v[116:119], a[148:151], v[172:175], v[116:119]
    ds_read_b128 v[140:143], v211 offset:18688
    v_mfma_f32_16x16x32_bf16 v[112:115], a[152:155], v[176:179], v[112:115]
    ds_read_b128 v[144:147], v211 offset:20480
    s_waitcnt lgkmcnt(6)
    v_mfma_f32_16x16x32_bf16 v[116:119], a[152:155], v[180:183], v[116:119]
    ds_read_b128 v[148:151], v211 offset:20736
    v_mfma_f32_16x16x32_bf16 v[112:115], a[156:159], v[184:187], v[112:115]
    ds_read_b128 v[152:155], v211 offset:22528
    s_waitcnt lgkmcnt(7)
    v_mfma_f32_16x16x32_bf16 v[116:119], a[156:159], v[188:191], v[116:119]
    ds_read_b128 v[156:159], v211 offset:22784
    s_waitcnt lgkmcnt(7)
    v_mfma_f32_16x16x32_bf16 v[112:115], a[160:163], v[128:131], v[112:115]
    ds_read_b128 v[160:163], v211 offset:24576
    s_waitcnt lgkmcnt(7)
    v_mfma_f32_16x16x32_bf16 v[116:119], a[160:163], v[132:135], v[116:119]
    ds_read_b128 v[164:167], v211 offset:24832
    s_waitcnt lgkmcnt(7)
    v_mfma_f32_16x16x32_bf16 v[112:115], a[164:167], v[136:139], v[112:115]
    ds_read_b128 v[168:171], v211 offset:26624
    s_waitcnt lgkmcnt(7)
    v_mfma_f32_16x16x32_bf16 v[116:119], a[164:167], v[140:143], v[116:119]
    ds_read_b128 v[172:175], v211 offset:26880
    s_waitcnt lgkmcnt(7)
    v_mfma_f32_16x16x32_bf16 v[112:115], a[168:171], v[144:147], v[112:115]
    ds_read_b128 v[176:179], v211 offset:28672
    s_waitcnt lgkmcnt(7)
    v_mfma_f32_16x16x32_bf16 v[116:119], a[168:171], v[148:151], v[116:119]
    ds_read_b128 v[180:183], v211 offset:28928
    s_waitcnt lgkmcnt(7)
    v_mfma_f32_16x16x32_bf16 v[112:115], a[172:175], v[152:155], v[112:115]
    ds_read_b128 v[184:187], v211 offset:30720
    s_waitcnt lgkmcnt(7)
    v_mfma_f32_16x16x32_bf16 v[116:119], a[172:175], v[156:159], v[116:119]
    ds_read_b128 v[188:191], v211 offset:30976
    s_waitcnt lgkmcnt(7)
    v_mfma_f32_16x16x32_bf16 v[112:115], a[176:179], v[160:163], v[112:115]
    s_waitcnt lgkmcnt(6)
    v_mfma_f32_16x16x32_bf16 v[116:119], a[176:179], v[164:167], v[116:119]
    s_waitcnt lgkmcnt(5)
    v_mfma_f32_16x16x32_bf16 v[112:115], a[180:183], v[168:171], v[112:115]
    s_waitcnt lgkmcnt(4)
    v_mfma_f32_16x16x32_bf16 v[116:119], a[180:183], v[172:175], v[116:119]
    s_waitcnt lgkmcnt(3)
    v_mfma_f32_16x16x32_bf16 v[112:115], a[184:187], v[176:179], v[112:115]
    s_waitcnt lgkmcnt(2)
    v_mfma_f32_16x16x32_bf16 v[116:119], a[184:187], v[180:183], v[116:119]
    s_waitcnt lgkmcnt(1)
    v_mfma_f32_16x16x32_bf16 v[112:115], a[188:191], v[184:187], v[112:115]
    s_waitcnt lgkmcnt(0)
    v_mfma_f32_16x16x32_bf16 v[116:119], a[188:191], v[188:191], v[116:119]
    buffer_load_dwordx2 v[22:23], v16, s[36:39], s77 offen offset:256 sc1
    s_add_u32 s54, s72, 2097152
    s_nop 3
    v_cvt_pk_bf16_f32 v24, v112, v113
    v_cvt_pk_bf16_f32 v25, v114, v115
    v_cvt_pk_bf16_f32 v26, v116, v117
    v_cvt_pk_bf16_f32 v27, v118, v119
    s_nop 0
    v_permlane16_swap_b32 v24, v26
    v_permlane16_swap_b32 v25, v27
    buffer_store_dwordx4 v[24:27], v1, s[36:39], s54 offen sc1
    s_waitcnt vmcnt(1)
    v_cmp_ne_u64 vcc, s[46:47], v[22:23]
    s_nop 0
    s_cbranch_vccz L_ok_45
L_spin_46:
    buffer_load_dwordx2 v[22:23], v16, s[36:39], s77 offen offset:256 sc1
    s_sub_u32 s52, s52, 1
    s_cbranch_scc1 L_abort
    s_waitcnt vmcnt(0)
    v_cmp_ne_u64 vcc, s[46:47], v[22:23]
    s_nop 0
    s_cbranch_vccnz L_spin_46
L_ok_45:
    s_add_u32 m0, s53, 98304
    s_add_u32 s79, s79, 16384
    buffer_load_dwordx4 v1, s[36:39], s79 offen sc1 lds
    buffer_load_dwordx4 v1, s[36:39], s79 offen offset:1024 sc1 lds
    buffer_load_dwordx4 v1, s[36:39], s79 offen offset:2048 sc1 lds
    buffer_load_dwordx4 v1, s[36:39], s79 offen offset:3072 sc1 lds
    v_lshlrev_b32 v104, 16, v28
    v_and_b32 v105, 0xffff0000, v28
    v_lshlrev_b32 v106, 16, v29
    s_add_u32 m0, s53, 114688
    s_add_u32 s79, s79, 16384
    buffer_load_dwordx4 v1, s[36:39], s79 offen sc1 lds
    v_and_b32 v107, 0xffff0000, v29
    v_lshlrev_b32 v108, 16, v30
    v_and_b32 v109, 0xffff0000, v30
    v_lshlrev_b32 v110, 16, v31
    v_and_b32 v111, 0xffff0000, v31
    buffer_load_dwordx4 v1, s[36:39], s79 offen offset:1024 sc1 lds
    v_mov_b32 v10, v214
    v_xor_b32 v11, 0x800, v214
    v_xor_b32 v12, 64, v214
    v_xor_b32 v13, 0x840, v214
    v_and_b32 v19, 31, v0
    buffer_load_dwordx4 v1, s[36:39], s79 offen offset:2048 sc1 lds
    v_lshlrev_b32 v5, 10, v19
    v_lshrrev_b32 v4, 5, v0
    v_lshl_add_u32 v5, v4, 4, v5
    v_lshlrev_b32 v19, 3, v19
    v_min_u32 v16, 6, v0
    buffer_load_dwordx4 v1, s[36:39], s79 offen offset:3072 sc1 lds
    s_mul_i32 s54, s43, 7
    v_add_lshl_u32 v16, s54, v16, 3
    s_waitcnt vmcnt(8)
    s_cmp_lg_u32 s51, 0
    s_cbranch_scc1 L_rel_47
    buffer_store_dwordx2 v[124:125], v2, s[36:39], s73 offen offset:512
L_reld_48:
    s_waitcnt vmcnt(5)
    s_barrier
    ds_read_b128 v[128:131], v210 offset:0
    ds_read_b128 v[132:135], v210 offset:256
    ds_read_b128 v[136:139], v210 offset:2048
    ds_read_b128 v[140:143], v210 offset:2304
    ds_read_b128 v[144:147], v210 offset:4096
    ds_read_b128 v[148:151], v210 offset:4352
    ds_read_b128 v[152:155], v210 offset:6144
    ds_read_b128 v[156:159], v210 offset:6400
    s_waitcnt lgkmcnt(7)
    v_mfma_f32_16x16x32_bf16 v[104:107], a[128:131], v[128:131], v[104:107]
    ds_read_b128 v[160:163], v210 offset:8192
    s_waitcnt lgkmcnt(7)
    v_mfma_f32_16x16x32_bf16 v[108:111], a[128:131], v[132:135], v[108:111]
    ds_read_b128 v[164:167], v210 offset:8448
    s_waitcnt lgkmcnt(7)
    v_mfma_f32_16x16x32_bf16 v[104:107], a[132:135], v[136:139], v[104:107]
    ds_read_b128 v[168:171], v210 offset:10240
    s_waitcnt lgkmcnt(7)
    buffer_load_dwordx2 v[22:23], v19, s[36:39], s78 offen offset:512 sc1
    v_mfma_f32_16x16x32_bf16 v[108:111], a[132:135], v[140:143], v[108:111]
    ds_read_b128 v[172:175], v210 offset:10496
    s_waitcnt lgkmcnt(7)
    v_mfma_f32_16x16x32_bf16 v[104:107], a[136:139], v[144:147], v[104:107]
    ds_read_b128 v[176:179], v210 offset:12288
    s_waitcnt lgkmcnt(7)
    v_mfma_f32_16x16x32_bf16 v[108:111], a[136:139], v[148:151], v[108:111]
    ds_read_b128 v[180:183], v210 offset:12544
    s_waitcnt lgkmcnt(7)
    v_mfma_f32_16x16x32_bf16 v[104:107], a[140:143], v[152:155], v[104:107]
    ds_read_b128 v[184:187], v210 offset:14336
    s_waitcnt lgkmcnt(7)
    v_mfma_f32_16x16x32_bf16 v[108:111], a[140:143], v[156:159], v[108:111]
    ds_read_b128 v[188:191], v210 offset:14592
    s_waitcnt lgkmcnt(7)
    v_mfma_f32_16x16x32_bf16 v[104:107], a[144:147], v[160:163], v[104:107]
    s_waitcnt vmcnt(2)
    s_barrier
    ds_read_b128 v[128:131], v210 offset:16384
    s_waitcnt lgkmcnt(7)
    v_mfma_f32_16x16x32_bf16 v[108:111], a[144:147], v[164:167], v[108:111]
    ds_read_b128 v[132:135], v210 offset:16640
    s_waitcnt lgkmcnt(7)
    v_mfma_f32_16x16x32_bf16 v[104:107], a[148:151], v[168:171], v[104:107]
    ds_read_b128 v[136:139], v210 offset:18432
    s_waitcnt lgkmcnt(7)
    v_mfma_f32_16x16x32_bf16 v[108:111], a[148:151], v[172:175], v[108:111]
    ds_read_b128 v[140:143], v210 offset:18688
    s_waitcnt lgkmcnt(7)
    v_mfma_f32_16x16x32_bf16 v[104:107], a[152:155], v[176:179], v[104:107]
    ds_read_b128 v[144:147], v210 offset:20480
    s_waitcnt lgkmcnt(7)
    v_mfma_f32_16x16x32_bf16 v[108:111], a[152:155], v[180:183], v[108:111]
    ds_read_b128 v[148:151], v210 offset:20736
    s_waitcnt lgkmcnt(7)
    v_mfma_f32_16x16x32_bf16 v[104:107], a[156:159], v[184:187], v[104:107]
    ds_read_b128 v[152:155], v210 offset:22528
    s_waitcnt lgkmcnt(7)
    v_mfma_f32_16x16x32_bf16 v[108:111], a[156:159], v[188:191], v[108:111]
    ds_read_b128 v[156:159], v210 offset:22784
    s_waitcnt lgkmcnt(7)
    v_mfma_f32_16x16x32_bf16 v[104:107], a[160:163], v[128:131], v[104:107]
    ds_read_b128 v[160:163], v210 offset:24576
    s_waitcnt vmcnt(0)
    v_cmp_ne_u64 vcc, s[46:47], v[22:23]
    s_nop 0
    s_cbranch_vccz L_ok_49
L_spin_50:
    buffer_load_dwordx2 v[22:23], v19, s[36:39], s78 offen offset:512 sc1
    s_sub_u32 s52, s52, 1
    s_cbranch_scc1 L_abort
    s_waitcnt vmcnt(0)
    v_cmp_ne_u64 vcc, s[46:47], v[22:23]
    s_nop 0
    s_cbranch_vccnz L_spin_50
L_ok_49:
    s_waitcnt lgkmcnt(6)
    v_mfma_f32_16x16x32_bf16 v[108:111], a[160:163], v[132:135], v[108:111]
    ds_read_b128 v[164:167], v210 offset:24832
    s_add_u32 s90, s88, 0
    s_and_b32 s90, s90, 0x7000
    s_add_u32 s90, s90, s3
    buffer_load_dwordx4 v[64:67], v1, s[36:39], s90 offen sc1
    v_mfma_f32_16x16x32_bf16 v[104:107], a[164:167], v[136:139], v[104:107]
    ds_read_b128 v[168:171], v210 offset:26624
    s_waitcnt lgkmcnt(6)
    v_mfma_f32_16x16x32_bf16 v[108:111], a[164:167], v[140:143], v[108:111]
    ds_read_b128 v[172:175], v210 offset:26880
    buffer_load_dwordx4 v[68:71], v1, s[36:39], s90 offen offset:1024 sc1
    v_mfma_f32_16x16x32_bf16 v[104:107], a[168:171], v[144:147], v[104:107]
    ds_read_b128 v[176:179], v210 offset:28672
    s_waitcnt lgkmcnt(6)
    v_mfma_f32_16x16x32_bf16 v[108:111], a[168:171], v[148:151], v[108:111]
    ds_read_b128 v[180:183], v210 offset:28928
    buffer_load_dwordx4 v[72:75], v1, s[36:39], s90 offen offset:2048 sc1
    v_mfma_f32_16x16x32_bf16 v[104:107], a[172:175], v[152:155], v[104:107]
    ds_read_b128 v[184:187], v210 offset:30720
    s_waitcnt lgkmcnt(6)
    v_mfma_f32_16x16x32_bf16 v[108:111], a[172:175], v[156:159], v[108:111]
    ds_read_b128 v[188:191], v210 offset:30976
    buffer_load_dwordx4 v[76:79], v1, s[36:39], s90 offen offset:3072 sc1
    v_mfma_f32_16x16x32_bf16 v[104:107], a[176:179], v[160:163], v[104:107]
    s_waitcnt lgkmcnt(5)
    v_mfma_f32_16x16x32_bf16 v[108:111], a[176:179], v[164:167], v[108:111]
    s_add_u32 s90, s88, 4096
    s_and_b32 s90, s90, 0x7000
    s_add_u32 s90, s90, s3
    buffer_load_dwordx4 v[80:83], v1, s[36:39], s90 offen sc1
    v_mfma_f32_16x16x32_bf16 v[104:107], a[180:183], v[168:171], v[104:107]
    s_waitcnt lgkmcnt(3)
    v_mfma_f32_16x16x32_bf16 v[108:111], a[180:183], v[172:175], v[108:111]
    buffer_load_dwordx4 v[84:87], v1, s[36:39], s90 offen offset:1024 sc1
    v_mfma_f32_16x16x32_bf16 v[104:107], a[184:187], v[176:179], v[104:107]
    s_waitcnt lgkmcnt(1)
    v_mfma_f32_16x16x32_bf16 v[108:111], a[184:187], v[180:183], v[108:111]
    buffer_load_dwordx4 v[88:91], v1, s[36:39], s90 offen offset:2048 sc1
    v_mfma_f32_16x16x32_bf16 v[104:107], a[188:191], v[184:187], v[104:107]
    s_waitcnt lgkmcnt(0)
    v_mfma_f32_16x16x32_bf16 v[108:111], a[188:191], v[188:191], v[108:111]
    buffer_load_dwordx4 v[92:95], v1, s[36:39], s90 offen offset:3072 sc1
    s_add_u32 s54, s72, 2129920
    s_nop 3
    v_cvt_pk_bf16_f32 v28, v104, v105
    v_cvt_pk_bf16_f32 v29, v106, v107
    v_cvt_pk_bf16_f32 v30, v108, v109
    v_cvt_pk_bf16_f32 v31, v110, v111
    s_nop 0
    v_permlane16_swap_b32 v28, v30
    v_permlane16_swap_b32 v29, v31
    buffer_store_dwordx4 v[28:31], v1, s[36:39], s54 offen sc1
    s_cmp_ge_u32 s45, 28
    s_cbranch_scc1 L_spare
    s_barrier
    ds_read_b64_tr_b16 v[32:33], v10 offset:0
    ds_read_b64_tr_b16 v[34:35], v10 offset:512
    ds_read_b64_tr_b16 v[36:37], v11 offset:0
    ds_read_b64_tr_b16 v[38:39], v11 offset:512
    ds_read_b64_tr_b16 v[40:41], v12 offset:0
    ds_read_b64_tr_b16 v[42:43], v12 offset:512
    ds_read_b64_tr_b16 v[44:45], v13 offset:0
    ds_read_b64_tr_b16 v[46:47], v13 offset:512
    s_waitcnt vmcnt(8) lgkmcnt(6)
    v_mfma_f32_32x32x16_bf16 v[128:143], v[32:35], v[64:67], 0
    ds_read_b64_tr_b16 v[48:49], v10 offset:4096
    s_add_u32 s90, s88, 8192
    s_and_b32 s90, s90, 0x7000
    ds_read_b64_tr_b16 v[50:51], v10 offset:4608
    s_add_u32 s90, s90, s3
    ds_read_b64_tr_b16 v[52:53], v11 offset:4096
    buffer_load_dwordx4 v[96:99], v1, s[36:39], s90 offen sc1
    v_mfma_f32_16x16x32_bf16 v[116:119], v[120:123], v[32:35], 0
    ds_read_b64_tr_b16 v[54:55], v11 offset:4608
    s_waitcnt lgkmcnt(8)
    v_mfma_f32_32x32x16_bf16 v[144:159], v[36:39], v[64:67], 0
    ds_read_b64_tr_b16 v[56:57], v12 offset:4096
    s_add_u32 m0, s53, 49152
    s_add_u32 s41, s88, 12288
    s_and_b32 s41, s41, 0x7000
    s_mul_i32 s41, s41, 56
    s_add_u32 s41, s41, s74
    buffer_load_dwordx4 v14, s[20:23], s41 offen lds
    s_waitcnt lgkmcnt(7)
    v_mfma_f32_32x32x16_bf16 v[160:175], v[40:43], v[64:67], 0
    ds_read_b64_tr_b16 v[58:59], v12 offset:4608
    s_waitcnt lgkmcnt(6)
    ds_read_b64_tr_b16 v[60:61], v13 offset:4096
    ds_read_b64_tr_b16 v[62:63], v13 offset:4608
    v_mfma_f32_32x32x16_bf16 v[176:191], v[44:47], v[64:67], 0
    buffer_load_dwordx4 v[100:103], v1, s[36:39], s90 offen offset:1024 sc1
    s_waitcnt vmcnt(10) lgkmcnt(5)
    v_mfma_f32_32x32x16_bf16 v[128:143], v[48:51], v[68:71], v[128:143]
    ds_read_b64_tr_b16 v[32:33], v10 offset:8192
    ds_read_b64_tr_b16 v[34:35], v10 offset:8704
    buffer_load_dwordx4 v[104:107], v1, s[36:39], s90 offen offset:2048 sc1
    ds_read_b64_tr_b16 v[36:37], v11 offset:8192
    v_mfma_f32_16x16x32_bf16 v[116:119], v[120:123], v[48:51], v[116:119]
    ds_read_b64_tr_b16 v[38:39], v11 offset:8704
    s_waitcnt lgkmcnt(7)
    v_mfma_f32_32x32x16_bf16 v[144:159], v[52:55], v[68:71], v[144:159]
    ds_read_b64_tr_b16 v[40:41], v12 offset:8192
    s_waitcnt lgkmcnt(7)
    ds_read_b64_tr_b16 v[42:43], v12 offset:8704
    buffer_load_dwordx4 v15, s[20:23], s41 offen offset:1024 lds
    ds_read_b64_tr_b16 v[44:45], v13 offset:8192
    v_mfma_f32_32x32x16_bf16 v[160:175], v[56:59], v[68:71], v[160:175]
    ds_read_b64_tr_b16 v[46:47], v13 offset:8704
    s_waitcnt lgkmcnt(8)
    v_mfma_f32_32x32x16_bf16 v[176:191], v[60:63], v[68:71], v[176:191]
    buffer_load_dwordx4 v[108:111], v1, s[36:39], s90 offen offset:3072 sc1
    s_waitcnt vmcnt(12) lgkmcnt(5)
    v_mfma_f32_32x32x16_bf16 v[128:143], v[32:35], v[72:75], v[128:143]
    ds_read_b64_tr_b16 v[48:49], v10 offset:12288
    s_add_u32 s90, s88, 12288
    s_and_b32 s90, s90, 0x7000
    ds_read_b64_tr_b16 v[50:51], v10 offset:12800
    s_add_u32 s90, s90, s3
    ds_read_b64_tr_b16 v[52:53], v11 offset:12288
    buffer_load_dwordx4 v[112:115], v1, s[36:39], s90 offen sc1
    v_mfma_f32_16x16x32_bf16 v[116:119], v[120:123], v[32:35], v[116:119]
    ds_read_b64_tr_b16 v[54:55], v11 offset:12800
    s_waitcnt lgkmcnt(6)
    v_mfma_f32_32x32x16_bf16 v[144:159], v[36:39], v[72:75], v[144:159]
    ds_read_b64_tr_b16 v[56:57], v12 offset:12288
    s_add_u32 m0, s53, 51200
    ds_read_b64_tr_b16 v[58:59], v12 offset:12800
    buffer_load_dwordx4 v14, s[24:27], s41 offen lds
    ds_read_b64_tr_b16 v[60:61], v13 offset:12288
    v_mfma_f32_32x32x16_bf16 v[160:175], v[40:43], v[72:75], v[160:175]
    ds_read_b64_tr_b16 v[62:63], v13 offset:12800
    s_waitcnt lgkmcnt(8)
    v_mfma_f32_32x32x16_bf16 v[176:191], v[44:47], v[72:75], v[176:191]
    buffer_load_dwordx4 v[64:67], v1, s[36:39], s90 offen offset:1024 sc1
    s_waitcnt vmcnt(14) lgkmcnt(5)
    v_mfma_f32_32x32x16_bf16 v[128:143], v[48:51], v[76:79], v[128:143]
    ds_read_b64_tr_b16 v[32:33], v10 offset:16384
    ds_read_b64_tr_b16 v[34:35], v10 offset:16896
    ds_read_b64_tr_b16 v[36:37], v11 offset:16384
    v_mfma_f32_16x16x32_bf16 v[116:119], v[120:123], v[48:51], v[116:119]
    ds_read_b64_tr_b16 v[38:39], v11 offset:16896
    s_waitcnt lgkmcnt(6)
    v_mfma_f32_32x32x16_bf16 v[144:159], v[52:55], v[76:79], v[144:159]
    ds_read_b64_tr_b16 v[40:41], v12 offset:16384
    ds_read_b64_tr_b16 v[42:43], v12 offset:16896
    buffer_load_dwordx4 v[68:71], v1, s[36:39], s90 offen offset:2048 sc1
    ds_read_b64_tr_b16 v[44:45], v13 offset:16384
    v_mfma_f32_32x32x16_bf16 v[160:175], v[56:59], v[76:79], v[160:175]
    ds_read_b64_tr_b16 v[46:47], v13 offset:16896
    s_waitcnt lgkmcnt(8)
    v_mfma_f32_32x32x16_bf16 v[176:191], v[60:63], v[76:79], v[176:191]
    s_waitcnt vmcnt(14) lgkmcnt(5)
    v_mfma_f32_32x32x16_bf16 v[128:143], v[32:35], v[80:83], v[128:143]
    ds_read_b64_tr_b16 v[48:49], v10 offset:20480
    ds_read_b64_tr_b16 v[50:51], v10 offset:20992
    buffer_load_dwordx4 v[72:75], v1, s[36:39], s90 offen offset:3072 sc1
    ds_read_b64_tr_b16 v[52:53], v11 offset:20480
    v_mfma_f32_16x16x32_bf16 v[116:119], v[120:123], v[32:35], v[116:119]
    ds_read_b64_tr_b16 v[54:55], v11 offset:20992
    s_waitcnt lgkmcnt(6)
    v_mfma_f32_32x32x16_bf16 v[144:159], v[36:39], v[80:83], v[144:159]
    ds_read_b64_tr_b16 v[56:57], v12 offset:20480
    ds_read_b64_tr_b16 v[58:59], v12 offset:20992
    ds_read_b64_tr_b16 v[60:61], v13 offset:20480
    v_mfma_f32_32x32x16_bf16 v[160:175], v[40:43], v[80:83], v[160:175]
    ds_read_b64_tr_b16 v[62:63], v13 offset:20992
    s_waitcnt vmcnt(11)
    s_cmp_lg_u32 s51, 0
    s_cbranch_scc1 L_rel_53
    buffer_store_dwordx2 v[124:125], v2, s[36:39], s73 offen offset:768
L_reld_54:
    buffer_load_dwordx4 v15, s[24:27], s41 offen offset:1024 lds
    s_waitcnt lgkmcnt(8)
    v_mfma_f32_32x32x16_bf16 v[176:191], v[44:47], v[80:83], v[176:191]
    s_waitcnt lgkmcnt(5)
    v_mfma_f32_32x32x16_bf16 v[128:143], v[48:51], v[84:87], v[128:143]
    ds_read_b64_tr_b16 v[32:33], v10 offset:24576
    s_add_u32 s90, s88, 16384
    s_and_b32 s90, s90, 0x7000
    ds_read_b64_tr_b16 v[34:35], v10 offset:25088
    s_add_u32 s90, s90, s3
    ds_read_b64_tr_b16 v[36:37], v11 offset:24576
    buffer_load_dwordx4 v[76:79], v1, s[36:39], s90 offen sc1
    v_mfma_f32_16x16x32_bf16 v[116:119], v[120:123], v[48:51], v[116:119]
    ds_read_b64_tr_b16 v[38:39], v11 offset:25088
    s_waitcnt lgkmcnt(6)
    v_mfma_f32_32x32x16_bf16 v[144:159], v[52:55], v[84:87], v[144:159]
    ds_read_b64_tr_b16 v[40:41], v12 offset:24576
    ds_read_b64_tr_b16 v[42:43], v12 offset:25088
    ds_read_b64_tr_b16 v[44:45], v13 offset:24576
    v_mfma_f32_32x32x16_bf16 v[160:175], v[56:59], v[84:87], v[160:175]
    ds_read_b64_tr_b16 v[46:47], v13 offset:25088
    s_add_u32 m0, s53, 65536
    s_add_u32 s41, s88, 16384
    s_and_b32 s41, s41, 0x7000
    s_mul_i32 s41, s41, 56
    s_add_u32 s41, s41, s74
    buffer_load_dwordx4 v14, s[20:23], s41 offen lds
    s_waitcnt lgkmcnt(8)
    v_mfma_f32_32x32x16_bf16 v[176:191], v[60:63], v[84:87], v[176:191]
    s_waitcnt lgkmcnt(5)
    v_mfma_f32_32x32x16_bf16 v[128:143], v[32:35], v[88:91], v[128:143]
    ds_read_b64_tr_b16 v[48:49], v10 offset:28672
    ds_read_b64_tr_b16 v[50:51], v10 offset:29184
    ds_read_b64_tr_b16 v[52:53], v11 offset:28672
    v_mfma_f32_16x16x32_bf16 v[116:119], v[120:123], v[32:35], v[116:119]
    ds_read_b64_tr_b16 v[54:55], v11 offset:29184
    s_waitcnt lgkmcnt(5)
    v_mfma_f32_32x32x16_bf16 v[144:159], v[36:39], v[88:91], v[144:159]
    ds_read_b64_tr_b16 v[56:57], v12 offset:28672
    ds_read_b64_tr_b16 v[58:59], v12 offset:29184
    buffer_load_dwordx4 v15, s[20:23], s41 offen offset:1024 lds
    ds_read_b64_tr_b16 v[60:61], v13 offset:28672
    v_mfma_f32_32x32x16_bf16 v[160:175], v[40:43], v[88:91], v[160:175]
    ds_read_b64_tr_b16 v[62:63], v13 offset:29184
    s_waitcnt lgkmcnt(8)
    v_mfma_f32_32x32x16_bf16 v[176:191], v[44:47], v[88:91], v[176:191]
    s_waitcnt lgkmcnt(5)
    v_mfma_f32_32x32x16_bf16 v[128:143], v[48:51], v[92:95], v[128:143]
    ds_read_b64_tr_b16 v[32:33], v10 offset:32768
    ds_read_b64_tr_b16 v[34:35], v10 offset:33280
    ds_read_b64_tr_b16 v[36:37], v11 offset:32768
    v_mfma_f32_16x16x32_bf16 v[116:119], v[120:123], v[48:51], v[116:119]
    ds_read_b64_tr_b16 v[38:39], v11 offset:33280
    s_waitcnt lgkmcnt(6)
    v_mfma_f32_32x32x16_bf16 v[144:159], v[52:55], v[92:95], v[144:159]
    ds_read_b64_tr_b16 v[40:41], v12 offset:32768
    ds_read_b64_tr_b16 v[42:43], v12 offset:33280
    buffer_load_dwordx2 v[22:23], v19, s[36:39], s78 offen offset:768 sc1
    ds_read_b64_tr_b16 v[44:45], v13 offset:32768
    v_mfma_f32_32x32x16_bf16 v[160:175], v[56:59], v[92:95], v[160:175]
    ds_read_b64_tr_b16 v[46:47], v13 offset:33280
    s_waitcnt lgkmcnt(8)
    v_mfma_f32_32x32x16_bf16 v[176:191], v[60:63], v[92:95], v[176:191]
    s_waitcnt vmcnt(16) lgkmcnt(5)
    v_mfma_f32_32x32x16_bf16 v[128:143], v[32:35], v[96:99], v[128:143]
    ds_read_b64_tr_b16 v[48:49], v10 offset:36864
    ds_read_b64_tr_b16 v[50:51], v10 offset:37376
    ds_read_b64_tr_b16 v[52:53], v11 offset:36864
    v_mfma_f32_16x16x32_bf16 v[116:119], v[120:123], v[32:35], v[116:119]
    ds_read_b64_tr_b16 v[54:55], v11 offset:37376
    s_waitcnt lgkmcnt(6)
    v_mfma_f32_32x32x16_bf16 v[144:159], v[36:39], v[96:99], v[144:159]
    ds_read_b64_tr_b16 v[56:57], v12 offset:36864
    s_add_u32 m0, s53, 67584
    ds_read_b64_tr_b16 v[58:59], v12 offset:37376
    buffer_load_dwordx4 v14, s[24:27], s41 offen lds
    ds_read_b64_tr_b16 v[60:61], v13 offset:36864
    v_mfma_f32_32x32x16_bf16 v[160:175], v[40:43], v[96:99], v[160:175]
    ds_read_b64_tr_b16 v[62:63], v13 offset:37376
    s_waitcnt lgkmcnt(8)
    v_mfma_f32_32x32x16_bf16 v[176:191], v[44:47], v[96:99], v[176:191]
    s_waitcnt vmcnt(15) lgkmcnt(5)
    v_mfma_f32_32x32x16_bf16 v[128:143], v[48:51], v[100:103], v[128:143]
    ds_read_b64_tr_b16 v[32:33], v10 offset:40960
    ds_read_b64_tr_b16 v[34:35], v10 offset:41472
    ds_read_b64_tr_b16 v[36:37], v11 offset:40960
    v_mfma_f32_16x16x32_bf16 v[116:119], v[120:123], v[48:51], v[116:119]
    ds_read_b64_tr_b16 v[38:39], v11 offset:41472
    s_waitcnt lgkmcnt(6)
    v_mfma_f32_32x32x16_bf16 v[144:159], v[52:55], v[100:103], v[144:159]
    ds_read_b64_tr_b16 v[40:41], v12 offset:40960
    ds_read_b64_tr_b16 v[42:43], v12 offset:41472
    buffer_load_dwordx4 v15, s[24:27], s41 offen offset:1024 lds
    ds_read_b64_tr_b16 v[44:45], v13 offset:40960
    v_mfma_f32_32x32x16_bf16 v[160:175], v[56:59], v[100:103], v[160:175]
    ds_read_b64_tr_b16 v[46:47], v13 offset:41472
    s_waitcnt lgkmcnt(8)
    v_mfma_f32_32x32x16_bf16 v[176:191], v[60:63], v[100:103], v[176:191]
    s_waitcnt vmcnt(15) lgkmcnt(5)
    v_mfma_f32_32x32x16_bf16 v[128:143], v[32:35], v[104:107], v[128:143]
    ds_read_b64_tr_b16 v[48:49], v10 offset:45056
    ds_read_b64_tr_b16 v[50:51], v10 offset:45568
    ds_read_b64_tr_b16 v[52:53], v11 offset:45056
    v_mfma_f32_16x16x32_bf16 v[116:119], v[120:123], v[32:35], v[116:119]
    ds_read_b64_tr_b16 v[54:55], v11 offset:45568
    s_waitcnt lgkmcnt(6)
    v_mfma_f32_32x32x16_bf16 v[144:159], v[36:39], v[104:107], v[144:159]
    ds_read_b64_tr_b16 v[56:57], v12 offset:45056
    s_add_u32 m0, s53, 81920
    s_add_u32 s41, s88, 20480
    s_and_b32 s41, s41, 0x7000
    s_mul_i32 s41, s41, 56
    s_add_u32 s41, s41, s74
    buffer_load_dwordx4 v14, s[20:23], s41 offen lds
    v_mfma_f32_32x32x16_bf16 v[160:175], v[40:43], v[104:107], v[160:175]
    ds_read_b64_tr_b16 v[58:59], v12 offset:45568
    s_waitcnt lgkmcnt(6)
    ds_read_b64_tr_b16 v[60:61], v13 offset:45056
    ds_read_b64_tr_b16 v[62:63], v13 offset:45568
    v_mfma_f32_32x32x16_bf16 v[176:191], v[44:47], v[104:107], v[176:191]
    s_waitcnt vmcnt(14) lgkmcnt(5)
    v_mfma_f32_32x32x16_bf16 v[128:143], v[48:51], v[108:111], v[128:143]
    s_waitcnt vmcnt(7)
    s_barrier
    ds_read_b64_tr_b16 v[32:33], v10 offset:49152
    ds_read_b64_tr_b16 v[34:35], v10 offset:49664
    ds_read_b64_tr_b16 v[36:37], v11 offset:49152
    v_mfma_f32_16x16x32_bf16 v[116:119], v[120:123], v[48:51], v[116:119]
    ds_read_b64_tr_b16 v[38:39], v11 offset:49664
    s_waitcnt lgkmcnt(7)
    v_mfma_f32_32x32x16_bf16 v[144:159], v[52:55], v[108:111], v[144:159]
    ds_read_b64_tr_b16 v[40:41], v12 offset:49152
    s_waitcnt lgkmcnt(7)
    ds_read_b64_tr_b16 v[42:43], v12 offset:49664
    ds_read_b64_tr_b16 v[44:45], v13 offset:49152
    v_mfma_f32_32x32x16_bf16 v[160:175], v[56:59], v[108:111], v[160:175]
    ds_read_b64_tr_b16 v[46:47], v13 offset:49664
    s_waitcnt vmcnt(3)
    v_cmp_ne_u64 vcc, s[46:47], v[22:23]
    s_nop 0
    s_cbranch_vccz L_ok_55
L_spin_56:
    buffer_load_dwordx2 v[22:23], v19, s[36:39], s78 offen offset:768 sc1
    s_sub_u32 s52, s52, 1
    s_cbranch_scc1 L_abort
    s_waitcnt vmcnt(0)
    v_cmp_ne_u64 vcc, s[46:47], v[22:23]
    s_nop 0
    s_cbranch_vccnz L_spin_56
L_ok_55:
    s_waitcnt lgkmcnt(8)
    v_mfma_f32_32x32x16_bf16 v[176:191], v[60:63], v[108:111], v[176:191]
    s_waitcnt lgkmcnt(5)
    v_mfma_f32_32x32x16_bf16 v[128:143], v[32:35], v[112:115], v[128:143]
    ds_read_b64_tr_b16 v[48:49], v10 offset:53248
    s_add_u32 s91, s90, 32768
    ds_read_b64_tr_b16 v[50:51], v10 offset:53760
    buffer_load_dwordx4 v[80:83], v1, s[36:39], s91 offen sc1
    ds_read_b64_tr_b16 v[52:53], v11 offset:53248
    v_mfma_f32_16x16x32_bf16 v[116:119], v[120:123], v[32:35], v[116:119]
    ds_read_b64_tr_b16 v[54:55], v11 offset:53760
    s_waitcnt lgkmcnt(6)
    v_mfma_f32_32x32x16_bf16 v[144:159], v[36:39], v[112:115], v[144:159]
    ds_read_b64_tr_b16 v[56:57], v12 offset:53248
    ds_read_b64_tr_b16 v[58:59], v12 offset:53760
    buffer_load_dwordx4 v15, s[20:23], s41 offen offset:1024 lds
    ds_read_b64_tr_b16 v[60:61], v13 offset:53248
    v_mfma_f32_32x32x16_bf16 v[160:175], v[40:43], v[112:115], v[160:175]
    ds_read_b64_tr_b16 v[62:63], v13 offset:53760
    s_waitcnt lgkmcnt(8)
    v_mfma_f32_32x32x16_bf16 v[176:191], v[44:47], v[112:115], v[176:191]
    buffer_load_dwordx4 v[84:87], v1, s[36:39], s90 offen offset:1024 sc1
    s_waitcnt lgkmcnt(5)
    v_mfma_f32_32x32x16_bf16 v[128:143], v[48:51], v[64:67], v[128:143]
    ds_read_b64_tr_b16 v[32:33], v10 offset:57344
    ds_read_b64_tr_b16 v[34:35], v10 offset:57856
    buffer_load_dwordx4 v[88:91], v1, s[36:39], s91 offen offset:1024 sc1
    ds_read_b64_tr_b16 v[36:37], v11 offset:57344
    v_mfma_f32_16x16x32_bf16 v[116:119], v[120:123], v[48:51], v[116:119]
    ds_read_b64_tr_b16 v[38:39], v11 offset:57856
    s_waitcnt lgkmcnt(6)
    v_mfma_f32_32x32x16_bf16 v[144:159], v[52:55], v[64:67], v[144:159]
    ds_read_b64_tr_b16 v[40:41], v12 offset:57344
    s_add_u32 m0, s53, 83968
    ds_read_b64_tr_b16 v[42:43], v12 offset:57856
    buffer_load_dwordx4 v14, s[24:27], s41 offen lds
    ds_read_b64_tr_b16 v[44:45], v13 offset:57344
    v_mfma_f32_32x32x16_bf16 v[160:175], v[56:59], v[64:67], v[160:175]
    ds_read_b64_tr_b16 v[46:47], v13 offset:57856
    s_waitcnt lgkmcnt(8)
    v_mfma_f32_32x32x16_bf16 v[176:191], v[60:63], v[64:67], v[176:191]
    buffer_load_dwordx4 v[92:95], v1, s[36:39], s90 offen offset:2048 sc1
    s_waitcnt lgkmcnt(5)
    v_mfma_f32_32x32x16_bf16 v[128:143], v[32:35], v[68:71], v[128:143]
    ds_read_b64_tr_b16 v[48:49], v10 offset:61440
    ds_read_b64_tr_b16 v[50:51], v10 offset:61952
    buffer_load_dwordx4 v[96:99], v1, s[36:39], s91 offen offset:2048 sc1
    ds_read_b64_tr_b16 v[52:53], v11 offset:61440
    v_mfma_f32_16x16x32_bf16 v[116:119], v[120:123], v[32:35], v[116:119]
    ds_read_b64_tr_b16 v[54:55], v11 offset:61952
    s_waitcnt lgkmcnt(6)
    v_mfma_f32_32x32x16_bf16 v[144:159], v[36:39], v[68:71], v[144:159]
    ds_read_b64_tr_b16 v[56:57], v12 offset:61440
    ds_read_b64_tr_b16 v[58:59], v12 offset:61952
    buffer_load_dwordx4 v15, s[24:27], s41 offen offset:1024 lds
    ds_read_b64_tr_b16 v[60:61], v13 offset:61440
    v_mfma_f32_32x32x16_bf16 v[160:175], v[40:43], v[68:71], v[160:175]
    ds_read_b64_tr_b16 v[62:63], v13 offset:61952
    s_waitcnt lgkmcnt(8)
    v_xor_b32 v10, 0x10000, v10
    v_xor_b32 v11, 0x10000, v11
    v_xor_b32 v12, 0x10000, v12
    v_xor_b32 v13, 0x10000, v13
    v_mfma_f32_32x32x16_bf16 v[176:191], v[44:47], v[68:71], v[176:191]
    buffer_load_dwordx4 v[100:103], v1, s[36:39], s90 offen offset:3072 sc1
    s_waitcnt lgkmcnt(5)
    v_mfma_f32_32x32x16_bf16 v[128:143], v[48:51], v[72:75], v[128:143]
    s_waitcnt vmcnt(10)
    s_barrier
    ds_read_b64_tr_b16 v[32:33], v10 offset:0
    ds_read_b64_tr_b16 v[34:35], v10 offset:512
    buffer_load_dwordx4 v[104:107], v1, s[36:39], s91 offen offset:3072 sc1
    ds_read_b64_tr_b16 v[36:37], v11 offset:0
    v_mfma_f32_16x16x32_bf16 v[116:119], v[120:123], v[48:51], v[116:119]
    ds_read_b64_tr_b16 v[38:39], v11 offset:512
    s_waitcnt lgkmcnt(5)
    v_mfma_f32_32x32x16_bf16 v[144:159], v[52:55], v[72:75], v[144:159]
    ds_read_b64_tr_b16 v[40:41], v12 offset:0
    ds_read_b64_tr_b16 v[42:43], v12 offset:512
    ds_read_b64_tr_b16 v[44:45], v13 offset:0
    v_mfma_f32_32x32x16_bf16 v[160:175], v[56:59], v[72:75], v[160:175]
    ds_read_b64_tr_b16 v[46:47], v13 offset:512
    s_add_u32 s90, s88, 20480
    s_and_b32 s90, s90, 0x7000
    s_add_u32 s90, s90, s3
    buffer_load_dwordx4 v[108:111], v1, s[36:39], s90 offen sc1
    s_waitcnt lgkmcnt(8)
    v_mfma_f32_32x32x16_bf16 v[176:191], v[60:63], v[72:75], v[176:191]
    s_waitcnt lgkmcnt(5)
    v_mfma_f32_32x32x16_bf16 v[128:143], v[32:35], v[76:79], v[128:143]
    ds_read_b64_tr_b16 v[48:49], v10 offset:4096
    s_waitcnt vmcnt(10)
    ds_read_b64_tr_b16 v[50:51], v10 offset:4608
    ds_read_b64_tr_b16 v[52:53], v11 offset:4096
    v_mfma_f32_32x32x16_bf16 v[192:207], v[32:35], v[80:83], 0
    ds_read_b64_tr_b16 v[54:55], v11 offset:4608
    s_add_u32 s91, s90, 32768
    ds_read_b64_tr_b16 v[56:57], v12 offset:4096
    buffer_load_dwordx4 v[112:115], v1, s[36:39], s91 offen sc1
    ds_read_b64_tr_b16 v[58:59], v12 offset:4608
    v_mfma_f32_16x16x32_bf16 v[116:119], v[120:123], v[32:35], v[116:119]
    ds_read_b64_tr_b16 v[60:61], v13 offset:4096
    s_waitcnt lgkmcnt(7)
    v_mfma_f32_32x32x16_bf16 v[144:159], v[36:39], v[76:79], v[144:159]
    ds_read_b64_tr_b16 v[62:63], v13 offset:4608
    s_add_u32 m0, s53, 98304
    s_add_u32 s41, s88, 24576
    s_and_b32 s41, s41, 0x7000
    s_mul_i32 s41, s41, 56
    s_add_u32 s41, s41, s74
    buffer_load_dwordx4 v14, s[20:23], s41 offen lds
    v_mfma_f32_32x32x16_bf16 v[208:223], v[36:39], v[80:83], 0
    v_mfma_f32_32x32x16_bf16 v[160:175], v[40:43], v[76:79], v[160:175]
    buffer_load_dwordx4 v[64:67], v1, s[36:39], s90 offen offset:1024 sc1
    v_mfma_f32_32x32x16_bf16 v[224:239], v[40:43], v[80:83], 0
    v_mfma_f32_32x32x16_bf16 v[176:191], v[44:47], v[76:79], v[176:191]
    v_mfma_f32_32x32x16_bf16 v[240:255], v[44:47], v[80:83], 0
    buffer_load_dwordx4 v[68:71], v1, s[36:39], s91 offen offset:1024 sc1
    s_waitcnt vmcnt(12) lgkmcnt(0)
    v_mfma_f32_32x32x16_bf16 v[128:143], v[48:51], v[84:87], v[128:143]
    ds_read_b64_tr_b16 v[32:33], v10 offset:8192
    s_waitcnt vmcnt(11)
    ds_read_b64_tr_b16 v[34:35], v10 offset:8704
    ds_read_b64_tr_b16 v[36:37], v11 offset:8192
    v_mfma_f32_32x32x16_bf16 v[192:207], v[48:51], v[88:91], v[192:207]
    ds_read_b64_tr_b16 v[38:39], v11 offset:8704
    ds_read_b64_tr_b16 v[40:41], v12 offset:8192
    buffer_load_dwordx4 v[72:75], v1, s[36:39], s90 offen offset:2048 sc1
    ds_read_b64_tr_b16 v[42:43], v12 offset:8704
    v_mfma_f32_16x16x32_bf16 v[116:119], v[120:123], v[48:51], v[116:119]
    ds_read_b64_tr_b16 v[44:45], v13 offset:8192
    v_mfma_f32_32x32x16_bf16 v[144:159], v[52:55], v[84:87], v[144:159]
    ds_read_b64_tr_b16 v[46:47], v13 offset:8704
    buffer_load_dwordx4 v[76:79], v1, s[36:39], s91 offen offset:2048 sc1
    v_mfma_f32_32x32x16_bf16 v[208:223], v[52:55], v[88:91], v[208:223]
    v_mfma_f32_32x32x16_bf16 v[160:175], v[56:59], v[84:87], v[160:175]
    buffer_load_dwordx4 v15, s[20:23], s41 offen offset:1024 lds
    v_mfma_f32_32x32x16_bf16 v[224:239], v[56:59], v[88:91], v[224:239]
    v_mfma_f32_32x32x16_bf16 v[176:191], v[60:63], v[84:87], v[176:191]
    v_mfma_f32_32x32x16_bf16 v[240:255], v[60:63], v[88:91], v[240:255]
    buffer_load_dwordx4 v[80:83], v1, s[36:39], s90 offen offset:3072 sc1
    s_waitcnt vmcnt(13) lgkmcnt(0)
    v_mfma_f32_32x32x16_bf16 v[128:143], v[32:35], v[92:95], v[128:143]
    ds_read_b64_tr_b16 v[48:49], v10 offset:12288
    s_waitcnt vmcnt(12)
    ds_read_b64_tr_b16 v[50:51], v10 offset:12800
    ds_read_b64_tr_b16 v[52:53], v11 offset:12288
    v_mfma_f32_32x32x16_bf16 v[192:207], v[32:35], v[96:99], v[192:207]
    ds_read_b64_tr_b16 v[54:55], v11 offset:12800
    ds_read_b64_tr_b16 v[56:57], v12 offset:12288
    buffer_load_dwordx4 v[84:87], v1, s[36:39], s91 offen offset:3072 sc1
    ds_read_b64_tr_b16 v[58:59], v12 offset:12800
    v_mfma_f32_16x16x32_bf16 v[116:119], v[120:123], v[32:35], v[116:119]
    ds_read_b64_tr_b16 v[60:61], v13 offset:12288
    v_mfma_f32_32x32x16_bf16 v[144:159], v[36:39], v[92:95], v[144:159]
    ds_read_b64_tr_b16 v[62:63], v13 offset:12800
    v_mfma_f32_32x32x16_bf16 v[208:223], v[36:39], v[96:99], v[208:223]
    s_add_u32 s90, s88, 24576
    s_and_b32 s90, s90, 0x7000
    s_add_u32 s90, s90, s3
    buffer_load_dwordx4 v[88:91], v1, s[36:39], s90 offen sc1
    v_mfma_f32_32x32x16_bf16 v[160:175], v[40:43], v[92:95], v[160:175]
    v_mfma_f32_32x32x16_bf16 v[224:239], v[40:43], v[96:99], v[224:239]
    v_mfma_f32_32x32x16_bf16 v[176:191], v[44:47], v[92:95], v[176:191]
    s_add_u32 m0, s53, 100352
    s_nop 0
    buffer_load_dwordx4 v14, s[24:27], s41 offen lds
    v_mfma_f32_32x32x16_bf16 v[240:255], v[44:47], v[96:99], v[240:255]
    s_waitcnt vmcnt(13) lgkmcnt(0)
    v_mfma_f32_32x32x16_bf16 v[128:143], v[48:51], v[100:103], v[128:143]
    s_barrier
    ds_read_b64_tr_b16 v[32:33], v10 offset:16384
    s_waitcnt vmcnt(12)
    ds_read_b64_tr_b16 v[34:35], v10 offset:16896
    ds_read_b64_tr_b16 v[36:37], v11 offset:16384
    v_mfma_f32_32x32x16_bf16 v[192:207], v[48:51], v[104:107], v[192:207]
    ds_read_b64_tr_b16 v[38:39], v11 offset:16896
    s_add_u32 s91, s90, 32768
    ds_read_b64_tr_b16 v[40:41], v12 offset:16384
    buffer_load_dwordx4 v[92:95], v1, s[36:39], s91 offen sc1
    ds_read_b64_tr_b16 v[42:43], v12 offset:16896
    v_mfma_f32_16x16x32_bf16 v[116:119], v[120:123], v[48:51], v[116:119]
    ds_read_b64_tr_b16 v[44:45], v13 offset:16384
    v_mfma_f32_32x32x16_bf16 v[144:159], v[52:55], v[100:103], v[144:159]
    ds_read_b64_tr_b16 v[46:47], v13 offset:16896
    v_mfma_f32_32x32x16_bf16 v[208:223], v[52:55], v[104:107], v[208:223]
    buffer_load_dwordx4 v15, s[24:27], s41 offen offset:1024 lds
    v_mfma_f32_32x32x16_bf16 v[160:175], v[56:59], v[100:103], v[160:175]
    v_mfma_f32_32x32x16_bf16 v[224:239], v[56:59], v[104:107], v[224:239]
    v_mfma_f32_32x32x16_bf16 v[176:191], v[60:63], v[100:103], v[176:191]
    buffer_load_dwordx4 v[96:99], v1, s[36:39], s90 offen offset:1024 sc1
    v_mfma_f32_32x32x16_bf16 v[240:255], v[60:63], v[104:107], v[240:255]
    s_waitcnt vmcnt(14) lgkmcnt(0)
    v_mfma_f32_32x32x16_bf16 v[128:143], v[32:35], v[108:111], v[128:143]
    ds_read_b64_tr_b16 v[48:49], v10 offset:20480
    s_waitcnt vmcnt(13)
    ds_read_b64_tr_b16 v[50:51], v10 offset:20992
    ds_read_b64_tr_b16 v[52:53], v11 offset:20480
    v_mfma_f32_32x32x16_bf16 v[192:207], v[32:35], v[112:115], v[192:207]
    ds_read_b64_tr_b16 v[54:55], v11 offset:20992
    ds_read_b64_tr_b16 v[56:57], v12 offset:20480
    buffer_load_dwordx4 v[100:103], v1, s[36:39], s91 offen offset:1024 sc1
    ds_read_b64_tr_b16 v[58:59], v12 offset:20992
    v_mfma_f32_16x16x32_bf16 v[116:119], v[120:123], v[32:35], v[116:119]
    ds_read_b64_tr_b16 v[60:61], v13 offset:20480
    v_mfma_f32_32x32x16_bf16 v[144:159], v[36:39], v[108:111], v[144:159]
    ds_read_b64_tr_b16 v[62:63], v13 offset:20992
    s_add_u32 m0, s53, 114688
    s_add_u32 s41, s88, 28672
    s_and_b32 s41, s41, 0x7000
    s_mul_i32 s41, s41, 56
    s_add_u32 s41, s41, s74
    buffer_load_dwordx4 v14, s[20:23], s41 offen lds
    v_mfma_f32_32x32x16_bf16 v[208:223], v[36:39], v[112:115], v[208:223]
    v_mfma_f32_32x32x16_bf16 v[160:175], v[40:43], v[108:111], v[160:175]
    buffer_load_dwordx4 v[104:107], v1, s[36:39], s90 offen offset:2048 sc1
    v_mfma_f32_32x32x16_bf16 v[224:239], v[40:43], v[112:115], v[224:239]
    v_mfma_f32_32x32x16_bf16 v[176:191], v[44:47], v[108:111], v[176:191]
    v_mfma_f32_32x32x16_bf16 v[240:255], v[44:47], v[112:115], v[240:255]
    s_add_u32 m0, s53, 131072
    s_add_u32 s67, s89, 0
    s_lshl_b32 s67, s67, 4
    s_add_u32 s67, s67, s75
    buffer_load_dwordx4 v6, s[28:31], s67 offen lds
    s_waitcnt vmcnt(15) lgkmcnt(0)
    v_mfma_f32_32x32x16_bf16 v[128:143], v[48:51], v[64:67], v[128:143]
    ds_read_b64_tr_b16 v[32:33], v10 offset:24576
    s_waitcnt vmcnt(14)
    ds_read_b64_tr_b16 v[34:35], v10 offset:25088
    ds_read_b64_tr_b16 v[36:37], v11 offset:24576
    v_mfma_f32_32x32x16_bf16 v[192:207], v[48:51], v[68:71], v[192:207]
    ds_read_b64_tr_b16 v[38:39], v11 offset:25088
    ds_read_b64_tr_b16 v[40:41], v12 offset:24576
    buffer_load_dwordx4 v[108:111], v1, s[36:39], s91 offen offset:2048 sc1
    ds_read_b64_tr_b16 v[42:43], v12 offset:25088
    v_mfma_f32_16x16x32_bf16 v[116:119], v[120:123], v[48:51], v[116:119]
    ds_read_b64_tr_b16 v[44:45], v13 offset:24576
    v_mfma_f32_32x32x16_bf16 v[144:159], v[52:55], v[64:67], v[144:159]
    ds_read_b64_tr_b16 v[46:47], v13 offset:25088
    s_add_u32 m0, s53, 114688
    s_nop 0
    buffer_load_dwordx4 v15, s[20:23], s41 offen offset:1024 lds
    v_mfma_f32_32x32x16_bf16 v[208:223], v[52:55], v[68:71], v[208:223]
    v_mfma_f32_32x32x16_bf16 v[160:175], v[56:59], v[64:67], v[160:175]
    buffer_load_dwordx4 v[112:115], v1, s[36:39], s90 offen offset:3072 sc1
    v_mfma_f32_32x32x16_bf16 v[224:239], v[56:59], v[68:71], v[224:239]
    v_mfma_f32_32x32x16_bf16 v[176:191], v[60:63], v[64:67], v[176:191]
    v_mfma_f32_32x32x16_bf16 v[240:255], v[60:63], v[68:71], v[240:255]
    s_add_u32 m0, s53, 131072
    s_nop 0
    buffer_load_dwordx4 v7, s[28:31], s67 offen offset:1024 lds
    s_waitcnt vmcnt(17) lgkmcnt(0)
    v_mfma_f32_32x32x16_bf16 v[128:143], v[32:35], v[72:75], v[128:143]
    ds_read_b64_tr_b16 v[48:49], v10 offset:28672
    s_waitcnt vmcnt(16)
    ds_read_b64_tr_b16 v[50:51], v10 offset:29184
    ds_read_b64_tr_b16 v[52:53], v11 offset:28672
    v_mfma_f32_32x32x16_bf16 v[192:207], v[32:35], v[76:79], v[192:207]
    ds_read_b64_tr_b16 v[54:55], v11 offset:29184
    ds_read_b64_tr_b16 v[56:57], v12 offset:28672
    buffer_load_dwordx4 v[64:67], v1, s[36:39], s91 offen offset:3072 sc1
    ds_read_b64_tr_b16 v[58:59], v12 offset:29184
    v_mfma_f32_16x16x32_bf16 v[116:119], v[120:123], v[32:35], v[116:119]
    ds_read_b64_tr_b16 v[60:61], v13 offset:28672
    v_mfma_f32_32x32x16_bf16 v[144:159], v[36:39], v[72:75], v[144:159]
    ds_read_b64_tr_b16 v[62:63], v13 offset:29184
    s_add_u32 s90, s88, 28672
    s_and_b32 s90, s90, 0x7000
    s_add_u32 s90, s90, s3
    buffer_load_dwordx4 v[68:71], v1, s[36:39], s90 offen sc1
    v_mfma_f32_32x32x16_bf16 v[208:223], v[36:39], v[76:79], v[208:223]
    v_mfma_f32_32x32x16_bf16 v[160:175], v[40:43], v[72:75], v[160:175]
    s_add_u32 m0, s53, 116736
    s_nop 0
    buffer_load_dwordx4 v14, s[24:27], s41 offen lds
    v_mfma_f32_32x32x16_bf16 v[224:239], v[40:43], v[76:79], v[224:239]
    v_mfma_f32_32x32x16_bf16 v[176:191], v[44:47], v[72:75], v[176:191]
    v_mfma_f32_32x32x16_bf16 v[240:255], v[44:47], v[76:79], v[240:255]
    s_add_u32 m0, s53, 131072
    s_nop 0
    buffer_load_dwordx4 v8, s[28:31], s67 offen offset:2048 lds
    s_waitcnt vmcnt(18) lgkmcnt(0)
    v_mfma_f32_32x32x16_bf16 v[128:143], v[48:51], v[80:83], v[128:143]
    s_waitcnt vmcnt(13)
    s_barrier
    ds_read_b64_tr_b16 v[32:33], v10 offset:32768
    ds_read_b64_tr_b16 v[34:35], v10 offset:33280
    ds_read_b64_tr_b16 v[36:37], v11 offset:32768
    v_mfma_f32_32x32x16_bf16 v[192:207], v[48:51], v[84:87], v[192:207]
    ds_read_b64_tr_b16 v[38:39], v11 offset:33280
    s_add_u32 s91, s90, 32768
    ds_read_b64_tr_b16 v[40:41], v12 offset:32768
    buffer_load_dwordx4 v[72:75], v1, s[36:39], s91 offen sc1
    ds_read_b64_tr_b16 v[42:43], v12 offset:33280
    v_mfma_f32_16x16x32_bf16 v[116:119], v[120:123], v[48:51], v[116:119]
    ds_read_b64_tr_b16 v[44:45], v13 offset:32768
    v_mfma_f32_32x32x16_bf16 v[144:159], v[52:55], v[80:83], v[144:159]
    ds_read_b64_tr_b16 v[46:47], v13 offset:33280
    s_add_u32 m0, s53, 116736
    s_nop 0
    buffer_load_dwordx4 v15, s[24:27], s41 offen offset:1024 lds
    v_mfma_f32_32x32x16_bf16 v[208:223], v[52:55], v[84:87], v[208:223]
    v_mfma_f32_32x32x16_bf16 v[160:175], v[56:59], v[80:83], v[160:175]
    buffer_load_dwordx4 v[76:79], v1, s[36:39], s90 offen offset:1024 sc1
    v_mfma_f32_32x32x16_bf16 v[224:239], v[56:59], v[84:87], v[224:239]
    v_mfma_f32_32x32x16_bf16 v[176:191], v[60:63], v[80:83], v[176:191]
    v_mfma_f32_32x32x16_bf16 v[240:255], v[60:63], v[84:87], v[240:255]
    s_add_u32 m0, s53, 131072
    s_nop 0
    buffer_load_dwordx4 v9, s[28:31], s67 offen offset:3072 lds
    s_waitcnt lgkmcnt(0)
    v_mfma_f32_32x32x16_bf16 v[128:143], v[32:35], v[88:91], v[128:143]
    ds_read_b64_tr_b16 v[48:49], v10 offset:36864
    ds_read_b64_tr_b16 v[50:51], v10 offset:37376
    ds_read_b64_tr_b16 v[52:53], v11 offset:36864
    v_mfma_f32_32x32x16_bf16 v[192:207], v[32:35], v[92:95], v[192:207]
    ds_read_b64_tr_b16 v[54:55], v11 offset:37376
    ds_read_b64_tr_b16 v[56:57], v12 offset:36864
    buffer_load_dwordx4 v[80:83], v1, s[36:39], s91 offen offset:1024 sc1
    ds_read_b64_tr_b16 v[58:59], v12 offset:37376
    v_mfma_f32_16x16x32_bf16 v[116:119], v[120:123], v[32:35], v[116:119]
    ds_read_b64_tr_b16 v[60:61], v13 offset:36864
    v_mfma_f32_32x32x16_bf16 v[144:159], v[36:39], v[88:91], v[144:159]
    ds_read_b64_tr_b16 v[62:63], v13 offset:37376
    s_add_u32 m0, s53, 147456
    s_add_u32 s67, s67, 32768
    buffer_load_dwordx4 v6, s[28:31], s67 offen lds
    v_mfma_f32_32x32x16_bf16 v[208:223], v[36:39], v[92:95], v[208:223]
    s_lshl_b32 s58, s40, 7
    v_min_u32 v20, 7, v0
    v_lshlrev_b32 v20, 3, v20
    s_add_u32 s58, s58, 15794176
    buffer_load_dwordx2 v[22:23], v20, s[36:39], s58 offen sc1
    v_mfma_f32_32x32x16_bf16 v[160:175], v[40:43], v[88:91], v[160:175]
    buffer_load_dwordx4 v[84:87], v1, s[36:39], s90 offen offset:2048 sc1
    v_mfma_f32_32x32x16_bf16 v[224:239], v[40:43], v[92:95], v[224:239]
    v_mfma_f32_32x32x16_bf16 v[176:191], v[44:47], v[88:91], v[176:191]
    v_mfma_f32_32x32x16_bf16 v[240:255], v[44:47], v[92:95], v[240:255]
    buffer_load_dwordx4 v7, s[28:31], s67 offen offset:1024 lds
    s_waitcnt vmcnt(21) lgkmcnt(0)
    v_mfma_f32_32x32x16_bf16 v[128:143], v[48:51], v[96:99], v[128:143]
    ds_read_b64_tr_b16 v[32:33], v10 offset:40960
    s_waitcnt vmcnt(20)
    ds_read_b64_tr_b16 v[34:35], v10 offset:41472
    ds_read_b64_tr_b16 v[36:37], v11 offset:40960
    v_mfma_f32_32x32x16_bf16 v[192:207], v[48:51], v[100:103], v[192:207]
    ds_read_b64_tr_b16 v[38:39], v11 offset:41472
    ds_read_b64_tr_b16 v[40:41], v12 offset:40960
    buffer_load_dwordx4 v[88:91], v1, s[36:39], s91 offen offset:2048 sc1
    ds_read_b64_tr_b16 v[42:43], v12 offset:41472
    v_mfma_f32_16x16x32_bf16 v[116:119], v[120:123], v[48:51], v[116:119]
    ds_read_b64_tr_b16 v[44:45], v13 offset:40960
    v_mfma_f32_32x32x16_bf16 v[144:159], v[52:55], v[96:99], v[144:159]
    ds_read_b64_tr_b16 v[46:47], v13 offset:41472
    buffer_load_dwordx4 v8, s[28:31], s67 offen offset:2048 lds
    v_mfma_f32_32x32x16_bf16 v[208:223], v[52:55], v[100:103], v[208:223]
    v_mfma_f32_32x32x16_bf16 v[160:175], v[56:59], v[96:99], v[160:175]
    buffer_load_dwordx4 v[92:95], v1, s[36:39], s90 offen offset:3072 sc1
    v_mfma_f32_32x32x16_bf16 v[224:239], v[56:59], v[100:103], v[224:239]
    v_mfma_f32_32x32x16_bf16 v[176:191], v[60:63], v[96:99], v[176:191]
    v_mfma_f32_32x32x16_bf16 v[240:255], v[60:63], v[100:103], v[240:255]
    buffer_load_dwordx4 v9, s[28:31], s67 offen offset:3072 lds
    s_waitcnt vmcnt(22) lgkmcnt(0)
    v_mfma_f32_32x32x16_bf16 v[128:143], v[32:35], v[104:107], v[128:143]
    ds_read_b64_tr_b16 v[48:49], v10 offset:45056
    s_waitcnt vmcnt(20)
    ds_read_b64_tr_b16 v[50:51], v10 offset:45568
    ds_read_b64_tr_b16 v[52:53], v11 offset:45056
    v_mfma_f32_32x32x16_bf16 v[192:207], v[32:35], v[108:111], v[192:207]
    ds_read_b64_tr_b16 v[54:55], v11 offset:45568
    ds_read_b64_tr_b16 v[56:57], v12 offset:45056
    buffer_load_dwordx4 v[96:99], v1, s[36:39], s91 offen offset:3072 sc1
    ds_read_b64_tr_b16 v[58:59], v12 offset:45568
    v_mfma_f32_16x16x32_bf16 v[116:119], v[120:123], v[32:35], v[116:119]
    ds_read_b64_tr_b16 v[60:61], v13 offset:45056
    v_mfma_f32_32x32x16_bf16 v[144:159], v[36:39], v[104:107], v[144:159]
    ds_read_b64_tr_b16 v[62:63], v13 offset:45568
    v_mfma_f32_32x32x16_bf16 v[208:223], v[36:39], v[108:111], v[208:223]
    v_mfma_f32_32x32x16_bf16 v[160:175], v[40:43], v[104:107], v[160:175]
    v_mfma_f32_32x32x16_bf16 v[224:239], v[40:43], v[108:111], v[224:239]
    s_add_u32 s91, s88, 0
    s_and_b32 s91, s91, 0x7000
    s_add_u32 s3, s3, 32768
    s_add_u32 s91, s91, s3
    buffer_load_dwordx4 v[100:103], v1, s[36:39], s91 offen sc1
    v_mfma_f32_32x32x16_bf16 v[176:191], v[44:47], v[104:107], v[176:191]
    v_mfma_f32_32x32x16_bf16 v[240:255], v[44:47], v[108:111], v[240:255]
    s_waitcnt vmcnt(20) lgkmcnt(0)
    v_mfma_f32_32x32x16_bf16 v[128:143], v[48:51], v[112:115], v[128:143]
    s_waitcnt vmcnt(13)
    s_barrier
    ds_read_b64_tr_b16 v[32:33], v10 offset:49152
    ds_read_b64_tr_b16 v[34:35], v10 offset:49664
    ds_read_b64_tr_b16 v[36:37], v11 offset:49152
    v_mfma_f32_32x32x16_bf16 v[192:207], v[48:51], v[64:67], v[192:207]
    ds_read_b64_tr_b16 v[38:39], v11 offset:49664
    ds_read_b64_tr_b16 v[40:41], v12 offset:49152
    buffer_load_dwordx4 v[104:107], v1, s[36:39], s91 offen offset:1024 sc1
    ds_read_b64_tr_b16 v[42:43], v12 offset:49664
    v_mfma_f32_16x16x32_bf16 v[116:119], v[120:123], v[48:51], v[116:119]
    ds_read_b64_tr_b16 v[44:45], v13 offset:49152
    v_mfma_f32_32x32x16_bf16 v[144:159], v[52:55], v[112:115], v[144:159]
    ds_read_b64_tr_b16 v[46:47], v13 offset:49664
    v_mfma_f32_32x32x16_bf16 v[208:223], v[52:55], v[64:67], v[208:223]
    v_xor_b32 v17, 131072, v17
    s_waitcnt vmcnt(12)
    ds_read_b64_tr_b16 a[0:1], v17 offset:0
    ds_read_b64_tr_b16 a[2:3], v17 offset:512
    v_xor_b32 v18, 131072, v18
    v_mfma_f32_32x32x16_bf16 v[160:175], v[56:59], v[112:115], v[160:175]
    ds_read_b64_tr_b16 a[4:5], v18 offset:0
    ds_read_b64_tr_b16 a[6:7], v18 offset:512
    ds_read_b64_tr_b16 a[8:9], v17 offset:2048
    v_mfma_f32_32x32x16_bf16 v[224:239], v[56:59], v[64:67], v[224:239]
    ds_read_b64_tr_b16 a[10:11], v17 offset:2560
    ds_read_b64_tr_b16 a[12:13], v18 offset:2048
    ds_read_b64_tr_b16 a[14:15], v18 offset:2560
    buffer_load_dwordx4 v[108:111], v1, s[36:39], s91 offen offset:2048 sc1
    v_mfma_f32_32x32x16_bf16 v[176:191], v[60:63], v[112:115], v[176:191]
    s_waitcnt vmcnt(10)
    v_cmp_ne_u64 vcc, s[46:47], v[22:23]
    s_nop 0
    s_cbranch_vccz L_ok_51
L_spin_52:
    buffer_load_dwordx2 v[22:23], v20, s[36:39], s58 offen sc1
    s_sub_u32 s52, s52, 1
    s_cbranch_scc1 L_abort
    s_waitcnt vmcnt(0)
    v_cmp_ne_u64 vcc, s[46:47], v[22:23]
    s_nop 0
    s_cbranch_vccnz L_spin_52
L_ok_51:
    v_mfma_f32_32x32x16_bf16 v[240:255], v[60:63], v[64:67], v[240:255]
    s_waitcnt lgkmcnt(5)
    v_mfma_f32_32x32x16_bf16 v[128:143], v[32:35], v[68:71], v[128:143]
    ds_read_b64_tr_b16 v[48:49], v10 offset:53248
    ds_read_b64_tr_b16 v[50:51], v10 offset:53760
    buffer_load_dwordx4 v[112:115], v1, s[36:39], s91 offen offset:3072 sc1
    ds_read_b64_tr_b16 v[52:53], v11 offset:53248
    v_mfma_f32_32x32x16_bf16 v[192:207], v[32:35], v[72:75], v[192:207]
    ds_read_b64_tr_b16 v[54:55], v11 offset:53760
    ds_read_b64_tr_b16 v[56:57], v12 offset:53248
    ds_read_b64_tr_b16 v[58:59], v12 offset:53760
    v_mfma_f32_16x16x32_bf16 v[116:119], v[120:123], v[32:35], v[116:119]
    ds_read_b64_tr_b16 v[60:61], v13 offset:53248
    v_mfma_f32_32x32x16_bf16 v[144:159], v[36:39], v[68:71], v[144:159]
    ds_read_b64_tr_b16 v[62:63], v13 offset:53760
    s_add_u32 s91, s88, 4096
    s_and_b32 s91, s91, 0x7000
    s_add_u32 s91, s91, s3
    buffer_load_dwordx4 v[64:67], v1, s[36:39], s91 offen sc1
    v_mfma_f32_32x32x16_bf16 v[208:223], v[36:39], v[72:75], v[208:223]
    s_add_u32 m0, s53, 81920
    s_add_u32 s67, s89, 4096
    s_sub_u32 s66, s67, 28672
    s_cselect_b32 s67, s67, s66
    s_lshl_b32 s67, s67, 4
    s_add_u32 s67, s67, s75
    buffer_load_dwordx4 v6, s[28:31], s67 offen lds
    v_mfma_f32_32x32x16_bf16 v[160:175], v[40:43], v[68:71], v[160:175]
    buffer_load_dwordx4 v7, s[28:31], s67 offen offset:1024 lds
    v_mfma_f32_32x32x16_bf16 v[224:239], v[40:43], v[72:75], v[224:239]
    v_mfma_f32_32x32x16_bf16 v[176:191], v[44:47], v[68:71], v[176:191]
    buffer_load_dword v126, v19, s[36:39], s78 offen offset:1536 sc1
    buffer_load_dword v127, v19, s[36:39], s78 offen offset:1792 sc1
    v_mfma_f32_32x32x16_bf16 v[240:255], v[44:47], v[72:75], v[240:255]
    buffer_load_dword v14, v19, s[36:39], s77 offen offset:1540 sc1
    buffer_load_dword v15, v19, s[36:39], s77 offen offset:1796 sc1
    s_waitcnt lgkmcnt(0)
    v_mfma_f32_32x32x16_bf16 v[128:143], v[48:51], v[76:79], v[128:143]
    ds_read_b64_tr_b16 v[32:33], v10 offset:57344
    ds_read_b64_tr_b16 v[34:35], v10 offset:57856
    ds_read_b64_tr_b16 v[36:37], v11 offset:57344
    v_mfma_f32_32x32x16_bf16 v[192:207], v[48:51], v[80:83], v[192:207]
    ds_read_b64_tr_b16 v[38:39], v11 offset:57856
    ds_read_b64_tr_b16 v[40:41], v12 offset:57344
    buffer_load_dwordx4 v[68:71], v1, s[36:39], s91 offen offset:1024 sc1
    ds_read_b64_tr_b16 v[42:43], v12 offset:57856
    v_mfma_f32_16x16x32_bf16 v[116:119], v[120:123], v[48:51], v[116:119]
    ds_read_b64_tr_b16 v[44:45], v13 offset:57344
    v_mfma_f32_32x32x16_bf16 v[144:159], v[52:55], v[76:79], v[144:159]
    ds_read_b64_tr_b16 v[46:47], v13 offset:57856
    buffer_load_dwordx4 v8, s[28:31], s67 offen offset:2048 lds
    v_mfma_f32_32x32x16_bf16 v[208:223], v[52:55], v[80:83], v[208:223]
    v_mfma_f32_32x32x16_bf16 v[160:175], v[56:59], v[76:79], v[160:175]
    buffer_load_dwordx4 v[72:75], v1, s[36:39], s91 offen offset:2048 sc1
    v_mfma_f32_32x32x16_bf16 v[224:239], v[56:59], v[80:83], v[224:239]
    v_mfma_f32_32x32x16_bf16 v[176:191], v[60:63], v[76:79], v[176:191]
    v_mfma_f32_32x32x16_bf16 v[240:255], v[60:63], v[80:83], v[240:255]
    buffer_load_dwordx4 v9, s[28:31], s67 offen offset:3072 lds
    s_waitcnt vmcnt(21) lgkmcnt(0)
    v_mfma_f32_32x32x16_bf16 v[128:143], v[32:35], v[84:87], v[128:143]
    ds_read_b64_tr_b16 v[48:49], v10 offset:61440
    s_waitcnt vmcnt(19)
    ds_read_b64_tr_b16 v[50:51], v10 offset:61952
    ds_read_b64_tr_b16 v[52:53], v11 offset:61440
    v_mfma_f32_32x32x16_bf16 v[192:207], v[32:35], v[88:91], v[192:207]
    ds_read_b64_tr_b16 v[54:55], v11 offset:61952
    ds_read_b64_tr_b16 v[56:57], v12 offset:61440
    buffer_load_dwordx4 v[76:79], v1, s[36:39], s91 offen offset:3072 sc1
    ds_read_b64_tr_b16 v[58:59], v12 offset:61952
    v_mfma_f32_16x16x32_bf16 v[116:119], v[120:123], v[32:35], v[116:119]
    ds_read_b64_tr_b16 v[60:61], v13 offset:61440
    v_mfma_f32_32x32x16_bf16 v[144:159], v[36:39], v[84:87], v[144:159]
    ds_read_b64_tr_b16 v[62:63], v13 offset:61952
    s_add_u32 s91, s88, 8192
    s_and_b32 s91, s91, 0x7000
    s_add_u32 s91, s91, s3
    buffer_load_dwordx4 v[80:83], v1, s[36:39], s91 offen sc1
    v_xor_b32 v10, 0x10000, v10
    v_xor_b32 v11, 0x10000, v11
    v_mfma_f32_32x32x16_bf16 v[208:223], v[36:39], v[88:91], v[208:223]
    s_waitcnt vmcnt(18)
    ds_read_b64_tr_b16 a[192:193], v17 offset:16384
    ds_read_b64_tr_b16 a[194:195], v17 offset:16896
    v_xor_b32 v12, 0x10000, v12
    v_xor_b32 v13, 0x10000, v13
    v_mfma_f32_32x32x16_bf16 v[160:175], v[40:43], v[84:87], v[160:175]
    ds_read_b64_tr_b16 a[196:197], v18 offset:16384
    s_add_u32 m0, s53, 131072
    s_add_u32 s67, s67, 32768
    ds_read_b64_tr_b16 a[198:199], v18 offset:16896
    ds_read_b64_tr_b16 a[200:201], v17 offset:18432
    buffer_load_dwordx4 v6, s[28:31], s67 offen lds
    v_mfma_f32_32x32x16_bf16 v[224:239], v[40:43], v[88:91], v[224:239]
    ds_read_b64_tr_b16 a[202:203], v17 offset:18944
    ds_read_b64_tr_b16 a[204:205], v18 offset:18432
    ds_read_b64_tr_b16 a[206:207], v18 offset:18944
    v_mfma_f32_32x32x16_bf16 v[176:191], v[44:47], v[84:87], v[176:191]
    v_mfma_f32_32x32x16_bf16 v[240:255], v[44:47], v[88:91], v[240:255]
    buffer_load_dwordx4 v7, s[28:31], s67 offen offset:1024 lds
    s_waitcnt lgkmcnt(5)
    v_mfma_f32_32x32x16_bf16 v[128:143], v[48:51], v[92:95], v[128:143]
    ds_read_b64_tr_b16 v[32:33], v10 offset:0
    s_waitcnt vmcnt(19)
    ds_read_b64_tr_b16 v[34:35], v10 offset:512
    ds_read_b64_tr_b16 v[36:37], v11 offset:0
    v_mfma_f32_32x32x16_bf16 v[192:207], v[48:51], v[96:99], v[192:207]
    ds_read_b64_tr_b16 v[38:39], v11 offset:512
    ds_read_b64_tr_b16 v[40:41], v12 offset:0
    buffer_load_dwordx4 v[84:87], v1, s[36:39], s91 offen offset:1024 sc1
    ds_read_b64_tr_b16 v[42:43], v12 offset:512
    v_mfma_f32_16x16x32_bf16 v[116:119], v[120:123], v[48:51], v[116:119]
    ds_read_b64_tr_b16 v[44:45], v13 offset:0
    v_mfma_f32_32x32x16_bf16 v[144:159], v[52:55], v[92:95], v[144:159]
    ds_read_b64_tr_b16 v[46:47], v13 offset:512
    s_lshl_b32 s54, s43, 8
    s_add_u32 s54, s54, 65536
    buffer_load_dwordx4 v8, s[28:31], s67 offen offset:2048 lds
    v_lshl_add_u32 v20, v0, 2, s54
    v_mfma_f32_32x32x16_bf16 v[208:223], v[52:55], v[96:99], v[208:223]
    ds_write_b32 v20, v116
    v_xor_b32 v21, 256, v20
    v_xor_b32 v22, 512, v20
    v_xor_b32 v23, 768, v20
    v_mfma_f32_32x32x16_bf16 v[160:175], v[56:59], v[92:95], v[160:175]
    buffer_load_dwordx4 v[88:91], v1, s[36:39], s91 offen offset:2048 sc1
    v_mfma_f32_32x32x16_bf16 v[224:239], v[56:59], v[96:99], v[224:239]
    v_mfma_f32_32x32x16_bf16 v[176:191], v[60:63], v[92:95], v[176:191]
    v_mfma_f32_32x32x16_bf16 v[240:255], v[60:63], v[96:99], v[240:255]
    buffer_load_dwordx4 v9, s[28:31], s67 offen offset:3072 lds
    s_waitcnt vmcnt(22) lgkmcnt(0)
    v_mfma_f32_32x32x16_bf16 v[192:207], v[32:35], v[100:103], v[192:207]
    s_barrier
    ds_read_b32 v117, v21
    ds_read_b32 v118, v22
    buffer_load_dwordx4 v[92:95], v1, s[36:39], s91 offen offset:3072 sc1
    ds_read_b32 v119, v23
    v_mfma_f32_32x32x16_bf16 v[208:223], v[36:39], v[100:103], v[208:223]
    ds_read_b64_tr_b16 v[48:49], v10 offset:4096
    ds_read_b64_tr_b16 v[50:51], v10 offset:4608
    ds_read_b64_tr_b16 v[52:53], v11 offset:4096
    ds_read_b64_tr_b16 v[54:55], v11 offset:4608
    v_mfma_f32_32x32x16_bf16 v[224:239], v[40:43], v[100:103], v[224:239]
    ds_read_b64_tr_b16 v[56:57], v12 offset:4096
    s_add_u32 m0, s53, 147456
    s_add_u32 s67, s89, 8192
    s_sub_u32 s66, s67, 28672
    s_cselect_b32 s67, s67, s66
    s_lshl_b32 s67, s67, 4
    s_add_u32 s67, s67, s75
    buffer_load_dwordx4 v6, s[28:31], s67 offen lds
    v_mfma_f32_32x32x16_bf16 v[240:255], v[44:47], v[100:103], v[240:255]
    ds_read_b64_tr_b16 v[58:59], v12 offset:4608
    ds_read_b64_tr_b16 v[60:61], v13 offset:4096
    buffer_load_dwordx4 v7, s[28:31], s67 offen offset:1024 lds
    ds_read_b64_tr_b16 v[62:63], v13 offset:4608
    s_waitcnt vmcnt(24) lgkmcnt(6)
    v_mfma_f32_32x32x16_bf16 v[192:207], v[48:51], v[104:107], v[192:207]
    ds_read_b64_tr_b16 v[32:33], v10 offset:8192
    s_add_u32 s91, s88, 12288
    s_and_b32 s91, s91, 0x7000
    ds_read_b64_tr_b16 v[34:35], v10 offset:8704
    s_add_u32 s91, s91, s3
    ds_read_b64_tr_b16 v[36:37], v11 offset:8192
    buffer_load_dwordx4 v[96:99], v1, s[36:39], s91 offen sc1
    ds_read_b64_tr_b16 v[38:39], v11 offset:8704
    ds_read_b64_tr_b16 v[40:41], v12 offset:8192
    ds_read_b64_tr_b16 v[42:43], v12 offset:8704
    s_waitcnt lgkmcnt(9)
    v_mfma_f32_32x32x16_bf16 v[208:223], v[52:55], v[104:107], v[208:223]
    ds_read_b64_tr_b16 v[44:45], v13 offset:8192
    s_waitcnt lgkmcnt(9)
    ds_read_b64_tr_b16 v[46:47], v13 offset:8704
    s_waitcnt vmcnt(19)
    v_cvt_pk_bf16_f32 v21, v126, 0
    v_lshlrev_b32 v4, 16, v21
    v_sub_f32 v4, v126, v4
    v_cvt_pk_bf16_f32 v20, v126, v4
    v_mov_b32 v22, 0
    v_mov_b32 v23, 0
    v_mov_b32 v122, 0
    v_mov_b32 v123, 0
    v_mfma_f32_32x32x16_bf16 v[224:239], v[56:59], v[104:107], v[224:239]
    v_cvt_pk_bf16_f32 v120, v116, v116
    v_and_b32 v4, 0xffff0000, v120
    v_sub_f32 v4, v116, v4
    v_cvt_pk_bf16_f32 v121, v4, 0
    s_nop 1
    v_mfma_f32_32x32x16_bf16 v[128:143], v[120:123], v[20:23], v[128:143]
    buffer_load_dwordx4 v8, s[28:31], s67 offen offset:2048 lds
    s_waitcnt lgkmcnt(4)
    v_cvt_pk_bf16_f32 v120, v117, v117
    v_and_b32 v4, 0xffff0000, v120
    v_mfma_f32_32x32x16_bf16 v[240:255], v[60:63], v[104:107], v[240:255]
    v_sub_f32 v4, v117, v4
    v_cvt_pk_bf16_f32 v121, v4, 0
    s_nop 1
    v_mfma_f32_32x32x16_bf16 v[144:159], v[120:123], v[20:23], v[144:159]
    buffer_load_dwordx4 v9, s[28:31], s67 offen offset:3072 lds
    v_cvt_pk_bf16_f32 v120, v118, v118
    v_and_b32 v4, 0xffff0000, v120
    v_sub_f32 v4, v118, v4
    v_mfma_f32_32x32x16_bf16 v[192:207], v[32:35], v[108:111], v[192:207]
    ds_read_b64_tr_b16 v[48:49], v10 offset:12288
    ds_read_b64_tr_b16 v[50:51], v10 offset:12800
    buffer_load_dwordx4 v[100:103], v1, s[36:39], s91 offen offset:1024 sc1
    ds_read_b64_tr_b16 v[52:53], v11 offset:12288
    ds_read_b64_tr_b16 v[54:55], v11 offset:12800
    ds_read_b64_tr_b16 v[56:57], v12 offset:12288
    ds_read_b64_tr_b16 v[58:59], v12 offset:12800
    v_mfma_f32_32x32x16_bf16 v[208:223], v[36:39], v[108:111], v[208:223]
    ds_read_b64_tr_b16 v[60:61], v13 offset:12288
    ds_read_b64_tr_b16 v[62:63], v13 offset:12800
    v_cvt_pk_bf16_f32 v121, v4, 0
    s_nop 1
    v_mfma_f32_32x32x16_bf16 v[160:175], v[120:123], v[20:23], v[160:175]
    v_cvt_pk_bf16_f32 v120, v119, v119
    v_and_b32 v4, 0xffff0000, v120
    v_sub_f32 v4, v119, v4
    v_cvt_pk_bf16_f32 v121, v4, 0
    s_waitcnt lgkmcnt(8)
    v_mfma_f32_32x32x16_bf16 v[224:239], v[40:43], v[108:111], v[224:239]
    v_mfma_f32_32x32x16_bf16 v[176:191], v[120:123], v[20:23], v[176:191]
    s_xor_b32 s55, s4, 2048
    s_add_u32 m0, s53, 98304
    s_add_u32 s67, s67, 32768
    buffer_load_dwordx4 v6, s[28:31], s67 offen lds
    v_mul_f32 v128, v128, v144
    v_mul_f32 v129, v129, v145
    v_cvt_pk_bf16_f32 v128, v128, v129
    v_mul_f32 v130, v130, v146
    v_mul_f32 v131, v131, v147
    v_mfma_f32_32x32x16_bf16 v[240:255], v[44:47], v[108:111], v[240:255]
    v_cvt_pk_bf16_f32 v129, v130, v131
    v_mul_f32 v132, v132, v148
    v_mul_f32 v133, v133, v149
    v_cvt_pk_bf16_f32 v130, v132, v133
    v_mul_f32 v134, v134, v150
    v_mul_f32 v135, v135, v151
    v_cvt_pk_bf16_f32 v131, v134, v135
    buffer_store_dwordx4 v[128:131], v1, s[36:39], s4 offen sc1
    buffer_load_dwordx4 v7, s[28:31], s67 offen offset:1024 lds
    s_waitcnt lgkmcnt(0)
    v_mfma_f32_32x32x16_bf16 v[192:207], v[48:51], v[112:115], v[192:207]
    ds_read_b64_tr_b16 v[32:33], v10 offset:16384
    ds_read_b64_tr_b16 v[34:35], v10 offset:16896
    buffer_load_dwordx4 v[104:107], v1, s[36:39], s91 offen offset:2048 sc1
    ds_read_b64_tr_b16 v[36:37], v11 offset:16384
    ds_read_b64_tr_b16 v[38:39], v11 offset:16896
    ds_read_b64_tr_b16 v[40:41], v12 offset:16384
    ds_read_b64_tr_b16 v[42:43], v12 offset:16896
    v_mfma_f32_32x32x16_bf16 v[208:223], v[52:55], v[112:115], v[208:223]
    ds_read_b64_tr_b16 v[44:45], v13 offset:16384
    ds_read_b64_tr_b16 v[46:47], v13 offset:16896
    v_mul_f32 v136, v136, v152
    v_mul_f32 v137, v137, v153
    v_cvt_pk_bf16_f32 v132, v136, v137
    v_mul_f32 v138, v138, v154
    v_mul_f32 v139, v139, v155
    v_cvt_pk_bf16_f32 v133, v138, v139
    v_mul_f32 v140, v140, v156
    v_mul_f32 v141, v141, v157
    v_mfma_f32_32x32x16_bf16 v[224:239], v[56:59], v[112:115], v[224:239]
    v_cvt_pk_bf16_f32 v134, v140, v141
    v_mul_f32 v142, v142, v158
    v_mul_f32 v143, v143, v159
    v_cvt_pk_bf16_f32 v135, v142, v143
    buffer_store_dwordx4 v[132:135], v1, s[36:39], s4 offen offset:1024 sc1
    buffer_load_dwordx4 v8, s[28:31], s67 offen offset:2048 lds
    v_mul_f32 v160, v160, v176
    v_mul_f32 v161, v161, v177
    v_mfma_f32_32x32x16_bf16 v[240:255], v[60:63], v[112:115], v[240:255]
    buffer_load_dwordx4 v9, s[28:31], s67 offen offset:3072 lds
    v_cvt_pk_bf16_f32 v160, v160, v161
    v_mul_f32 v162, v162, v178
    v_mul_f32 v163, v163, v179
    v_cvt_pk_bf16_f32 v161, v162, v163
    v_mul_f32 v164, v164, v180
    v_mul_f32 v165, v165, v181
    s_waitcnt lgkmcnt(0)
    v_mfma_f32_32x32x16_bf16 v[192:207], v[32:35], v[64:67], v[192:207]
    ds_read_b64_tr_b16 v[48:49], v10 offset:20480
    ds_read_b64_tr_b16 v[50:51], v10 offset:20992
    buffer_load_dwordx4 v[108:111], v1, s[36:39], s91 offen offset:3072 sc1
    ds_read_b64_tr_b16 v[52:53], v11 offset:20480
    ds_read_b64_tr_b16 v[54:55], v11 offset:20992
    ds_read_b64_tr_b16 v[56:57], v12 offset:20480
    ds_read_b64_tr_b16 v[58:59], v12 offset:20992
    ds_read_b64_tr_b16 v[60:61], v13 offset:20480
    v_mfma_f32_32x32x16_bf16 v[208:223], v[36:39], v[64:67], v[208:223]
    ds_read_b64_tr_b16 v[62:63], v13 offset:20992
    v_xor_b32 v17, 196608, v17
    s_waitcnt vmcnt(23)
    ds_read_b64_tr_b16 a[208:209], v17 offset:16384
    ds_read_b64_tr_b16 a[210:211], v17 offset:16896
    v_xor_b32 v18, 196608, v18
    ds_read_b64_tr_b16 a[212:213], v18 offset:16384
    ds_read_b64_tr_b16 a[214:215], v18 offset:16896
    v_cvt_pk_bf16_f32 v162, v164, v165
    v_mul_f32 v166, v166, v182
    v_mfma_f32_32x32x16_bf16 v[224:239], v[40:43], v[64:67], v[224:239]
    s_add_u32 m0, s53, 114688
    v_mul_f32 v167, v167, v183
    v_cvt_pk_bf16_f32 v163, v166, v167
    buffer_store_dwordx4 v[160:163], v1, s[36:39], s55 offen sc1
    s_add_u32 s67, s89, 12288
    s_sub_u32 s66, s67, 28672
    s_cselect_b32 s67, s67, s66
    s_lshl_b32 s67, s67, 4
    s_add_u32 s67, s67, s75
    buffer_load_dwordx4 v6, s[28:31], s67 offen lds
    v_mul_f32 v168, v168, v184
    v_mul_f32 v169, v169, v185
    v_cvt_pk_bf16_f32 v164, v168, v169
    v_mul_f32 v170, v170, v186
    v_mul_f32 v171, v171, v187
    v_mfma_f32_32x32x16_bf16 v[240:255], v[44:47], v[64:67], v[240:255]
    v_cvt_pk_bf16_f32 v165, v170, v171
    v_mul_f32 v172, v172, v188
    v_mul_f32 v173, v173, v189
    v_cvt_pk_bf16_f32 v166, v172, v173
    v_mul_f32 v174, v174, v190
    v_mul_f32 v175, v175, v191
    v_cvt_pk_bf16_f32 v167, v174, v175
    buffer_store_dwordx4 v[164:167], v1, s[36:39], s55 offen offset:1024 sc1
    buffer_load_dwordx4 v7, s[28:31], s67 offen offset:1024 lds
    s_waitcnt lgkmcnt(0)
    v_mfma_f32_32x32x16_bf16 v[192:207], v[48:51], v[68:71], v[192:207]
    ds_read_b64_tr_b16 v[32:33], v10 offset:24576
    ds_read_b64_tr_b16 v[34:35], v10 offset:25088
    ds_read_b64_tr_b16 v[36:37], v11 offset:24576
    ds_read_b64_tr_b16 v[38:39], v11 offset:25088
    ds_read_b64_tr_b16 v[40:41], v12 offset:24576
    v_mfma_f32_32x32x16_bf16 v[208:223], v[52:55], v[68:71], v[208:223]
    ds_read_b64_tr_b16 v[42:43], v12 offset:25088
    ds_read_b64_tr_b16 v[44:45], v13 offset:24576
    ds_read_b64_tr_b16 v[46:47], v13 offset:25088
    ds_read_b64_tr_b16 a[216:217], v17 offset:18432
    ds_read_b64_tr_b16 a[218:219], v17 offset:18944
    buffer_load_dwordx4 v8, s[28:31], s67 offen offset:2048 lds
    v_mfma_f32_32x32x16_bf16 v[224:239], v[56:59], v[68:71], v[224:239]
    ds_read_b64_tr_b16 a[220:221], v18 offset:18432
    ds_read_b64_tr_b16 a[222:223], v18 offset:18944
    v_cvt_pk_bf16_f32 v21, v127, 0
    v_lshlrev_b32 v4, 16, v21
    v_sub_f32 v4, v127, v4
    v_cvt_pk_bf16_f32 v20, v127, v4
    v_mov_b32 v22, 0
    v_mov_b32 v23, 0
    v_cvt_pk_bf16_f32 v120, v116, v116
    v_mfma_f32_32x32x16_bf16 v[240:255], v[60:63], v[68:71], v[240:255]
    v_and_b32 v4, 0xffff0000, v120
    v_sub_f32 v4, v116, v4
    v_cvt_pk_bf16_f32 v121, v4, 0
    s_nop 1
    v_mfma_f32_32x32x16_bf16 v[192:207], v[120:123], v[20:23], v[192:207]
    buffer_load_dwordx4 v9, s[28:31], s67 offen offset:3072 lds
    v_cvt_pk_bf16_f32 v120, v117, v117
    v_and_b32 v4, 0xffff0000, v120
    s_waitcnt lgkmcnt(2)
    v_mfma_f32_32x32x16_bf16 v[192:207], v[32:35], v[72:75], v[192:207]
    ds_read_b64_tr_b16 v[48:49], v10 offset:28672
    ds_read_b64_tr_b16 v[50:51], v10 offset:29184
    ds_read_b64_tr_b16 v[52:53], v11 offset:28672
    ds_read_b64_tr_b16 v[54:55], v11 offset:29184
    ds_read_b64_tr_b16 v[56:57], v12 offset:28672
    ds_read_b64_tr_b16 v[58:59], v12 offset:29184
    ds_read_b64_tr_b16 v[60:61], v13 offset:28672
    ds_read_b64_tr_b16 v[62:63], v13 offset:29184
    v_mfma_f32_32x32x16_bf16 v[208:223], v[36:39], v[72:75], v[208:223]
    s_waitcnt lgkmcnt(8)
    s_add_u32 m0, s53, 81920
    v_xor_b32 v17, 196608, v17
    s_waitcnt vmcnt(21)
    ds_read_b64_tr_b16 a[224:225], v17 offset:0
    s_add_u32 s67, s67, 32768
    ds_read_b64_tr_b16 a[226:227], v17 offset:512
    v_xor_b32 v18, 196608, v18
    ds_read_b64_tr_b16 a[228:229], v18 offset:0
    ds_read_b64_tr_b16 a[230:231], v18 offset:512
    buffer_load_dwordx4 v6, s[28:31], s67 offen lds
    v_sub_f32 v4, v117, v4
    v_cvt_pk_bf16_f32 v121, v4, 0
    v_mfma_f32_32x32x16_bf16 v[224:239], v[40:43], v[72:75], v[224:239]
    s_nop 0
    v_mfma_f32_32x32x16_bf16 v[208:223], v[120:123], v[20:23], v[208:223]
    v_cvt_pk_bf16_f32 v120, v118, v118
    v_and_b32 v4, 0xffff0000, v120
    v_sub_f32 v4, v118, v4
    v_cvt_pk_bf16_f32 v121, v4, 0
    s_nop 1
    v_mfma_f32_32x32x16_bf16 v[224:239], v[120:123], v[20:23], v[224:239]
    v_mfma_f32_32x32x16_bf16 v[240:255], v[44:47], v[72:75], v[240:255]
    v_cvt_pk_bf16_f32 v120, v119, v119
    v_and_b32 v4, 0xffff0000, v120
    v_sub_f32 v4, v119, v4
    v_cvt_pk_bf16_f32 v121, v4, 0
    s_nop 1
    v_mfma_f32_32x32x16_bf16 v[240:255], v[120:123], v[20:23], v[240:255]
    buffer_load_dwordx4 v7, s[28:31], s67 offen offset:1024 lds
    s_waitcnt lgkmcnt(0)
    v_mfma_f32_32x32x16_bf16 v[192:207], v[48:51], v[76:79], v[192:207]
    ds_read_b64_tr_b16 v[32:33], v10 offset:32768
    ds_read_b64_tr_b16 v[34:35], v10 offset:33280
    ds_read_b64_tr_b16 v[36:37], v11 offset:32768
    v_mfma_f32_32x32x16_bf16 v[208:223], v[52:55], v[76:79], v[208:223]
    ds_read_b64_tr_b16 v[38:39], v11 offset:33280
    ds_read_b64_tr_b16 v[40:41], v12 offset:32768
    buffer_load_dwordx4 v8, s[28:31], s67 offen offset:2048 lds
    ds_read_b64_tr_b16 v[42:43], v12 offset:33280
    v_mfma_f32_32x32x16_bf16 v[224:239], v[56:59], v[76:79], v[224:239]
    ds_read_b64_tr_b16 v[44:45], v13 offset:32768
    ds_read_b64_tr_b16 v[46:47], v13 offset:33280
    ds_read_b64_tr_b16 a[232:233], v17 offset:2048
    v_mfma_f32_32x32x16_bf16 v[240:255], v[60:63], v[76:79], v[240:255]
    ds_read_b64_tr_b16 a[234:235], v17 offset:2560
    ds_read_b64_tr_b16 a[236:237], v18 offset:2048
    ds_read_b64_tr_b16 a[238:239], v18 offset:2560
    buffer_load_dwordx4 v9, s[28:31], s67 offen offset:3072 lds
    s_waitcnt lgkmcnt(10)
    v_mfma_f32_32x32x16_bf16 v[192:207], v[32:35], v[80:83], v[192:207]
    ds_read_b64_tr_b16 v[48:49], v10 offset:36864
    s_waitcnt lgkmcnt(9)
    ds_read_b64_tr_b16 v[50:51], v10 offset:37376
    ds_read_b64_tr_b16 v[52:53], v11 offset:36864
    ds_read_b64_tr_b16 v[54:55], v11 offset:37376
    v_mfma_f32_32x32x16_bf16 v[208:223], v[36:39], v[80:83], v[208:223]
    ds_read_b64_tr_b16 v[56:57], v12 offset:36864
    s_waitcnt lgkmcnt(5)
    s_add_u32 m0, s53, 131072
    s_add_u32 s67, s89, 16384
    s_sub_u32 s66, s67, 28672
    s_cselect_b32 s67, s67, s66
    s_lshl_b32 s67, s67, 4
    s_add_u32 s67, s67, s75
    buffer_load_dwordx4 v6, s[28:31], s67 offen lds
    v_mfma_f32_32x32x16_bf16 v[224:239], v[40:43], v[80:83], v[224:239]
    ds_read_b64_tr_b16 v[58:59], v12 offset:37376
    ds_read_b64_tr_b16 v[60:61], v13 offset:36864
    ds_read_b64_tr_b16 v[62:63], v13 offset:37376
    s_waitcnt vmcnt(20)
    ds_read_b64_tr_b16 a[240:241], v17 offset:16384
    v_mfma_f32_32x32x16_bf16 v[240:255], v[44:47], v[80:83], v[240:255]
    ds_read_b64_tr_b16 a[242:243], v17 offset:16896
    ds_read_b64_tr_b16 a[244:245], v18 offset:16384
    ds_read_b64_tr_b16 a[246:247], v18 offset:16896
    buffer_load_dwordx4 v7, s[28:31], s67 offen offset:1024 lds
    s_waitcnt lgkmcnt(9)
    v_mfma_f32_32x32x16_bf16 v[192:207], v[48:51], v[84:87], v[192:207]
    ds_read_b64_tr_b16 v[32:33], v10 offset:40960
    s_waitcnt lgkmcnt(8)
    ds_read_b64_tr_b16 v[34:35], v10 offset:41472
    ds_read_b64_tr_b16 v[36:37], v11 offset:40960
    v_mfma_f32_32x32x16_bf16 v[208:223], v[52:55], v[84:87], v[208:223]
    ds_read_b64_tr_b16 v[38:39], v11 offset:41472
    s_waitcnt lgkmcnt(10)
    ds_read_b64_tr_b16 v[40:41], v12 offset:40960
    buffer_load_dwordx4 v8, s[28:31], s67 offen offset:2048 lds
    ds_read_b64_tr_b16 v[42:43], v12 offset:41472
    v_mfma_f32_32x32x16_bf16 v[224:239], v[56:59], v[84:87], v[224:239]
    ds_read_b64_tr_b16 v[44:45], v13 offset:40960
    s_waitcnt lgkmcnt(11)
    ds_read_b64_tr_b16 v[46:47], v13 offset:41472
    ds_read_b64_tr_b16 a[248:249], v17 offset:18432
    v_mfma_f32_32x32x16_bf16 v[240:255], v[60:63], v[84:87], v[240:255]
    ds_read_b64_tr_b16 a[250:251], v17 offset:18944
    ds_read_b64_tr_b16 a[252:253], v18 offset:18432
    ds_read_b64_tr_b16 a[254:255], v18 offset:18944
    buffer_load_dwordx4 v9, s[28:31], s67 offen offset:3072 lds
    s_waitcnt lgkmcnt(10)
    v_mfma_f32_32x32x16_bf16 v[192:207], v[32:35], v[88:91], v[192:207]
    ds_read_b64_tr_b16 v[48:49], v10 offset:45056
    s_waitcnt lgkmcnt(9)
    ds_read_b64_tr_b16 v[50:51], v10 offset:45568
    ds_read_b64_tr_b16 v[52:53], v11 offset:45056
    ds_read_b64_tr_b16 v[54:55], v11 offset:45568
    v_mfma_f32_32x32x16_bf16 v[208:223], v[36:39], v[88:91], v[208:223]
    ds_read_b64_tr_b16 v[56:57], v12 offset:45056
    s_waitcnt lgkmcnt(5)
    s_add_u32 m0, s53, 147456
    s_add_u32 s67, s67, 32768
    ds_read_b64_tr_b16 v[58:59], v12 offset:45568
    buffer_load_dwordx4 v6, s[28:31], s67 offen lds
    ds_read_b64_tr_b16 v[60:61], v13 offset:45056
    ds_read_b64_tr_b16 v[62:63], v13 offset:45568
    v_mfma_f32_32x32x16_bf16 v[224:239], v[40:43], v[88:91], v[224:239]
    v_xor_b32 v17, 196608, v17
    s_waitcnt vmcnt(16)
    ds_read_b64_tr_b16 a[48:49], v17 offset:32768
    ds_read_b64_tr_b16 a[50:51], v17 offset:33280
    v_xor_b32 v18, 196608, v18
    v_mfma_f32_32x32x16_bf16 v[240:255], v[44:47], v[88:91], v[240:255]
    ds_read_b64_tr_b16 a[52:53], v18 offset:32768
    s_waitcnt vmcnt(12)
    s_cmp_lg_u32 s51, 0
    ds_read_b64_tr_b16 a[54:55], v18 offset:33280
    s_cbranch_scc1 L_rel_57
    buffer_store_dwordx2 v[124:125], v2, s[36:39], s5 offen offset:1024
L_reld_58:
    buffer_load_dwordx4 v7, s[28:31], s67 offen offset:1024 lds
    s_waitcnt lgkmcnt(9)
    v_mfma_f32_32x32x16_bf16 v[192:207], v[48:51], v[92:95], v[192:207]
    ds_read_b64_tr_b16 v[32:33], v10 offset:49152
    s_waitcnt lgkmcnt(8)
    ds_read_b64_tr_b16 v[34:35], v10 offset:49664
    ds_read_b64_tr_b16 v[36:37], v11 offset:49152
    v_mfma_f32_32x32x16_bf16 v[208:223], v[52:55], v[92:95], v[208:223]
    ds_read_b64_tr_b16 v[38:39], v11 offset:49664
    s_waitcnt lgkmcnt(8)
    ds_read_b64_tr_b16 v[40:41], v12 offset:49152
    buffer_load_dwordx4 v8, s[28:31], s67 offen offset:2048 lds
    ds_read_b64_tr_b16 v[42:43], v12 offset:49664
    v_mfma_f32_32x32x16_bf16 v[224:239], v[56:59], v[92:95], v[224:239]
    ds_read_b64_tr_b16 v[44:45], v13 offset:49152
    ds_read_b64_tr_b16 v[46:47], v13 offset:49664
    ds_read_b64_tr_b16 a[56:57], v17 offset:34816
    v_mfma_f32_32x32x16_bf16 v[240:255], v[60:63], v[92:95], v[240:255]
    ds_read_b64_tr_b16 a[58:59], v17 offset:35328
    ds_read_b64_tr_b16 a[60:61], v18 offset:34816
    ds_read_b64_tr_b16 a[62:63], v18 offset:35328
    buffer_load_dwordx4 v9, s[28:31], s67 offen offset:3072 lds
    s_waitcnt lgkmcnt(10)
    v_mfma_f32_32x32x16_bf16 v[192:207], v[32:35], v[96:99], v[192:207]
    ds_read_b64_tr_b16 v[48:49], v10 offset:53248
    s_waitcnt lgkmcnt(9)
    ds_read_b64_tr_b16 v[50:51], v10 offset:53760
    ds_read_b64_tr_b16 v[52:53], v11 offset:53248
    ds_read_b64_tr_b16 v[54:55], v11 offset:53760
    v_mfma_f32_32x32x16_bf16 v[208:223], v[36:39], v[96:99], v[208:223]
    ds_read_b64_tr_b16 v[56:57], v12 offset:53248
    s_waitcnt lgkmcnt(5)
    s_add_u32 m0, s53, 98304
    s_add_u32 s67, s89, 20480
    s_sub_u32 s66, s67, 28672
    s_cselect_b32 s67, s67, s66
    s_lshl_b32 s67, s67, 4
    s_add_u32 s67, s67, s75
    buffer_load_dwordx4 v6, s[28:31], s67 offen lds
    v_mfma_f32_32x32x16_bf16 v[224:239], v[40:43], v[96:99], v[224:239]
    ds_read_b64_tr_b16 v[58:59], v12 offset:53760
    ds_read_b64_tr_b16 v[60:61], v13 offset:53248
    ds_read_b64_tr_b16 v[62:63], v13 offset:53760
    s_waitcnt vmcnt(14)
    ds_read_b64_tr_b16 a[16:17], v17 offset:49152
    v_mfma_f32_32x32x16_bf16 v[240:255], v[44:47], v[96:99], v[240:255]
    ds_read_b64_tr_b16 a[18:19], v17 offset:49664
    ds_read_b64_tr_b16 a[20:21], v18 offset:49152
    ds_read_b64_tr_b16 a[22:23], v18 offset:49664
    buffer_load_dwordx4 v7, s[28:31], s67 offen offset:1024 lds
    s_waitcnt lgkmcnt(9)
    v_mfma_f32_32x32x16_bf16 v[192:207], v[48:51], v[100:103], v[192:207]
    ds_read_b64_tr_b16 v[32:33], v10 offset:57344
    s_waitcnt lgkmcnt(8)
    ds_read_b64_tr_b16 v[34:35], v10 offset:57856
    ds_read_b64_tr_b16 v[36:37], v11 offset:57344
    v_mfma_f32_32x32x16_bf16 v[208:223], v[52:55], v[100:103], v[208:223]
    ds_read_b64_tr_b16 v[38:39], v11 offset:57856
    s_waitcnt lgkmcnt(10)
    ds_read_b64_tr_b16 v[40:41], v12 offset:57344
    buffer_load_dwordx4 v8, s[28:31], s67 offen offset:2048 lds
    ds_read_b64_tr_b16 v[42:43], v12 offset:57856
    v_mfma_f32_32x32x16_bf16 v[224:239], v[56:59], v[100:103], v[224:239]
    ds_read_b64_tr_b16 v[44:45], v13 offset:57344
    s_waitcnt lgkmcnt(11)
    ds_read_b64_tr_b16 v[46:47], v13 offset:57856
    ds_read_b64_tr_b16 a[24:25], v17 offset:51200
    v_mfma_f32_32x32x16_bf16 v[240:255], v[60:63], v[100:103], v[240:255]
    ds_read_b64_tr_b16 a[26:27], v17 offset:51712
    ds_read_b64_tr_b16 a[28:29], v18 offset:51200
    ds_read_b64_tr_b16 a[30:31], v18 offset:51712
    buffer_load_dwordx4 v9, s[28:31], s67 offen offset:3072 lds
    s_waitcnt lgkmcnt(10)
    v_mfma_f32_32x32x16_bf16 v[192:207], v[32:35], v[104:107], v[192:207]
    ds_read_b64_tr_b16 v[48:49], v10 offset:61440
    s_waitcnt lgkmcnt(9)
    ds_read_b64_tr_b16 v[50:51], v10 offset:61952
    buffer_load_dwordx2 v[22:23], v16, s[36:39], s77 offen offset:1024 sc1
    ds_read_b64_tr_b16 v[52:53], v11 offset:61440
    v_mfma_f32_32x32x16_bf16 v[208:223], v[36:39], v[104:107], v[208:223]
    ds_read_b64_tr_b16 v[54:55], v11 offset:61952
    s_waitcnt lgkmcnt(10)
    ds_read_b64_tr_b16 v[56:57], v12 offset:61440
    ds_read_b64_tr_b16 v[58:59], v12 offset:61952
    v_mfma_f32_32x32x16_bf16 v[224:239], v[40:43], v[104:107], v[224:239]
    ds_read_b64_tr_b16 v[60:61], v13 offset:61440
    s_waitcnt lgkmcnt(7)
    s_add_u32 m0, s53, 114688
    s_add_u32 s67, s67, 32768
    ds_read_b64_tr_b16 v[62:63], v13 offset:61952
    buffer_load_dwordx4 v6, s[28:31], s67 offen lds
    v_mfma_f32_32x32x16_bf16 v[240:255], v[44:47], v[104:107], v[240:255]
    buffer_load_dwordx4 v7, s[28:31], s67 offen offset:1024 lds
    s_waitcnt lgkmcnt(6)
    v_mfma_f32_32x32x16_bf16 v[192:207], v[48:51], v[108:111], v[192:207]
    s_waitcnt lgkmcnt(4)
    v_mfma_f32_32x32x16_bf16 v[208:223], v[52:55], v[108:111], v[208:223]
    buffer_load_dwordx4 v8, s[28:31], s67 offen offset:2048 lds
    s_waitcnt lgkmcnt(2)
    v_mfma_f32_32x32x16_bf16 v[224:239], v[56:59], v[108:111], v[224:239]
    s_waitcnt lgkmcnt(0)
    v_mfma_f32_32x32x16_bf16 v[240:255], v[60:63], v[108:111], v[240:255]
    buffer_load_dwordx4 v9, s[28:31], s67 offen offset:3072 lds
    s_add_u32 s4, s4, 114688
    s_xor_b32 s55, s4, 2048
    s_nop 3
    v_mul_f32 v192, v192, v208
    v_mul_f32 v193, v193, v209
    v_cvt_pk_bf16_f32 v192, v192, v193
    v_mul_f32 v194, v194, v210
    v_mul_f32 v195, v195, v211
    v_cvt_pk_bf16_f32 v193, v194, v195
    v_mul_f32 v196, v196, v212
    v_mul_f32 v197, v197, v213
    v_cvt_pk_bf16_f32 v194, v196, v197
    v_mul_f32 v198, v198, v214
    v_mul_f32 v199, v199, v215
    v_cvt_pk_bf16_f32 v195, v198, v199
    buffer_store_dwordx4 v[192:195], v1, s[36:39], s4 offen sc1
    v_mul_f32 v200, v200, v216
    v_mul_f32 v201, v201, v217
    v_cvt_pk_bf16_f32 v196, v200, v201
    v_mul_f32 v202, v202, v218
    v_mul_f32 v203, v203, v219
    v_cvt_pk_bf16_f32 v197, v202, v203
    v_mul_f32 v204, v204, v220
    v_mul_f32 v205, v205, v221
    v_cvt_pk_bf16_f32 v198, v204, v205
    v_mul_f32 v206, v206, v222
    v_mul_f32 v207, v207, v223
    v_cvt_pk_bf16_f32 v199, v206, v207
    buffer_store_dwordx4 v[196:199], v1, s[36:39], s4 offen offset:1024 sc1
    v_mul_f32 v224, v224, v240
    v_mul_f32 v225, v225, v241
    v_cvt_pk_bf16_f32 v224, v224, v225
    v_mul_f32 v226, v226, v242
    v_mul_f32 v227, v227, v243
    v_cvt_pk_bf16_f32 v225, v226, v227
    v_mul_f32 v228, v228, v244
    v_mul_f32 v229, v229, v245
    v_cvt_pk_bf16_f32 v226, v228, v229
    v_mul_f32 v230, v230, v246
    v_mul_f32 v231, v231, v247
    v_cvt_pk_bf16_f32 v227, v230, v231
    buffer_store_dwordx4 v[224:227], v1, s[36:39], s55 offen sc1
    v_mul_f32 v232, v232, v248
    v_mul_f32 v233, v233, v249
    v_cvt_pk_bf16_f32 v228, v232, v233
    v_mul_f32 v234, v234, v250
    v_mul_f32 v235, v235, v251
    v_cvt_pk_bf16_f32 v229, v234, v235
    v_mul_f32 v236, v236, v252
    v_mul_f32 v237, v237, v253
    v_cvt_pk_bf16_f32 v230, v236, v237
    v_mul_f32 v238, v238, v254
    v_mul_f32 v239, v239, v255
    v_cvt_pk_bf16_f32 v231, v238, v239
    buffer_store_dwordx4 v[228:231], v1, s[36:39], s55 offen offset:1024 sc1
    s_waitcnt vmcnt(8)
    v_cmp_ne_u64 vcc, s[46:47], v[22:23]
    s_nop 0
    s_cbranch_vccz L_ok_59
L_spin_60:
    buffer_load_dwordx2 v[22:23], v16, s[36:39], s77 offen offset:1024 sc1
    s_sub_u32 s52, s52, 1
    s_cbranch_scc1 L_abort
    s_waitcnt vmcnt(0)
    v_cmp_ne_u64 vcc, s[46:47], v[22:23]
    s_nop 0
    s_cbranch_vccnz L_spin_60
L_ok_59:
    s_add_u32 s90, s89, 0
    s_add_u32 s90, s90, s76
    buffer_load_dwordx4 v[112:115], v1, s[36:39], s90 offen sc1
    buffer_load_dwordx4 v[64:67], v1, s[36:39], s90 offen offset:1024 sc1
    ds_read_b64_tr_b16 a[32:33], v17 offset:16384
    ds_read_b64_tr_b16 a[34:35], v17 offset:16896
    buffer_load_dwordx4 v[68:71], v1, s[36:39], s90 offen offset:2048 sc1
    ds_read_b64_tr_b16 a[36:37], v18 offset:16384
    ds_read_b64_tr_b16 a[38:39], v18 offset:16896
    ds_read_b64_tr_b16 a[40:41], v17 offset:18432
    buffer_load_dwordx4 v[72:75], v1, s[36:39], s90 offen offset:3072 sc1
    ds_read_b64_tr_b16 a[42:43], v17 offset:18944
    ds_read_b64_tr_b16 a[44:45], v18 offset:18432
    s_add_u32 s90, s89, 4096
    s_sub_u32 s66, s90, 28672
    s_cselect_b32 s90, s90, s66
    s_add_u32 s90, s90, s76
    buffer_load_dwordx4 v[76:79], v1, s[36:39], s90 offen sc1
    ds_read_b64_tr_b16 a[46:47], v18 offset:18944
    v_xor_b32 v17, 196608, v17
    v_xor_b32 v18, 196608, v18
    ds_read_b64_tr_b16 a[64:65], v17 offset:0
    buffer_load_dwordx4 v[80:83], v1, s[36:39], s90 offen offset:1024 sc1
    ds_read_b64_tr_b16 a[66:67], v17 offset:512
    ds_read_b64_tr_b16 a[68:69], v18 offset:0
    ds_read_b64_tr_b16 a[70:71], v18 offset:512
    buffer_load_dwordx4 v[84:87], v1, s[36:39], s90 offen offset:2048 sc1
    ds_read_b64_tr_b16 a[72:73], v17 offset:2048
    ds_read_b64_tr_b16 a[74:75], v17 offset:2560
    ds_read_b64_tr_b16 a[76:77], v18 offset:2048
    buffer_load_dwordx4 v[88:91], v1, s[36:39], s90 offen offset:3072 sc1
    ds_read_b64_tr_b16 a[78:79], v18 offset:2560
    ds_read_b64_tr_b16 a[80:81], v17 offset:16384
    ds_read_b64_tr_b16 a[82:83], v17 offset:16896
    s_add_u32 s90, s89, 8192
    s_sub_u32 s66, s90, 28672
    s_cselect_b32 s90, s90, s66
    s_add_u32 s90, s90, s76
    buffer_load_dwordx4 v[92:95], v1, s[36:39], s90 offen sc1
    ds_read_b64_tr_b16 a[84:85], v18 offset:16384
    ds_read_b64_tr_b16 a[86:87], v18 offset:16896
    buffer_load_dwordx4 v[96:99], v1, s[36:39], s90 offen offset:1024 sc1
    ds_read_b64_tr_b16 a[88:89], v17 offset:18432
    ds_read_b64_tr_b16 a[90:91], v17 offset:18944
    ds_read_b64_tr_b16 a[92:93], v18 offset:18432
    buffer_load_dwordx4 v[100:103], v1, s[36:39], s90 offen offset:2048 sc1
    ds_read_b64_tr_b16 a[94:95], v18 offset:18944
    s_waitcnt vmcnt(10)
    v_mfma_f32_32x32x16_bf16 v[128:143], a[0:3], v[112:115], 0
    s_cmp_lg_u32 s51, 0
    s_cbranch_scc1 L_rel_61
    buffer_store_dwordx2 v[124:125], v2, s[36:39], s5 offen offset:1280
L_reld_62:
    buffer_load_dwordx4 v[104:107], v1, s[36:39], s90 offen offset:3072 sc1
    v_mfma_f32_32x32x16_bf16 v[144:159], a[4:7], v[112:115], 0
    s_add_u32 s90, s89, 12288
    s_sub_u32 s66, s90, 28672
    s_cselect_b32 s90, s90, s66
    s_add_u32 s90, s90, s76
    buffer_load_dwordx4 v[108:111], v1, s[36:39], s90 offen sc1
    s_waitcnt lgkmcnt(6)
    s_add_u32 m0, s53, 81920
    s_add_u32 s67, s89, 24576
    s_sub_u32 s66, s67, 28672
    s_cselect_b32 s67, s67, s66
    s_lshl_b32 s67, s67, 4
    s_add_u32 s67, s67, s75
    buffer_load_dwordx4 v6, s[28:31], s67 offen lds
    s_waitcnt vmcnt(13)
    v_mfma_f32_32x32x16_bf16 v[128:143], a[8:11], v[64:67], v[128:143]
    v_mfma_f32_32x32x16_bf16 v[144:159], a[12:15], v[64:67], v[144:159]
    buffer_load_dwordx4 v[112:115], v1, s[36:39], s90 offen offset:1024 sc1
    s_waitcnt vmcnt(13)
    v_mfma_f32_32x32x16_bf16 v[128:143], a[192:195], v[68:71], v[128:143]
    v_xor_b32 v17, 196608, v17
    ds_read_b64_tr_b16 a[96:97], v17 offset:32768
    buffer_load_dwordx4 v[64:67], v1, s[36:39], s90 offen offset:2048 sc1
    v_xor_b32 v18, 196608, v18
    v_mfma_f32_32x32x16_bf16 v[144:159], a[196:199], v[68:71], v[144:159]
    ds_read_b64_tr_b16 a[98:99], v17 offset:33280
    ds_read_b64_tr_b16 a[100:101], v18 offset:32768
    ds_read_b64_tr_b16 a[102:103], v18 offset:33280
    buffer_load_dwordx4 v7, s[28:31], s67 offen offset:1024 lds
    s_waitcnt vmcnt(14)
    v_mfma_f32_32x32x16_bf16 v[128:143], a[200:203], v[72:75], v[128:143]
    ds_read_b64_tr_b16 a[104:105], v17 offset:34816
    ds_read_b64_tr_b16 a[106:107], v17 offset:35328
    ds_read_b64_tr_b16 a[108:109], v18 offset:34816
    v_mfma_f32_32x32x16_bf16 v[144:159], a[204:207], v[72:75], v[144:159]
    ds_read_b64_tr_b16 a[110:111], v18 offset:35328
    buffer_load_dwordx4 v[68:71], v1, s[36:39], s90 offen offset:3072 sc1
    s_waitcnt vmcnt(14)
    v_mfma_f32_32x32x16_bf16 v[128:143], a[208:211], v[76:79], v[128:143]
    ds_read_b64_tr_b16 a[112:113], v17 offset:49152
    s_add_u32 s90, s89, 16384
    s_sub_u32 s66, s90, 28672
    ds_read_b64_tr_b16 a[114:115], v17 offset:49664
    s_cselect_b32 s90, s90, s66
    s_add_u32 s90, s90, s76
    buffer_load_dwordx4 v[72:75], v1, s[36:39], s90 offen sc1
    v_mfma_f32_32x32x16_bf16 v[144:159], a[212:215], v[76:79], v[144:159]
    ds_read_b64_tr_b16 a[116:117], v18 offset:49152
    ds_read_b64_tr_b16 a[118:119], v18 offset:49664
    buffer_load_dwordx4 v8, s[28:31], s67 offen offset:2048 lds
    s_waitcnt vmcnt(15)
    v_mfma_f32_32x32x16_bf16 v[128:143], a[216:219], v[80:83], v[128:143]
    ds_read_b64_tr_b16 a[120:121], v17 offset:51200
    ds_read_b64_tr_b16 a[122:123], v17 offset:51712
    ds_read_b64_tr_b16 a[124:125], v18 offset:51200
    v_mfma_f32_32x32x16_bf16 v[144:159], a[220:223], v[80:83], v[144:159]
    ds_read_b64_tr_b16 a[126:127], v18 offset:51712
    buffer_load_dwordx4 v[76:79], v1, s[36:39], s90 offen offset:1024 sc1
    s_waitcnt vmcnt(15)
    v_mfma_f32_32x32x16_bf16 v[128:143], a[224:227], v[84:87], v[128:143]
    buffer_load_dwordx4 v[80:83], v1, s[36:39], s90 offen offset:2048 sc1
    v_mfma_f32_32x32x16_bf16 v[144:159], a[228:231], v[84:87], v[144:159]
    buffer_load_dwordx4 v9, s[28:31], s67 offen offset:3072 lds
    s_waitcnt vmcnt(16)
    v_mfma_f32_32x32x16_bf16 v[128:143], a[232:235], v[88:91], v[128:143]
    v_mfma_f32_32x32x16_bf16 v[144:159], a[236:239], v[88:91], v[144:159]
    buffer_load_dwordx4 v[84:87], v1, s[36:39], s90 offen offset:3072 sc1
    s_waitcnt vmcnt(16)
    v_mfma_f32_32x32x16_bf16 v[128:143], a[240:243], v[92:95], v[128:143]
    s_add_u32 s90, s89, 20480
    s_sub_u32 s66, s90, 28672
    s_cselect_b32 s90, s90, s66
    s_add_u32 s90, s90, s76
    buffer_load_dwordx4 v[88:91], v1, s[36:39], s90 offen sc1
    v_mfma_f32_32x32x16_bf16 v[144:159], a[244:247], v[92:95], v[144:159]
    s_add_u32 m0, s53, 131072
    s_add_u32 s67, s67, 32768
    buffer_load_dwordx4 v6, s[28:31], s67 offen lds
    s_waitcnt vmcnt(17)
    v_mfma_f32_32x32x16_bf16 v[128:143], a[248:251], v[96:99], v[128:143]
    buffer_load_dwordx2 v[22:23], v16, s[36:39], s77 offen offset:1280 sc1
    v_mfma_f32_32x32x16_bf16 v[144:159], a[252:255], v[96:99], v[144:159]
    buffer_load_dwordx4 v[92:95], v1, s[36:39], s90 offen offset:1024 sc1
    s_waitcnt vmcnt(18)
    v_mfma_f32_32x32x16_bf16 v[128:143], a[48:51], v[100:103], v[128:143]
    buffer_load_dwordx4 v[96:99], v1, s[36:39], s90 offen offset:2048 sc1
    v_mfma_f32_32x32x16_bf16 v[144:159], a[52:55], v[100:103], v[144:159]
    buffer_load_dwordx4 v7, s[28:31], s67 offen offset:1024 lds
    s_waitcnt vmcnt(18)
    v_mfma_f32_32x32x16_bf16 v[128:143], a[56:59], v[104:107], v[128:143]
    v_mfma_f32_32x32x16_bf16 v[144:159], a[60:63], v[104:107], v[144:159]
    buffer_load_dwordx4 v[100:103], v1, s[36:39], s90 offen offset:3072 sc1
    s_waitcnt vmcnt(18)
    v_mfma_f32_32x32x16_bf16 v[128:143], a[16:19], v[108:111], v[128:143]
    s_add_u32 s90, s89, 24576
    s_sub_u32 s66, s90, 28672
    s_cselect_b32 s90, s90, s66
    s_add_u32 s90, s90, s76
    buffer_load_dwordx4 v[104:107], v1, s[36:39], s90 offen sc1
    v_mfma_f32_32x32x16_bf16 v[144:159], a[20:23], v[108:111], v[144:159]
    buffer_load_dwordx4 v8, s[28:31], s67 offen offset:2048 lds
    s_waitcnt vmcnt(18)
    v_mfma_f32_32x32x16_bf16 v[128:143], a[24:27], v[112:115], v[128:143]
    v_mfma_f32_32x32x16_bf16 v[144:159], a[28:31], v[112:115], v[144:159]
    buffer_load_dwordx4 v[108:111], v1, s[36:39], s90 offen offset:1024 sc1
    s_waitcnt vmcnt(18)
    v_mfma_f32_32x32x16_bf16 v[128:143], a[32:35], v[64:67], v[128:143]
    buffer_load_dwordx4 v[112:115], v1, s[36:39], s90 offen offset:2048 sc1
    v_mfma_f32_32x32x16_bf16 v[144:159], a[36:39], v[64:67], v[144:159]
    buffer_load_dwordx4 v9, s[28:31], s67 offen offset:3072 lds
    s_waitcnt vmcnt(18)
    v_mfma_f32_32x32x16_bf16 v[128:143], a[40:43], v[68:71], v[128:143]
    v_mfma_f32_32x32x16_bf16 v[144:159], a[44:47], v[68:71], v[144:159]
    buffer_load_dwordx4 v[64:67], v1, s[36:39], s90 offen offset:3072 sc1
    s_waitcnt vmcnt(18)
    v_mfma_f32_32x32x16_bf16 v[128:143], a[64:67], v[72:75], v[128:143]
    v_mfma_f32_32x32x16_bf16 v[144:159], a[68:71], v[72:75], v[144:159]
    s_waitcnt vmcnt(16)
    v_mfma_f32_32x32x16_bf16 v[128:143], a[72:75], v[76:79], v[128:143]
    v_mfma_f32_32x32x16_bf16 v[144:159], a[76:79], v[76:79], v[144:159]
    s_waitcnt vmcnt(15)
    v_mfma_f32_32x32x16_bf16 v[128:143], a[80:83], v[80:83], v[128:143]
    s_waitcnt lgkmcnt(0)
    v_mfma_f32_32x32x16_bf16 v[144:159], a[84:87], v[80:83], v[144:159]
    s_waitcnt vmcnt(13)
    v_mfma_f32_32x32x16_bf16 v[128:143], a[88:91], v[84:87], v[128:143]
    s_waitcnt vmcnt(10)
    v_cmp_ne_u64 vcc, s[46:47], v[22:23]
    s_nop 0
    s_cbranch_vccz L_ok_66
L_spin_67:
    buffer_load_dwordx2 v[22:23], v16, s[36:39], s77 offen offset:1280 sc1
    s_sub_u32 s52, s52, 1
    s_cbranch_scc1 L_abort
    s_waitcnt vmcnt(0)
    v_cmp_ne_u64 vcc, s[46:47], v[22:23]
    s_nop 0
    s_cbranch_vccnz L_spin_67
L_ok_66:
    ds_read_b64_tr_b16 a[128:129], v17 offset:16384
    ds_read_b64_tr_b16 a[130:131], v17 offset:16896
    v_mfma_f32_32x32x16_bf16 v[144:159], a[92:95], v[84:87], v[144:159]
    ds_read_b64_tr_b16 a[132:133], v18 offset:16384
    ds_read_b64_tr_b16 a[134:135], v18 offset:16896
    v_mfma_f32_32x32x16_bf16 v[128:143], a[96:99], v[88:91], v[128:143]
    ds_read_b64_tr_b16 a[136:137], v17 offset:18432
    s_add_u32 s90, s89, 0
    s_add_u32 s76, s76, 114688
    ds_read_b64_tr_b16 a[138:139], v17 offset:18944
    s_add_u32 s90, s90, s76
    ds_read_b64_tr_b16 a[140:141], v18 offset:18432
    buffer_load_dwordx4 v[68:71], v1, s[36:39], s90 offen sc1
    v_mfma_f32_32x32x16_bf16 v[144:159], a[100:103], v[88:91], v[144:159]
    ds_read_b64_tr_b16 a[142:143], v18 offset:18944
    buffer_load_dwordx4 v[72:75], v1, s[36:39], s90 offen offset:1024 sc1
    s_waitcnt vmcnt(11)
    v_mfma_f32_32x32x16_bf16 v[128:143], a[104:107], v[92:95], v[128:143]
    buffer_load_dwordx4 v[76:79], v1, s[36:39], s90 offen offset:2048 sc1
    v_mfma_f32_32x32x16_bf16 v[144:159], a[108:111], v[92:95], v[144:159]
    buffer_load_dwordx4 v[80:83], v1, s[36:39], s90 offen offset:3072 sc1
    s_waitcnt vmcnt(12)
    v_mfma_f32_32x32x16_bf16 v[128:143], a[112:115], v[96:99], v[128:143]
    s_add_u32 s90, s89, 4096
    s_sub_u32 s66, s90, 28672
    s_cselect_b32 s90, s90, s66
    s_add_u32 s90, s90, s76
    buffer_load_dwordx4 v[84:87], v1, s[36:39], s90 offen sc1
    v_mfma_f32_32x32x16_bf16 v[144:159], a[116:119], v[96:99], v[144:159]
    buffer_load_dwordx4 v[88:91], v1, s[36:39], s90 offen offset:1024 sc1
    s_waitcnt vmcnt(12)
    v_mfma_f32_32x32x16_bf16 v[128:143], a[120:123], v[100:103], v[128:143]
    buffer_load_dwordx4 v[92:95], v1, s[36:39], s90 offen offset:2048 sc1
    v_mfma_f32_32x32x16_bf16 v[144:159], a[124:127], v[100:103], v[144:159]
    buffer_load_dwordx4 v[96:99], v1, s[36:39], s90 offen offset:3072 sc1
    s_waitcnt vmcnt(13) lgkmcnt(0)
    v_mfma_f32_32x32x16_bf16 v[128:143], a[128:131], v[104:107], v[128:143]
    v_xor_b32 v17, 196608, v17
    s_waitcnt vmcnt(9)
    ds_read_b64_tr_b16 a[144:145], v17 offset:0
    ds_read_b64_tr_b16 a[146:147], v17 offset:512
    v_xor_b32 v18, 196608, v18
    ds_read_b64_tr_b16 a[148:149], v18 offset:0
    ds_read_b64_tr_b16 a[150:151], v18 offset:512
    v_add_u32 v10, s84, v1
    v_mfma_f32_32x32x16_bf16 v[144:159], a[132:135], v[104:107], v[144:159]
    s_add_u32 s57, s6, 32768
    s_add_u32 s90, s89, 8192
    s_sub_u32 s66, s90, 28672
    s_cselect_b32 s90, s90, s66
    s_add_u32 s90, s90, s76
    buffer_load_dwordx4 v[100:103], v1, s[36:39], s90 offen sc1
    v_xor_b32 v11, 8192, v10
    v_xor_b32 v12, 16384, v10
    v_xor_b32 v13, 24576, v10
    v_mfma_f32_32x32x16_bf16 v[128:143], a[136:139], v[108:111], v[128:143]
    ds_read_b64_tr_b16 a[152:153], v17 offset:2048
    ds_read_b64_tr_b16 a[154:155], v17 offset:2560
    v_lshlrev_b32 v32, 16, v24
    ds_read_b64_tr_b16 a[156:157], v18 offset:2048
    ds_read_b64_tr_b16 a[158:159], v18 offset:2560
    v_and_b32 v33, 0xffff0000, v24
    v_mfma_f32_32x32x16_bf16 v[144:159], a[140:143], v[108:111], v[144:159]
    buffer_load_dwordx4 v[104:107], v1, s[36:39], s90 offen offset:1024 sc1
    v_lshlrev_b32 v34, 16, v25
    v_and_b32 v35, 0xffff0000, v25
    v_lshlrev_b32 v36, 16, v26
    v_and_b32 v37, 0xffff0000, v26
    v_lshlrev_b32 v38, 16, v27
    v_and_b32 v39, 0xffff0000, v27
    s_waitcnt lgkmcnt(4)
    v_mfma_f32_32x32x16_bf16 v[128:143], a[144:147], v[112:115], v[128:143]
    v_lshlrev_b32 v40, 16, v28
    v_and_b32 v41, 0xffff0000, v28
    v_lshlrev_b32 v42, 16, v29
    v_and_b32 v43, 0xffff0000, v29
    v_lshlrev_b32 v44, 16, v30
    v_and_b32 v45, 0xffff0000, v30
    v_mfma_f32_32x32x16_bf16 v[144:159], a[148:151], v[112:115], v[144:159]
    buffer_load_dwordx4 v[108:111], v1, s[36:39], s90 offen offset:2048 sc1
    v_lshlrev_b32 v46, 16, v31
    v_and_b32 v47, 0xffff0000, v31
    s_waitcnt vmcnt(11) lgkmcnt(0)
    v_mfma_f32_32x32x16_bf16 v[128:143], a[152:155], v[64:67], v[128:143]
    v_mfma_f32_32x32x16_bf16 v[144:159], a[156:159], v[64:67], v[144:159]
    buffer_load_dwordx4 v[112:115], v1, s[36:39], s90 offen offset:3072 sc1
    s_waitcnt vmcnt(11)
    v_mfma_f32_32x32x16_bf16 v[160:175], a[0:3], v[68:71], 0
    v_mfma_f32_32x32x16_bf16 v[176:191], a[4:7], v[68:71], 0
    s_add_u32 s90, s89, 12288
    s_sub_u32 s66, s90, 28672
    s_cselect_b32 s90, s90, s66
    s_add_u32 s90, s90, s76
    buffer_load_dwordx4 v[64:67], v1, s[36:39], s90 offen sc1
    s_waitcnt vmcnt(11)
    v_mfma_f32_32x32x16_bf16 v[160:175], a[8:11], v[72:75], v[160:175]
    s_barrier
    v_mfma_f32_32x32x16_bf16 v[176:191], a[12:15], v[72:75], v[176:191]
    buffer_load_dwordx4 v[68:71], v1, s[36:39], s90 offen offset:1024 sc1
    s_waitcnt vmcnt(11)
    v_mfma_f32_32x32x16_bf16 v[160:175], a[192:195], v[76:79], v[160:175]
    ds_write_b128 v11, v[136:139] offset:2048
    v_mfma_f32_32x32x16_bf16 v[176:191], a[196:199], v[76:79], v[176:191]
    buffer_load_dwordx4 v[72:75], v1, s[36:39], s90 offen offset:2048 sc1
    s_waitcnt vmcnt(11)
    v_mfma_f32_32x32x16_bf16 v[160:175], a[200:203], v[80:83], v[160:175]
    ds_write_b128 v11, v[140:143] offset:3072
    v_mfma_f32_32x32x16_bf16 v[176:191], a[204:207], v[80:83], v[176:191]
    buffer_load_dwordx4 v[76:79], v1, s[36:39], s90 offen offset:3072 sc1
    s_waitcnt vmcnt(11)
    v_mfma_f32_32x32x16_bf16 v[160:175], a[208:211], v[84:87], v[160:175]
    ds_write_b128 v12, v[144:147] offset:4096
    v_mfma_f32_32x32x16_bf16 v[176:191], a[212:215], v[84:87], v[176:191]
    s_add_u32 s90, s89, 16384
    s_sub_u32 s66, s90, 28672
    s_cselect_b32 s90, s90, s66
    s_add_u32 s90, s90, s76
    buffer_load_dwordx4 v[80:83], v1, s[36:39], s90 offen sc1
    s_waitcnt vmcnt(11)
    v_mfma_f32_32x32x16_bf16 v[160:175], a[216:219], v[88:91], v[160:175]
    ds_write_b128 v12, v[148:151] offset:5120
    v_mfma_f32_32x32x16_bf16 v[176:191], a[220:223], v[88:91], v[176:191]
    buffer_load_dwordx4 v[84:87], v1, s[36:39], s90 offen offset:1024 sc1
    s_waitcnt vmcnt(11)
    v_mfma_f32_32x32x16_bf16 v[160:175], a[224:227], v[92:95], v[160:175]
    ds_write_b128 v13, v[152:155] offset:6144
    v_mfma_f32_32x32x16_bf16 v[176:191], a[228:231], v[92:95], v[176:191]
    buffer_load_dwordx4 v[88:91], v1, s[36:39], s90 offen offset:2048 sc1
    s_waitcnt vmcnt(11)
    v_mfma_f32_32x32x16_bf16 v[160:175], a[232:235], v[96:99], v[160:175]
    ds_write_b128 v13, v[156:159] offset:7168
    v_mfma_f32_32x32x16_bf16 v[176:191], a[236:239], v[96:99], v[176:191]
    buffer_load_dwordx4 v[92:95], v1, s[36:39], s90 offen offset:3072 sc1
    s_waitcnt vmcnt(11)
    v_mfma_f32_32x32x16_bf16 v[160:175], a[240:243], v[100:103], v[160:175]
    v_mfma_f32_32x32x16_bf16 v[176:191], a[244:247], v[100:103], v[176:191]
    s_add_u32 s90, s89, 20480
    s_sub_u32 s66, s90, 28672
    s_cselect_b32 s90, s90, s66
    s_add_u32 s90, s90, s76
    buffer_load_dwordx4 v[96:99], v1, s[36:39], s90 offen sc1
    s_waitcnt vmcnt(11)
    v_mfma_f32_32x32x16_bf16 v[160:175], a[248:251], v[104:107], v[160:175]
    s_waitcnt lgkmcnt(0)
    s_barrier
    ds_read_b128 v[192:195], v10 offset:2048
    ds_read_b128 v[200:203], v10 offset:4096
    v_mfma_f32_32x32x16_bf16 v[176:191], a[252:255], v[104:107], v[176:191]
    ds_read_b128 v[208:211], v10 offset:6144
    buffer_load_dwordx4 v[100:103], v1, s[36:39], s90 offen offset:1024 sc1
    ds_read_b128 v[196:199], v10 offset:3072
    s_waitcnt vmcnt(11)
    v_mfma_f32_32x32x16_bf16 v[160:175], a[48:51], v[108:111], v[160:175]
    ds_read_b128 v[204:207], v10 offset:5120
    s_waitcnt lgkmcnt(4)
    v_add_f32 v128, v128, v192
    ds_read_b128 v[212:215], v10 offset:7168
    v_mfma_f32_32x32x16_bf16 v[176:191], a[52:55], v[108:111], v[176:191]
    buffer_load_dwordx4 v[104:107], v1, s[36:39], s90 offen offset:2048 sc1
    v_add_f32 v129, v129, v193
    v_add_f32 v130, v130, v194
    s_waitcnt vmcnt(11)
    v_mfma_f32_32x32x16_bf16 v[160:175], a[56:59], v[112:115], v[160:175]
    v_add_f32 v131, v131, v195
    s_waitcnt lgkmcnt(4)
    v_add_f32 v128, v128, v200
    v_add_f32 v129, v129, v201
    v_add_f32 v130, v130, v202
    v_add_f32 v131, v131, v203
    v_mfma_f32_32x32x16_bf16 v[176:191], a[60:63], v[112:115], v[176:191]
    buffer_load_dwordx4 v[108:111], v1, s[36:39], s90 offen offset:3072 sc1
    s_waitcnt vmcnt(11)
    v_mfma_f32_32x32x16_bf16 v[160:175], a[16:19], v[64:67], v[160:175]
    s_waitcnt lgkmcnt(0)
    v_add_f32 v128, v128, v208
    v_add_f32 v129, v129, v209
    v_add_f32 v130, v130, v210
    v_add_f32 v131, v131, v211
    v_fma_f32 v128, v128, v14, v32
    v_mfma_f32_32x32x16_bf16 v[176:191], a[20:23], v[64:67], v[176:191]
    s_add_u32 s90, s89, 24576
    s_sub_u32 s66, s90, 28672
    s_cselect_b32 s90, s90, s66
    s_add_u32 s90, s90, s76
    buffer_load_dwordx4 v[112:115], v1, s[36:39], s90 offen sc1
    s_waitcnt vmcnt(11)
    v_mfma_f32_32x32x16_bf16 v[160:175], a[24:27], v[68:71], v[160:175]
    v_fma_f32 v129, v129, v14, v33
    v_fma_f32 v130, v130, v14, v34
    v_fma_f32 v131, v131, v14, v35
    v_cvt_pk_bf16_f32 v128, v128, v129
    v_cvt_pk_bf16_f32 v129, v130, v131
    v_mfma_f32_32x32x16_bf16 v[176:191], a[28:31], v[68:71], v[176:191]
    buffer_load_dwordx4 v[64:67], v1, s[36:39], s90 offen offset:1024 sc1
    s_waitcnt vmcnt(11)
    v_mfma_f32_32x32x16_bf16 v[160:175], a[32:35], v[72:75], v[160:175]
    v_add_f32 v132, v132, v196
    v_add_f32 v133, v133, v197
    v_add_f32 v134, v134, v198
    v_add_f32 v135, v135, v199
    v_add_f32 v132, v132, v204
    v_mfma_f32_32x32x16_bf16 v[176:191], a[36:39], v[72:75], v[176:191]
    buffer_load_dwordx4 v[68:71], v1, s[36:39], s90 offen offset:2048 sc1
    s_waitcnt vmcnt(11)
    v_mfma_f32_32x32x16_bf16 v[160:175], a[40:43], v[76:79], v[160:175]
    v_add_f32 v133, v133, v205
    v_add_f32 v134, v134, v206
    v_add_f32 v135, v135, v207
    v_add_f32 v132, v132, v212
    v_add_f32 v133, v133, v213
    v_mfma_f32_32x32x16_bf16 v[176:191], a[44:47], v[76:79], v[176:191]
    buffer_load_dwordx4 v[72:75], v1, s[36:39], s90 offen offset:3072 sc1
    s_waitcnt vmcnt(11)
    v_mfma_f32_32x32x16_bf16 v[160:175], a[64:67], v[80:83], v[160:175]
    v_add_f32 v134, v134, v214
    v_add_f32 v135, v135, v215
    v_fma_f32 v132, v132, v14, v36
    v_fma_f32 v133, v133, v14, v37
    v_fma_f32 v134, v134, v14, v38
    v_mfma_f32_32x32x16_bf16 v[176:191], a[68:71], v[80:83], v[176:191]
    s_waitcnt vmcnt(10)
    v_mfma_f32_32x32x16_bf16 v[160:175], a[72:75], v[84:87], v[160:175]
    v_fma_f32 v135, v135, v14, v39
    v_cvt_pk_bf16_f32 v130, v132, v133
    v_cvt_pk_bf16_f32 v131, v134, v135
    v_mfma_f32_32x32x16_bf16 v[176:191], a[76:79], v[84:87], v[176:191]
    buffer_store_dwordx4 v[128:131], v5, s[32:35], s6 offen
    s_waitcnt vmcnt(10)
    v_mfma_f32_32x32x16_bf16 v[160:175], a[80:83], v[88:91], v[160:175]
    v_mfma_f32_32x32x16_bf16 v[176:191], a[84:87], v[88:91], v[176:191]
    s_waitcnt vmcnt(9)
    v_mfma_f32_32x32x16_bf16 v[160:175], a[88:91], v[92:95], v[160:175]
    s_or_b32 s54, s45, s43
    s_cbranch_scc0 L_fin_63
L_fin_64:
    v_mfma_f32_32x32x16_bf16 v[176:191], a[92:95], v[92:95], v[176:191]
    s_waitcnt vmcnt(8)
    v_mfma_f32_32x32x16_bf16 v[176:191], a[100:103], v[96:99], v[176:191]
    s_waitcnt vmcnt(7)
    v_mfma_f32_32x32x16_bf16 v[176:191], a[108:111], v[100:103], v[176:191]
    s_waitcnt vmcnt(6)
    v_mfma_f32_32x32x16_bf16 v[176:191], a[116:119], v[104:107], v[176:191]
    s_waitcnt vmcnt(5)
    v_mfma_f32_32x32x16_bf16 v[176:191], a[124:127], v[108:111], v[176:191]
    s_waitcnt vmcnt(4)
    v_mfma_f32_32x32x16_bf16 v[176:191], a[132:135], v[112:115], v[176:191]
    s_waitcnt vmcnt(3)
    v_mfma_f32_32x32x16_bf16 v[176:191], a[140:143], v[64:67], v[176:191]
    s_waitcnt vmcnt(2)
    v_mfma_f32_32x32x16_bf16 v[176:191], a[148:151], v[68:71], v[176:191]
    s_waitcnt vmcnt(1)
    v_mfma_f32_32x32x16_bf16 v[176:191], a[156:159], v[72:75], v[176:191]
    v_mfma_f32_32x32x16_bf16 v[160:175], a[96:99], v[96:99], v[160:175]
    v_mfma_f32_32x32x16_bf16 v[160:175], a[104:107], v[100:103], v[160:175]
    v_mfma_f32_32x32x16_bf16 v[160:175], a[112:115], v[104:107], v[160:175]
    s_nop 8
    ds_write_b128 v12, v[176:179] offset:36864
    v_mfma_f32_32x32x16_bf16 v[160:175], a[120:123], v[108:111], v[160:175]
    v_mfma_f32_32x32x16_bf16 v[160:175], a[128:131], v[112:115], v[160:175]
    ds_write_b128 v12, v[180:183] offset:37888
    v_mfma_f32_32x32x16_bf16 v[160:175], a[136:139], v[64:67], v[160:175]
    ds_write_b128 v13, v[184:187] offset:38912
    v_mfma_f32_32x32x16_bf16 v[160:175], a[144:147], v[68:71], v[160:175]
    v_mfma_f32_32x32x16_bf16 v[160:175], a[152:155], v[72:75], v[160:175]
    ds_write_b128 v13, v[188:191] offset:39936
    s_nop 10
    ds_write_b128 v11, v[168:171] offset:34816
    ds_write_b128 v11, v[172:175] offset:35840
    s_waitcnt lgkmcnt(0)
    s_barrier
    ds_read_b128 v[192:195], v10 offset:34816
    ds_read_b128 v[200:203], v10 offset:36864
    ds_read_b128 v[208:211], v10 offset:38912
    ds_read_b128 v[196:199], v10 offset:35840
    ds_read_b128 v[204:207], v10 offset:37888
    ds_read_b128 v[212:215], v10 offset:39936
    s_waitcnt lgkmcnt(5)
    v_add_f32 v160, v160, v192
    v_add_f32 v161, v161, v193
    v_add_f32 v162, v162, v194
    v_add_f32 v163, v163, v195
    s_waitcnt lgkmcnt(4)
    v_add_f32 v160, v160, v200
    v_add_f32 v161, v161, v201
    v_add_f32 v162, v162, v202
    v_add_f32 v163, v163, v203
    s_waitcnt lgkmcnt(3)
    v_add_f32 v160, v160, v208
    v_add_f32 v161, v161, v209
    v_add_f32 v162, v162, v210
    v_add_f32 v163, v163, v211
    v_fma_f32 v160, v160, v15, v40
    v_fma_f32 v161, v161, v15, v41
    v_fma_f32 v162, v162, v15, v42
    v_fma_f32 v163, v163, v15, v43
    v_cvt_pk_bf16_f32 v160, v160, v161
    v_cvt_pk_bf16_f32 v161, v162, v163
    s_waitcnt lgkmcnt(2)
    v_add_f32 v164, v164, v196
    v_add_f32 v165, v165, v197
    v_add_f32 v166, v166, v198
    v_add_f32 v167, v167, v199
    s_waitcnt lgkmcnt(1)
    v_add_f32 v164, v164, v204
    v_add_f32 v165, v165, v205
    v_add_f32 v166, v166, v206
    v_add_f32 v167, v167, v207
    s_waitcnt lgkmcnt(0)
    v_add_f32 v164, v164, v212
    v_add_f32 v165, v165, v213
    v_add_f32 v166, v166, v214
    v_add_f32 v167, v167, v215
    v_fma_f32 v164, v164, v15, v44
    v_fma_f32 v165, v165, v15, v45
    v_fma_f32 v166, v166, v15, v46
    v_fma_f32 v167, v167, v15, v47
    v_cvt_pk_bf16_f32 v162, v164, v165
    v_cvt_pk_bf16_f32 v163, v166, v167
    buffer_store_dwordx4 v[160:163], v5, s[32:35], s57 offen
L_fin:
L_end:
    s_endpgm
L_spare:
    s_waitcnt vmcnt(0)
    s_cmp_lg_u32 s51, 0
    s_cbranch_scc1 L_rel_68
    buffer_store_dwordx2 v[124:125], v2, s[36:39], s73 offen offset:768
L_reld_69:
    s_lshl_b32 s54, s40, 2
    s_add_u32 s54, s54, s45
    s_sub_u32 s54, s54, 28
    s_and_b32 s55, s43, 1
    s_lshl_b32 s78, s54, 3
    s_add_u32 s78, s78, s55
    s_lshl_b32 s78, s78, 8
    s_add_u32 s78, s78, 15728640
    s_lshl_b32 s54, s54, 1
    s_add_u32 s54, s54, s55
    s_lshl_b32 s3, s54, 15
    s_lshr_b32 s55, s43, 1
    s_lshl_b32 s55, s55, 14
    s_add_u32 s3, s3, s55
    s_add_u32 s3, s3, 6291456
    s_and_b32 s54, s54, 7
    s_lshl_b32 s54, s54, 3
    s_lshl_b32 s5, s40, 7
    s_add_u32 s5, s5, s54
    s_add_u32 s5, s5, 15794176
    s_barrier
    v_lshrrev_b32 v32, 2, v0
    v_and_b32 v33, 3, v0
    v_lshlrev_b32 v33, 7, v33
    v_lshl_add_u32 v32, v32, 10, v33
    s_sub_u32 s54, s45, 28
    s_lshl_b32 s54, s54, 14
    v_add_u32 v32, s54, v32
    s_add_u32 m0, s53, 131072
    s_add_u32 s67, s89, 0
    s_lshl_b32 s67, s67, 4
    s_add_u32 s67, s67, s75
    s_and_b32 s55, s67, 0xfffffc00
    buffer_load_dword v34, v32, s[28:31], s55 offen
    buffer_load_dwordx4 v6, s[28:31], s67 offen lds
    buffer_load_dwordx4 v7, s[28:31], s67 offen offset:1024 lds
    buffer_load_dwordx4 v8, s[28:31], s67 offen offset:2048 lds
    buffer_load_dwordx4 v9, s[28:31], s67 offen offset:3072 lds
    s_add_u32 m0, s53, 147456
    s_add_u32 s67, s67, 32768
    buffer_load_dwordx4 v6, s[28:31], s67 offen lds
    buffer_load_dwordx4 v7, s[28:31], s67 offen offset:1024 lds
    buffer_load_dwordx4 v8, s[28:31], s67 offen offset:2048 lds
    buffer_load_dwordx4 v9, s[28:31], s67 offen offset:3072 lds
    buffer_load_dwordx2 v[22:23], v19, s[36:39], s78 offen offset:512 sc1
    s_waitcnt vmcnt(0)
    v_cmp_ne_u64 vcc, s[46:47], v[22:23]
    s_nop 0
    s_cbranch_vccz L_ok_70
L_spin_71:
    buffer_load_dwordx2 v[22:23], v19, s[36:39], s78 offen offset:512 sc1
    s_sub_u32 s52, s52, 1
    s_cbranch_scc1 L_abort
    s_waitcnt vmcnt(0)
    v_cmp_ne_u64 vcc, s[46:47], v[22:23]
    s_nop 0
    s_cbranch_vccnz L_spin_71
L_ok_70:
    s_add_u32 s56, s3, 0
    buffer_load_dwordx4 v[128:131], v1, s[36:39], s56 offen sc1
    buffer_load_dwordx4 v[132:135], v1, s[36:39], s56 offen offset:1024 sc1
    buffer_load_dwordx4 v[136:139], v1, s[36:39], s56 offen offset:2048 sc1
    buffer_load_dwordx4 v[140:143], v1, s[36:39], s56 offen offset:3072 sc1
    s_add_u32 s56, s3, 4096
    buffer_load_dwordx4 v[144:147], v1, s[36:39], s56 offen sc1
    buffer_load_dwordx4 v[148:151], v1, s[36:39], s56 offen offset:1024 sc1
    buffer_load_dwordx4 v[152:155], v1, s[36:39], s56 offen offset:2048 sc1
    buffer_load_dwordx4 v[156:159], v1, s[36:39], s56 offen offset:3072 sc1
    s_add_u32 s56, s3, 8192
    buffer_load_dwordx4 v[160:163], v1, s[36:39], s56 offen sc1
    buffer_load_dwordx4 v[164:167], v1, s[36:39], s56 offen offset:1024 sc1
    buffer_load_dwordx4 v[168:171], v1, s[36:39], s56 offen offset:2048 sc1
    buffer_load_dwordx4 v[172:175], v1, s[36:39], s56 offen offset:3072 sc1
    s_add_u32 s56, s3, 12288
    buffer_load_dwordx4 v[176:179], v1, s[36:39], s56 offen sc1
    buffer_load_dwordx4 v[180:183], v1, s[36:39], s56 offen offset:1024 sc1
    buffer_load_dwordx4 v[184:187], v1, s[36:39], s56 offen offset:2048 sc1
    buffer_load_dwordx4 v[188:191], v1, s[36:39], s56 offen offset:3072 sc1
    v_mov_b32 v112, 0
    v_mov_b32 v113, 0
    s_waitcnt vmcnt(15)
    v_mfma_f32_16x16x32_bf16 v[116:119], v[120:123], v[128:131], 0
    s_waitcnt vmcnt(14)
    v_mfma_f32_16x16x32_bf16 v[116:119], v[120:123], v[132:135], v[116:119]
    s_waitcnt vmcnt(13)
    v_mfma_f32_16x16x32_bf16 v[116:119], v[120:123], v[136:139], v[116:119]
    s_waitcnt vmcnt(12)
    v_mfma_f32_16x16x32_bf16 v[116:119], v[120:123], v[140:143], v[116:119]
    s_waitcnt vmcnt(11)
    v_mfma_f32_16x16x32_bf16 v[116:119], v[120:123], v[144:147], v[116:119]
    s_waitcnt vmcnt(10)
    v_mfma_f32_16x16x32_bf16 v[116:119], v[120:123], v[148:151], v[116:119]
    s_waitcnt vmcnt(9)
    v_mfma_f32_16x16x32_bf16 v[116:119], v[120:123], v[152:155], v[116:119]
    s_waitcnt vmcnt(8)
    v_mfma_f32_16x16x32_bf16 v[116:119], v[120:123], v[156:159], v[116:119]
    s_waitcnt vmcnt(7)
    v_mfma_f32_16x16x32_bf16 v[116:119], v[120:123], v[160:163], v[116:119]
    s_waitcnt vmcnt(6)
    v_mfma_f32_16x16x32_bf16 v[116:119], v[120:123], v[164:167], v[116:119]
    s_waitcnt vmcnt(5)
    v_mfma_f32_16x16x32_bf16 v[116:119], v[120:123], v[168:171], v[116:119]
    s_waitcnt vmcnt(4)
    v_mfma_f32_16x16x32_bf16 v[116:119], v[120:123], v[172:175], v[116:119]
    s_waitcnt vmcnt(3)
    v_mfma_f32_16x16x32_bf16 v[116:119], v[120:123], v[176:179], v[116:119]
    s_waitcnt vmcnt(2)
    v_mfma_f32_16x16x32_bf16 v[116:119], v[120:123], v[180:183], v[116:119]
    s_waitcnt vmcnt(1)
    v_mfma_f32_16x16x32_bf16 v[116:119], v[120:123], v[184:187], v[116:119]
    s_waitcnt vmcnt(0)
    v_mfma_f32_16x16x32_bf16 v[116:119], v[120:123], v[188:191], v[116:119]
    v_dot2c_f32_bf16 v112, v128, v128
    v_dot2c_f32_bf16 v113, v129, v129
    v_dot2c_f32_bf16 v112, v130, v130
    v_dot2c_f32_bf16 v113, v131, v131
    v_dot2c_f32_bf16 v112, v132, v132
    v_dot2c_f32_bf16 v113, v133, v133
    v_dot2c_f32_bf16 v112, v134, v134
    v_dot2c_f32_bf16 v113, v135, v135
    v_dot2c_f32_bf16 v112, v136, v136
    v_dot2c_f32_bf16 v113, v137, v137
    v_dot2c_f32_bf16 v112, v138, v138
    v_dot2c_f32_bf16 v113, v139, v139
    v_dot2c_f32_bf16 v112, v140, v140
    v_dot2c_f32_bf16 v113, v141, v141
    v_dot2c_f32_bf16 v112, v142, v142
    v_dot2c_f32_bf16 v113, v143, v143
    v_dot2c_f32_bf16 v112, v144, v144
    v_dot2c_f32_bf16 v113, v145, v145
    v_dot2c_f32_bf16 v112, v146, v146
    v_dot2c_f32_bf16 v113, v147, v147
    v_dot2c_f32_bf16 v112, v148, v148
    v_dot2c_f32_bf16 v113, v149, v149
    v_dot2c_f32_bf16 v112, v150, v150
    v_dot2c_f32_bf16 v113, v151, v151
    v_dot2c_f32_bf16 v112, v152, v152
    v_dot2c_f32_bf16 v113, v153, v153
    v_dot2c_f32_bf16 v112, v154, v154
    v_dot2c_f32_bf16 v113, v155, v155
    v_dot2c_f32_bf16 v112, v156, v156
    v_dot2c_f32_bf16 v113, v157, v157
    v_dot2c_f32_bf16 v112, v158, v158
    v_dot2c_f32_bf16 v113, v159, v159
    v_dot2c_f32_bf16 v112, v160, v160
    v_dot2c_f32_bf16 v113, v161, v161
    v_dot2c_f32_bf16 v112, v162, v162
    v_dot2c_f32_bf16 v113, v163, v163
    v_dot2c_f32_bf16 v112, v164, v164
    v_dot2c_f32_bf16 v113, v165, v165
    v_dot2c_f32_bf16 v112, v166, v166
    v_dot2c_f32_bf16 v113, v167, v167
    v_dot2c_f32_bf16 v112, v168, v168
    v_dot2c_f32_bf16 v113, v169, v169
    v_dot2c_f32_bf16 v112, v170, v170
    v_dot2c_f32_bf16 v113, v171, v171
    v_dot2c_f32_bf16 v112, v172, v172
    v_dot2c_f32_bf16 v113, v173, v173
    v_dot2c_f32_bf16 v112, v174, v174
    v_dot2c_f32_bf16 v113, v175, v175
    v_dot2c_f32_bf16 v112, v176, v176
    v_dot2c_f32_bf16 v113, v177, v177
    v_dot2c_f32_bf16 v112, v178, v178
    v_dot2c_f32_bf16 v113, v179, v179
    v_dot2c_f32_bf16 v112, v180, v180
    v_dot2c_f32_bf16 v113, v181, v181
    v_dot2c_f32_bf16 v112, v182, v182
    v_dot2c_f32_bf16 v113, v183, v183
    v_dot2c_f32_bf16 v112, v184, v184
    v_dot2c_f32_bf16 v113, v185, v185
    v_dot2c_f32_bf16 v112, v186, v186
    v_dot2c_f32_bf16 v113, v187, v187
    v_dot2c_f32_bf16 v112, v188, v188
    v_dot2c_f32_bf16 v113, v189, v189
    v_dot2c_f32_bf16 v112, v190, v190
    v_dot2c_f32_bf16 v113, v191, v191
    s_nop 2
    v_add_f32 v112, v112, v113
    v_mov_b32 v113, v112
    s_nop 1
    v_permlane32_swap_b32 v112, v113
    v_add_f32 v117, v112, v113
    s_lshl_b32 s54, s43, 9
    s_add_u32 s54, s54, 0
    v_lshl_add_u32 v20, v0, 3, s54
    ds_write_b64 v20, v[116:117]
    s_waitcnt lgkmcnt(0)
    s_barrier
    v_xor_b32 v20, 1024, v20
    ds_read_b64 v[112:113], v20
    s_waitcnt lgkmcnt(0)
    v_add_f32 v116, v116, v112
    v_add_f32 v117, v117, v113
    v_mul_f32 v116, 0.001953125, v116
    v_mul_f32 v117, 0.001953125, v117
    v_fma_f32 v117, -v116, v116, v117
    v_max_f32 v117, 0, v117
    v_add_f32 v117, 0x3727c5ac, v117
    v_rcp_f32 v117, v117
    v_mul_f32 v116, -0.5, v116
    buffer_store_dwordx2 v[116:117], v19, s[36:39], s78 offen offset:1536 sc1
    s_waitcnt vmcnt(0)
    s_cmp_lg_u32 s51, 0
    s_cbranch_scc1 L_rel_72
    buffer_store_dwordx2 v[124:125], v2, s[36:39], s5 offen
L_reld_73:
    v_and_b32 v33, 0x180, v32
    v_max_u32 v33, 384, v33
    v_and_b32 v32, 0xfffffe7f, v32
    v_or_b32 v32, v32, v33
    s_add_u32 m0, s53, 98304
    s_add_u32 s67, s89, 4096
    s_sub_u32 s66, s67, 28672
    s_cselect_b32 s67, s67, s66
    s_lshl_b32 s67, s67, 4
    s_add_u32 s67, s67, s75
    s_and_b32 s55, s67, 0xfffffc00
    buffer_load_dword v35, v32, s[28:31], s55 offen
    buffer_load_dwordx4 v6, s[28:31], s67 offen lds
    buffer_load_dwordx4 v7, s[28:31], s67 offen offset:1024 lds
    buffer_load_dwordx4 v8, s[28:31], s67 offen offset:2048 lds
    buffer_load_dwordx4 v9, s[28:31], s67 offen offset:3072 lds
    s_add_u32 m0, s53, 114688
    s_add_u32 s67, s67, 32768
    buffer_load_dwordx4 v6, s[28:31], s67 offen lds
    buffer_load_dwordx4 v7, s[28:31], s67 offen offset:1024 lds
    buffer_load_dwordx4 v8, s[28:31], s67 offen offset:2048 lds
    buffer_load_dwordx4 v9, s[28:31], s67 offen offset:3072 lds
    v_xor_b32 v17, 131072, v17
    v_xor_b32 v18, 131072, v18
    ds_read_b64_tr_b16 a[0:1], v17 offset:0
    ds_read_b64_tr_b16 a[2:3], v17 offset:512
    ds_read_b64_tr_b16 a[4:5], v18 offset:0
    ds_read_b64_tr_b16 a[6:7], v18 offset:512
    ds_read_b64_tr_b16 a[8:9], v17 offset:2048
    ds_read_b64_tr_b16 a[10:11], v17 offset:2560
    ds_read_b64_tr_b16 a[12:13], v18 offset:2048
    ds_read_b64_tr_b16 a[14:15], v18 offset:2560
    s_waitcnt lgkmcnt(0)
    s_add_u32 m0, s53, 131072
    s_add_u32 s67, s89, 8192
    s_sub_u32 s66, s67, 28672
    s_cselect_b32 s67, s67, s66
    s_lshl_b32 s67, s67, 4
    s_add_u32 s67, s67, s75
    s_and_b32 s55, s67, 0xfffffc00
    buffer_load_dword v36, v32, s[28:31], s55 offen
    buffer_load_dwordx4 v6, s[28:31], s67 offen lds
    buffer_load_dwordx4 v7, s[28:31], s67 offen offset:1024 lds
    buffer_load_dwordx4 v8, s[28:31], s67 offen offset:2048 lds
    buffer_load_dwordx4 v9, s[28:31], s67 offen offset:3072 lds
    ds_read_b64_tr_b16 a[192:193], v17 offset:16384
    ds_read_b64_tr_b16 a[194:195], v17 offset:16896
    ds_read_b64_tr_b16 a[196:197], v18 offset:16384
    ds_read_b64_tr_b16 a[198:199], v18 offset:16896
    ds_read_b64_tr_b16 a[200:201], v17 offset:18432
    ds_read_b64_tr_b16 a[202:203], v17 offset:18944
    ds_read_b64_tr_b16 a[204:205], v18 offset:18432
    ds_read_b64_tr_b16 a[206:207], v18 offset:18944
    s_waitcnt lgkmcnt(0)
    s_add_u32 m0, s53, 147456
    s_add_u32 s67, s67, 32768
    buffer_load_dwordx4 v6, s[28:31], s67 offen lds
    buffer_load_dwordx4 v7, s[28:31], s67 offen offset:1024 lds
    buffer_load_dwordx4 v8, s[28:31], s67 offen offset:2048 lds
    buffer_load_dwordx4 v9, s[28:31], s67 offen offset:3072 lds
    v_xor_b32 v17, 196608, v17
    v_xor_b32 v18, 196608, v18
    s_waitcnt vmcnt(13)
    ds_read_b64_tr_b16 a[208:209], v17 offset:32768
    ds_read_b64_tr_b16 a[210:211], v17 offset:33280
    ds_read_b64_tr_b16 a[212:213], v18 offset:32768
    ds_read_b64_tr_b16 a[214:215], v18 offset:33280
    ds_read_b64_tr_b16 a[216:217], v17 offset:34816
    ds_read_b64_tr_b16 a[218:219], v17 offset:35328
    ds_read_b64_tr_b16 a[220:221], v18 offset:34816
    ds_read_b64_tr_b16 a[222:223], v18 offset:35328
    s_waitcnt lgkmcnt(0)
    s_add_u32 m0, s53, 98304
    s_add_u32 s67, s89, 12288
    s_sub_u32 s66, s67, 28672
    s_cselect_b32 s67, s67, s66
    s_lshl_b32 s67, s67, 4
    s_add_u32 s67, s67, s75
    s_and_b32 s55, s67, 0xfffffc00
    buffer_load_dword v37, v32, s[28:31], s55 offen
    buffer_load_dwordx4 v6, s[28:31], s67 offen lds
    buffer_load_dwordx4 v7, s[28:31], s67 offen offset:1024 lds
    buffer_load_dwordx4 v8, s[28:31], s67 offen offset:2048 lds
    buffer_load_dwordx4 v9, s[28:31], s67 offen offset:3072 lds
    s_waitcnt vmcnt(14)
    ds_read_b64_tr_b16 a[224:225], v17 offset:49152
    ds_read_b64_tr_b16 a[226:227], v17 offset:49664
    ds_read_b64_tr_b16 a[228:229], v18 offset:49152
    ds_read_b64_tr_b16 a[230:231], v18 offset:49664
    ds_read_b64_tr_b16 a[232:233], v17 offset:51200
    ds_read_b64_tr_b16 a[234:235], v17 offset:51712
    ds_read_b64_tr_b16 a[236:237], v18 offset:51200
    ds_read_b64_tr_b16 a[238:239], v18 offset:51712
    s_waitcnt lgkmcnt(0)
    s_add_u32 m0, s53, 114688
    s_add_u32 s67, s67, 32768
    buffer_load_dwordx4 v6, s[28:31], s67 offen lds
    buffer_load_dwordx4 v7, s[28:31], s67 offen offset:1024 lds
    buffer_load_dwordx4 v8, s[28:31], s67 offen offset:2048 lds
    buffer_load_dwordx4 v9, s[28:31], s67 offen offset:3072 lds
    v_xor_b32 v17, 196608, v17
    v_xor_b32 v18, 196608, v18
    s_waitcnt vmcnt(13)
    ds_read_b64_tr_b16 a[240:241], v17 offset:0
    ds_read_b64_tr_b16 a[242:243], v17 offset:512
    ds_read_b64_tr_b16 a[244:245], v18 offset:0
    ds_read_b64_tr_b16 a[246:247], v18 offset:512
    ds_read_b64_tr_b16 a[248:249], v17 offset:2048
    ds_read_b64_tr_b16 a[250:251], v17 offset:2560
    ds_read_b64_tr_b16 a[252:253], v18 offset:2048
    ds_read_b64_tr_b16 a[254:255], v18 offset:2560
    s_waitcnt lgkmcnt(0)
    s_add_u32 m0, s53, 131072
    s_add_u32 s67, s89, 16384
    s_sub_u32 s66, s67, 28672
    s_cselect_b32 s67, s67, s66
    s_lshl_b32 s67, s67, 4
    s_add_u32 s67, s67, s75
    s_and_b32 s55, s67, 0xfffffc00
    buffer_load_dword v38, v32, s[28:31], s55 offen
    buffer_load_dwordx4 v6, s[28:31], s67 offen lds
    buffer_load_dwordx4 v7, s[28:31], s67 offen offset:1024 lds
    buffer_load_dwordx4 v8, s[28:31], s67 offen offset:2048 lds
    buffer_load_dwordx4 v9, s[28:31], s67 offen offset:3072 lds
    s_waitcnt vmcnt(14)
    ds_read_b64_tr_b16 a[48:49], v17 offset:16384
    ds_read_b64_tr_b16 a[50:51], v17 offset:16896
    ds_read_b64_tr_b16 a[52:53], v18 offset:16384
    ds_read_b64_tr_b16 a[54:55], v18 offset:16896
    ds_read_b64_tr_b16 a[56:57], v17 offset:18432
    ds_read_b64_tr_b16 a[58:59], v17 offset:18944
    ds_read_b64_tr_b16 a[60:61], v18 offset:18432
    ds_read_b64_tr_b16 a[62:63], v18 offset:18944
    s_waitcnt lgkmcnt(0)
    s_add_u32 m0, s53, 147456
    s_add_u32 s67, s67, 32768
    buffer_load_dwordx4 v6, s[28:31], s67 offen lds
    buffer_load_dwordx4 v7, s[28:31], s67 offen offset:1024 lds
    buffer_load_dwordx4 v8, s[28:31], s67 offen offset:2048 lds
    buffer_load_dwordx4 v9, s[28:31], s67 offen offset:3072 lds
    v_xor_b32 v17, 196608, v17
    v_xor_b32 v18, 196608, v18
    s_waitcnt vmcnt(13)
    ds_read_b64_tr_b16 a[16:17], v17 offset:32768
    ds_read_b64_tr_b16 a[18:19], v17 offset:33280
    ds_read_b64_tr_b16 a[20:21], v18 offset:32768
    ds_read_b64_tr_b16 a[22:23], v18 offset:33280
    ds_read_b64_tr_b16 a[24:25], v17 offset:34816
    ds_read_b64_tr_b16 a[26:27], v17 offset:35328
    ds_read_b64_tr_b16 a[28:29], v18 offset:34816
    ds_read_b64_tr_b16 a[30:31], v18 offset:35328
    s_waitcnt lgkmcnt(0)
    s_add_u32 m0, s53, 98304
    s_add_u32 s67, s89, 20480
    s_sub_u32 s66, s67, 28672
    s_cselect_b32 s67, s67, s66
    s_lshl_b32 s67, s67, 4
    s_add_u32 s67, s67, s75
    s_and_b32 s55, s67, 0xfffffc00
    buffer_load_dword v39, v32, s[28:31], s55 offen
    buffer_load_dwordx4 v6, s[28:31], s67 offen lds
    buffer_load_dwordx4 v7, s[28:31], s67 offen offset:1024 lds
    buffer_load_dwordx4 v8, s[28:31], s67 offen offset:2048 lds
    buffer_load_dwordx4 v9, s[28:31], s67 offen offset:3072 lds
    s_waitcnt vmcnt(14)
    ds_read_b64_tr_b16 a[32:33], v17 offset:49152
    ds_read_b64_tr_b16 a[34:35], v17 offset:49664
    ds_read_b64_tr_b16 a[36:37], v18 offset:49152
    ds_read_b64_tr_b16 a[38:39], v18 offset:49664
    ds_read_b64_tr_b16 a[40:41], v17 offset:51200
    ds_read_b64_tr_b16 a[42:43], v17 offset:51712
    ds_read_b64_tr_b16 a[44:45], v18 offset:51200
    ds_read_b64_tr_b16 a[46:47], v18 offset:51712
    s_waitcnt lgkmcnt(0)
    s_add_u32 m0, s53, 114688
    s_add_u32 s67, s67, 32768
    buffer_load_dwordx4 v6, s[28:31], s67 offen lds
    buffer_load_dwordx4 v7, s[28:31], s67 offen offset:1024 lds
    buffer_load_dwordx4 v8, s[28:31], s67 offen offset:2048 lds
    buffer_load_dwordx4 v9, s[28:31], s67 offen offset:3072 lds
    v_xor_b32 v17, 196608, v17
    v_xor_b32 v18, 196608, v18
    s_waitcnt vmcnt(13)
    ds_read_b64_tr_b16 a[64:65], v17 offset:0
    ds_read_b64_tr_b16 a[66:67], v17 offset:512
    ds_read_b64_tr_b16 a[68:69], v18 offset:0
    ds_read_b64_tr_b16 a[70:71], v18 offset:512
    ds_read_b64_tr_b16 a[72:73], v17 offset:2048
    ds_read_b64_tr_b16 a[74:75], v17 offset:2560
    ds_read_b64_tr_b16 a[76:77], v18 offset:2048
    ds_read_b64_tr_b16 a[78:79], v18 offset:2560
    s_waitcnt lgkmcnt(0)
    s_add_u32 m0, s53, 131072
    s_add_u32 s67, s89, 24576
    s_sub_u32 s66, s67, 28672
    s_cselect_b32 s67, s67, s66
    s_lshl_b32 s67, s67, 4
    s_add_u32 s67, s67, s75
    s_and_b32 s55, s67, 0xfffffc00
    buffer_load_dword v40, v32, s[28:31], s55 offen
    buffer_load_dwordx4 v6, s[28:31], s67 offen lds
    buffer_load_dwordx4 v7, s[28:31], s67 offen offset:1024 lds
    buffer_load_dwordx4 v8, s[28:31], s67 offen offset:2048 lds
    buffer_load_dwordx4 v9, s[28:31], s67 offen offset:3072 lds
    s_waitcnt vmcnt(14)
    ds_read_b64_tr_b16 a[80:81], v17 offset:16384
    ds_read_b64_tr_b16 a[82:83], v17 offset:16896
    ds_read_b64_tr_b16 a[84:85], v18 offset:16384
    ds_read_b64_tr_b16 a[86:87], v18 offset:16896
    ds_read_b64_tr_b16 a[88:89], v17 offset:18432
    ds_read_b64_tr_b16 a[90:91], v17 offset:18944
    ds_read_b64_tr_b16 a[92:93], v18 offset:18432
    ds_read_b64_tr_b16 a[94:95], v18 offset:18944
    s_waitcnt lgkmcnt(0)
    s_add_u32 m0, s53, 147456
    s_add_u32 s67, s67, 32768
    buffer_load_dwordx4 v6, s[28:31], s67 offen lds
    buffer_load_dwordx4 v7, s[28:31], s67 offen offset:1024 lds
    buffer_load_dwordx4 v8, s[28:31], s67 offen offset:2048 lds
    buffer_load_dwordx4 v9, s[28:31], s67 offen offset:3072 lds
    v_xor_b32 v17, 196608, v17
    v_xor_b32 v18, 196608, v18
    s_waitcnt vmcnt(13)
    ds_read_b64_tr_b16 a[96:97], v17 offset:32768
    ds_read_b64_tr_b16 a[98:99], v17 offset:33280
    ds_read_b64_tr_b16 a[100:101], v18 offset:32768
    ds_read_b64_tr_b16 a[102:103], v18 offset:33280
    ds_read_b64_tr_b16 a[104:105], v17 offset:34816
    ds_read_b64_tr_b16 a[106:107], v17 offset:35328
    ds_read_b64_tr_b16 a[108:109], v18 offset:34816
    ds_read_b64_tr_b16 a[110:111], v18 offset:35328
    s_waitcnt vmcnt(9)
    ds_read_b64_tr_b16 a[112:113], v17 offset:49152
    ds_read_b64_tr_b16 a[114:115], v17 offset:49664
    ds_read_b64_tr_b16 a[116:117], v18 offset:49152
    ds_read_b64_tr_b16 a[118:119], v18 offset:49664
    ds_read_b64_tr_b16 a[120:121], v17 offset:51200
    ds_read_b64_tr_b16 a[122:123], v17 offset:51712
    ds_read_b64_tr_b16 a[124:125], v18 offset:51200
    ds_read_b64_tr_b16 a[126:127], v18 offset:51712
    v_xor_b32 v17, 196608, v17
    v_xor_b32 v18, 196608, v18
    s_waitcnt vmcnt(4)
    ds_read_b64_tr_b16 a[128:129], v17 offset:0
    ds_read_b64_tr_b16 a[130:131], v17 offset:512
    ds_read_b64_tr_b16 a[132:133], v18 offset:0
    ds_read_b64_tr_b16 a[134:135], v18 offset:512
    ds_read_b64_tr_b16 a[136:137], v17 offset:2048
    ds_read_b64_tr_b16 a[138:139], v17 offset:2560
    ds_read_b64_tr_b16 a[140:141], v18 offset:2048
    ds_read_b64_tr_b16 a[142:143], v18 offset:2560
    s_waitcnt vmcnt(0)
    ds_read_b64_tr_b16 a[144:145], v17 offset:16384
    ds_read_b64_tr_b16 a[146:147], v17 offset:16896
    ds_read_b64_tr_b16 a[148:149], v18 offset:16384
    ds_read_b64_tr_b16 a[150:151], v18 offset:16896
    ds_read_b64_tr_b16 a[152:153], v17 offset:18432
    ds_read_b64_tr_b16 a[154:155], v17 offset:18944
    ds_read_b64_tr_b16 a[156:157], v18 offset:18432
    ds_read_b64_tr_b16 a[158:159], v18 offset:18944
    v_min_u32 v20, 7, v0
    v_lshlrev_b32 v20, 3, v20
    s_lshl_b32 s58, s40, 7
    s_add_u32 s58, s58, 15794176
    buffer_load_dwordx2 v[22:23], v20, s[36:39], s58 offen sc1
    s_waitcnt vmcnt(0)
    v_cmp_ne_u64 vcc, s[46:47], v[22:23]
    s_nop 0
    s_cbranch_vccz L_ok_74
L_spin_75:
    buffer_load_dwordx2 v[22:23], v20, s[36:39], s58 offen sc1
    s_sub_u32 s52, s52, 1
    s_cbranch_scc1 L_abort
    s_waitcnt vmcnt(0)
    v_cmp_ne_u64 vcc, s[46:47], v[22:23]
    s_nop 0
    s_cbranch_vccnz L_spin_75
L_ok_74:
    buffer_load_dword v14, v19, s[36:39], s77 offen offset:1540 sc1
    buffer_load_dword v15, v19, s[36:39], s77 offen offset:1796 sc1
    s_waitcnt vmcnt(0) lgkmcnt(0)
    buffer_load_dwordx2 v[22:23], v16, s[36:39], s77 offen offset:1024 sc1
    s_waitcnt vmcnt(0)
    v_cmp_ne_u64 vcc, s[46:47], v[22:23]
    s_nop 0
    s_cbranch_vccz L_ok_76
L_spin_77:
    buffer_load_dwordx2 v[22:23], v16, s[36:39], s77 offen offset:1024 sc1
    s_sub_u32 s52, s52, 1
    s_cbranch_scc1 L_abort
    s_waitcnt vmcnt(0)
    v_cmp_ne_u64 vcc, s[46:47], v[22:23]
    s_nop 0
    s_cbranch_vccnz L_spin_77
L_ok_76:
    s_add_u32 s90, s89, 0
    s_add_u32 s90, s90, s76
    buffer_load_dwordx4 v[112:115], v1, s[36:39], s90 offen sc1
    buffer_load_dwordx4 v[64:67], v1, s[36:39], s90 offen offset:1024 sc1
    buffer_load_dwordx4 v[68:71], v1, s[36:39], s90 offen offset:2048 sc1
    buffer_load_dwordx4 v[72:75], v1, s[36:39], s90 offen offset:3072 sc1
    s_add_u32 s90, s89, 4096
    s_sub_u32 s66, s90, 28672
    s_cselect_b32 s90, s90, s66
    s_add_u32 s90, s90, s76
    buffer_load_dwordx4 v[76:79], v1, s[36:39], s90 offen sc1
    buffer_load_dwordx4 v[80:83], v1, s[36:39], s90 offen offset:1024 sc1
    buffer_load_dwordx4 v[84:87], v1, s[36:39], s90 offen offset:2048 sc1
    buffer_load_dwordx4 v[88:91], v1, s[36:39], s90 offen offset:3072 sc1
    s_add_u32 s90, s89, 8192
    s_sub_u32 s66, s90, 28672
    s_cselect_b32 s90, s90, s66
    s_add_u32 s90, s90, s76
    buffer_load_dwordx4 v[92:95], v1, s[36:39], s90 offen sc1
    buffer_load_dwordx4 v[96:99], v1, s[36:39], s90 offen offset:1024 sc1
    buffer_load_dwordx4 v[100:103], v1, s[36:39], s90 offen offset:2048 sc1
    s_waitcnt vmcnt(10)
    v_mfma_f32_32x32x16_bf16 v[128:143], a[0:3], v[112:115], 0
    buffer_load_dwordx4 v[104:107], v1, s[36:39], s90 offen offset:3072 sc1
    v_mfma_f32_32x32x16_bf16 v[144:159], a[4:7], v[112:115], 0
    s_add_u32 s90, s89, 12288
    s_sub_u32 s66, s90, 28672
    s_cselect_b32 s90, s90, s66
    s_add_u32 s90, s90, s76
    buffer_load_dwordx4 v[108:111], v1, s[36:39], s90 offen sc1
    s_waitcnt vmcnt(11)
    v_mfma_f32_32x32x16_bf16 v[128:143], a[8:11], v[64:67], v[128:143]
    v_mfma_f32_32x32x16_bf16 v[144:159], a[12:15], v[64:67], v[144:159]
    buffer_load_dwordx4 v[112:115], v1, s[36:39], s90 offen offset:1024 sc1
    s_waitcnt vmcnt(11)
    v_mfma_f32_32x32x16_bf16 v[128:143], a[192:195], v[68:71], v[128:143]
    v_mfma_f32_32x32x16_bf16 v[144:159], a[196:199], v[68:71], v[144:159]
    buffer_load_dwordx4 v[64:67], v1, s[36:39], s90 offen offset:2048 sc1
    s_waitcnt vmcnt(11)
    v_mfma_f32_32x32x16_bf16 v[128:143], a[200:203], v[72:75], v[128:143]
    v_mfma_f32_32x32x16_bf16 v[144:159], a[204:207], v[72:75], v[144:159]
    buffer_load_dwordx4 v[68:71], v1, s[36:39], s90 offen offset:3072 sc1
    s_waitcnt vmcnt(11)
    v_mfma_f32_32x32x16_bf16 v[128:143], a[208:211], v[76:79], v[128:143]
    v_mfma_f32_32x32x16_bf16 v[144:159], a[212:215], v[76:79], v[144:159]
    s_add_u32 s90, s89, 16384
    s_sub_u32 s66, s90, 28672
    s_cselect_b32 s90, s90, s66
    s_add_u32 s90, s90, s76
    buffer_load_dwordx4 v[72:75], v1, s[36:39], s90 offen sc1
    s_waitcnt vmcnt(11)
    v_mfma_f32_32x32x16_bf16 v[128:143], a[216:219], v[80:83], v[128:143]
    v_mfma_f32_32x32x16_bf16 v[144:159], a[220:223], v[80:83], v[144:159]
    buffer_load_dwordx4 v[76:79], v1, s[36:39], s90 offen offset:1024 sc1
    s_waitcnt vmcnt(11)
    v_mfma_f32_32x32x16_bf16 v[128:143], a[224:227], v[84:87], v[128:143]
    v_mfma_f32_32x32x16_bf16 v[144:159], a[228:231], v[84:87], v[144:159]
    buffer_load_dwordx4 v[80:83], v1, s[36:39], s90 offen offset:2048 sc1
    s_waitcnt vmcnt(11)
    v_mfma_f32_32x32x16_bf16 v[128:143], a[232:235], v[88:91], v[128:143]
    v_mfma_f32_32x32x16_bf16 v[144:159], a[236:239], v[88:91], v[144:159]
    buffer_load_dwordx4 v[84:87], v1, s[36:39], s90 offen offset:3072 sc1
    s_waitcnt vmcnt(11)
    v_mfma_f32_32x32x16_bf16 v[128:143], a[240:243], v[92:95], v[128:143]
    v_mfma_f32_32x32x16_bf16 v[144:159], a[244:247], v[92:95], v[144:159]
    s_add_u32 s90, s89, 20480
    s_sub_u32 s66, s90, 28672
    s_cselect_b32 s90, s90, s66
    s_add_u32 s90, s90, s76
    buffer_load_dwordx4 v[88:91], v1, s[36:39], s90 offen sc1
    s_waitcnt vmcnt(11)
    v_mfma_f32_32x32x16_bf16 v[128:143], a[248:251], v[96:99], v[128:143]
    buffer_load_dwordx2 v[22:23], v16, s[36:39], s77 offen offset:1280 sc1
    v_mfma_f32_32x32x16_bf16 v[144:159], a[252:255], v[96:99], v[144:159]
    buffer_load_dwordx4 v[92:95], v1, s[36:39], s90 offen offset:1024 sc1
    s_waitcnt vmcnt(12)
    v_mfma_f32_32x32x16_bf16 v[128:143], a[48:51], v[100:103], v[128:143]
    v_mfma_f32_32x32x16_bf16 v[144:159], a[52:55], v[100:103], v[144:159]
    buffer_load_dwordx4 v[96:99], v1, s[36:39], s90 offen offset:2048 sc1
    s_waitcnt vmcnt(12)
    v_mfma_f32_32x32x16_bf16 v[128:143], a[56:59], v[104:107], v[128:143]
    v_mfma_f32_32x32x16_bf16 v[144:159], a[60:63], v[104:107], v[144:159]
    buffer_load_dwordx4 v[100:103], v1, s[36:39], s90 offen offset:3072 sc1
    s_waitcnt vmcnt(12)
    v_mfma_f32_32x32x16_bf16 v[128:143], a[16:19], v[108:111], v[128:143]
    v_mfma_f32_32x32x16_bf16 v[144:159], a[20:23], v[108:111], v[144:159]
    s_add_u32 s90, s89, 24576
    s_sub_u32 s66, s90, 28672
    s_cselect_b32 s90, s90, s66
    s_add_u32 s90, s90, s76
    buffer_load_dwordx4 v[104:107], v1, s[36:39], s90 offen sc1
    s_waitcnt vmcnt(12)
    v_mfma_f32_32x32x16_bf16 v[128:143], a[24:27], v[112:115], v[128:143]
    v_mfma_f32_32x32x16_bf16 v[144:159], a[28:31], v[112:115], v[144:159]
    buffer_load_dwordx4 v[108:111], v1, s[36:39], s90 offen offset:1024 sc1
    s_waitcnt vmcnt(12)
    v_mfma_f32_32x32x16_bf16 v[128:143], a[32:35], v[64:67], v[128:143]
    v_mfma_f32_32x32x16_bf16 v[144:159], a[36:39], v[64:67], v[144:159]
    buffer_load_dwordx4 v[112:115], v1, s[36:39], s90 offen offset:2048 sc1
    s_waitcnt vmcnt(12)
    v_mfma_f32_32x32x16_bf16 v[128:143], a[40:43], v[68:71], v[128:143]
    v_mfma_f32_32x32x16_bf16 v[144:159], a[44:47], v[68:71], v[144:159]
    buffer_load_dwordx4 v[64:67], v1, s[36:39], s90 offen offset:3072 sc1
    s_waitcnt vmcnt(12)
    v_mfma_f32_32x32x16_bf16 v[128:143], a[64:67], v[72:75], v[128:143]
    v_mfma_f32_32x32x16_bf16 v[144:159], a[68:71], v[72:75], v[144:159]
    s_waitcnt vmcnt(11)
    v_mfma_f32_32x32x16_bf16 v[128:143], a[72:75], v[76:79], v[128:143]
    v_mfma_f32_32x32x16_bf16 v[144:159], a[76:79], v[76:79], v[144:159]
    s_waitcnt vmcnt(10)
    v_mfma_f32_32x32x16_bf16 v[128:143], a[80:83], v[80:83], v[128:143]
    v_mfma_f32_32x32x16_bf16 v[144:159], a[84:87], v[80:83], v[144:159]
    s_waitcnt vmcnt(9)
    v_mfma_f32_32x32x16_bf16 v[128:143], a[88:91], v[84:87], v[128:143]
    s_waitcnt vmcnt(7)
    v_cmp_ne_u64 vcc, s[46:47], v[22:23]
    s_nop 0
    s_cbranch_vccz L_ok_78
L_spin_79:
    buffer_load_dwordx2 v[22:23], v16, s[36:39], s77 offen offset:1280 sc1
    s_sub_u32 s52, s52, 1
    s_cbranch_scc1 L_abort
    s_waitcnt vmcnt(0)
    v_cmp_ne_u64 vcc, s[46:47], v[22:23]
    s_nop 0
    s_cbranch_vccnz L_spin_79
L_ok_78:
    v_mfma_f32_32x32x16_bf16 v[144:159], a[92:95], v[84:87], v[144:159]
    v_mfma_f32_32x32x16_bf16 v[128:143], a[96:99], v[88:91], v[128:143]
    s_add_u32 s90, s89, 0
    s_add_u32 s76, s76, 114688
    s_add_u32 s90, s90, s76
    buffer_load_dwordx4 v[68:71], v1, s[36:39], s90 offen sc1
    v_mfma_f32_32x32x16_bf16 v[144:159], a[100:103], v[88:91], v[144:159]
    buffer_load_dwordx4 v[72:75], v1, s[36:39], s90 offen offset:1024 sc1
    s_waitcnt vmcnt(8)
    v_mfma_f32_32x32x16_bf16 v[128:143], a[104:107], v[92:95], v[128:143]
    buffer_load_dwordx4 v[76:79], v1, s[36:39], s90 offen offset:2048 sc1
    v_mfma_f32_32x32x16_bf16 v[144:159], a[108:111], v[92:95], v[144:159]
    buffer_load_dwordx4 v[80:83], v1, s[36:39], s90 offen offset:3072 sc1
    s_waitcnt vmcnt(9)
    v_mfma_f32_32x32x16_bf16 v[128:143], a[112:115], v[96:99], v[128:143]
    s_add_u32 s90, s89, 4096
    s_sub_u32 s66, s90, 28672
    s_cselect_b32 s90, s90, s66
    s_add_u32 s90, s90, s76
    buffer_load_dwordx4 v[84:87], v1, s[36:39], s90 offen sc1
    v_mfma_f32_32x32x16_bf16 v[144:159], a[116:119], v[96:99], v[144:159]
    buffer_load_dwordx4 v[88:91], v1, s[36:39], s90 offen offset:1024 sc1
    s_waitcnt vmcnt(10)
    v_mfma_f32_32x32x16_bf16 v[128:143], a[120:123], v[100:103], v[128:143]
    buffer_load_dwordx4 v[92:95], v1, s[36:39], s90 offen offset:2048 sc1
    v_mfma_f32_32x32x16_bf16 v[144:159], a[124:127], v[100:103], v[144:159]
    buffer_load_dwordx4 v[96:99], v1, s[36:39], s90 offen offset:3072 sc1
    s_waitcnt vmcnt(11)
    v_mfma_f32_32x32x16_bf16 v[128:143], a[128:131], v[104:107], v[128:143]
    s_add_u32 s57, s6, 32768
    v_add_u32 v10, s84, v1
    v_xor_b32 v11, 8192, v10
    v_xor_b32 v12, 16384, v10
    v_xor_b32 v13, 24576, v10
    v_mfma_f32_32x32x16_bf16 v[144:159], a[132:135], v[104:107], v[144:159]
    s_add_u32 s90, s89, 8192
    s_sub_u32 s66, s90, 28672
    s_cselect_b32 s90, s90, s66
    s_add_u32 s90, s90, s76
    buffer_load_dwordx4 v[100:103], v1, s[36:39], s90 offen sc1
    s_waitcnt vmcnt(11)
    v_mfma_f32_32x32x16_bf16 v[128:143], a[136:139], v[108:111], v[128:143]
    v_lshlrev_b32 v32, 16, v24
    v_and_b32 v33, 0xffff0000, v24
    v_lshlrev_b32 v34, 16, v25
    v_and_b32 v35, 0xffff0000, v25
    v_lshlrev_b32 v36, 16, v26
    v_and_b32 v37, 0xffff0000, v26
    v_mfma_f32_32x32x16_bf16 v[144:159], a[140:143], v[108:111], v[144:159]
    buffer_load_dwordx4 v[104:107], v1, s[36:39], s90 offen offset:1024 sc1
    s_waitcnt vmcnt(11)
    v_lshlrev_b32 v38, 16, v27
    v_and_b32 v39, 0xffff0000, v27
    v_mfma_f32_32x32x16_bf16 v[128:143], a[144:147], v[112:115], v[128:143]
    v_lshlrev_b32 v40, 16, v28
    v_and_b32 v41, 0xffff0000, v28
    v_lshlrev_b32 v42, 16, v29
    v_and_b32 v43, 0xffff0000, v29
    v_lshlrev_b32 v44, 16, v30
    v_and_b32 v45, 0xffff0000, v30
    v_mfma_f32_32x32x16_bf16 v[144:159], a[148:151], v[112:115], v[144:159]
    buffer_load_dwordx4 v[108:111], v1, s[36:39], s90 offen offset:2048 sc1
    s_waitcnt vmcnt(11)
    v_lshlrev_b32 v46, 16, v31
    v_and_b32 v47, 0xffff0000, v31
    v_mfma_f32_32x32x16_bf16 v[128:143], a[152:155], v[64:67], v[128:143]
    v_mfma_f32_32x32x16_bf16 v[144:159], a[156:159], v[64:67], v[144:159]
    buffer_load_dwordx4 v[112:115], v1, s[36:39], s90 offen offset:3072 sc1
    s_waitcnt vmcnt(11)
    v_mfma_f32_32x32x16_bf16 v[160:175], a[0:3], v[68:71], 0
    v_mfma_f32_32x32x16_bf16 v[176:191], a[4:7], v[68:71], 0
    s_add_u32 s90, s89, 12288
    s_sub_u32 s66, s90, 28672
    s_cselect_b32 s90, s90, s66
    s_add_u32 s90, s90, s76
    buffer_load_dwordx4 v[64:67], v1, s[36:39], s90 offen sc1
    s_waitcnt vmcnt(11)
    v_mfma_f32_32x32x16_bf16 v[160:175], a[8:11], v[72:75], v[160:175]
    s_barrier
    v_mfma_f32_32x32x16_bf16 v[176:191], a[12:15], v[72:75], v[176:191]
    buffer_load_dwordx4 v[68:71], v1, s[36:39], s90 offen offset:1024 sc1
    s_waitcnt vmcnt(11)
    v_mfma_f32_32x32x16_bf16 v[160:175], a[192:195], v[76:79], v[160:175]
    ds_write_b128 v11, v[136:139] offset:2048
    v_mfma_f32_32x32x16_bf16 v[176:191], a[196:199], v[76:79], v[176:191]
    buffer_load_dwordx4 v[72:75], v1, s[36:39], s90 offen offset:2048 sc1
    s_waitcnt vmcnt(11)
    v_mfma_f32_32x32x16_bf16 v[160:175], a[200:203], v[80:83], v[160:175]
    ds_write_b128 v11, v[140:143] offset:3072
    v_mfma_f32_32x32x16_bf16 v[176:191], a[204:207], v[80:83], v[176:191]
    buffer_load_dwordx4 v[76:79], v1, s[36:39], s90 offen offset:3072 sc1
    s_waitcnt vmcnt(11)
    v_mfma_f32_32x32x16_bf16 v[160:175], a[208:211], v[84:87], v[160:175]
    ds_write_b128 v12, v[144:147] offset:4096
    v_mfma_f32_32x32x16_bf16 v[176:191], a[212:215], v[84:87], v[176:191]
    s_add_u32 s90, s89, 16384
    s_sub_u32 s66, s90, 28672
    s_cselect_b32 s90, s90, s66
    s_add_u32 s90, s90, s76
    buffer_load_dwordx4 v[80:83], v1, s[36:39], s90 offen sc1
    s_waitcnt vmcnt(11)
    v_mfma_f32_32x32x16_bf16 v[160:175], a[216:219], v[88:91], v[160:175]
    ds_write_b128 v12, v[148:151] offset:5120
    v_mfma_f32_32x32x16_bf16 v[176:191], a[220:223], v[88:91], v[176:191]
    buffer_load_dwordx4 v[84:87], v1, s[36:39], s90 offen offset:1024 sc1
    s_waitcnt vmcnt(11)
    v_mfma_f32_32x32x16_bf16 v[160:175], a[224:227], v[92:95], v[160:175]
    ds_write_b128 v13, v[152:155] offset:6144
    v_mfma_f32_32x32x16_bf16 v[176:191], a[228:231], v[92:95], v[176:191]
    buffer_load_dwordx4 v[88:91], v1, s[36:39], s90 offen offset:2048 sc1
    s_waitcnt vmcnt(11)
    v_mfma_f32_32x32x16_bf16 v[160:175], a[232:235], v[96:99], v[160:175]
    ds_write_b128 v13, v[156:159] offset:7168
    v_mfma_f32_32x32x16_bf16 v[176:191], a[236:239], v[96:99], v[176:191]
    buffer_load_dwordx4 v[92:95], v1, s[36:39], s90 offen offset:3072 sc1
    s_waitcnt vmcnt(11)
    v_mfma_f32_32x32x16_bf16 v[160:175], a[240:243], v[100:103], v[160:175]
    v_mfma_f32_32x32x16_bf16 v[176:191], a[244:247], v[100:103], v[176:191]
    s_add_u32 s90, s89, 20480
    s_sub_u32 s66, s90, 28672
    s_cselect_b32 s90, s90, s66
    s_add_u32 s90, s90, s76
    buffer_load_dwordx4 v[96:99], v1, s[36:39], s90 offen sc1
    s_waitcnt vmcnt(11)
    v_mfma_f32_32x32x16_bf16 v[160:175], a[248:251], v[104:107], v[160:175]
    s_waitcnt lgkmcnt(0)
    s_barrier
    ds_read_b128 v[192:195], v10 offset:2048
    ds_read_b128 v[200:203], v10 offset:4096
    v_mfma_f32_32x32x16_bf16 v[176:191], a[252:255], v[104:107], v[176:191]
    ds_read_b128 v[208:211], v10 offset:6144
    s_waitcnt vmcnt(10)
    buffer_load_dwordx4 v[100:103], v1, s[36:39], s90 offen offset:1024 sc1
    ds_read_b128 v[196:199], v10 offset:3072
    v_mfma_f32_32x32x16_bf16 v[160:175], a[48:51], v[108:111], v[160:175]
    ds_read_b128 v[204:207], v10 offset:5120
    s_waitcnt lgkmcnt(4)
    v_add_f32 v128, v128, v192
    ds_read_b128 v[212:215], v10 offset:7168
    v_mfma_f32_32x32x16_bf16 v[176:191], a[52:55], v[108:111], v[176:191]
    buffer_load_dwordx4 v[104:107], v1, s[36:39], s90 offen offset:2048 sc1
    s_waitcnt vmcnt(11)
    v_add_f32 v129, v129, v193
    v_add_f32 v130, v130, v194
    v_mfma_f32_32x32x16_bf16 v[160:175], a[56:59], v[112:115], v[160:175]
    v_add_f32 v131, v131, v195
    s_waitcnt lgkmcnt(4)
    v_add_f32 v128, v128, v200
    v_add_f32 v129, v129, v201
    v_add_f32 v130, v130, v202
    v_add_f32 v131, v131, v203
    v_mfma_f32_32x32x16_bf16 v[176:191], a[60:63], v[112:115], v[176:191]
    buffer_load_dwordx4 v[108:111], v1, s[36:39], s90 offen offset:3072 sc1
    s_waitcnt vmcnt(11)
    v_mfma_f32_32x32x16_bf16 v[160:175], a[16:19], v[64:67], v[160:175]
    s_waitcnt lgkmcnt(0)
    v_add_f32 v128, v128, v208
    v_add_f32 v129, v129, v209
    v_add_f32 v130, v130, v210
    v_add_f32 v131, v131, v211
    v_fma_f32 v128, v128, v14, v32
    v_mfma_f32_32x32x16_bf16 v[176:191], a[20:23], v[64:67], v[176:191]
    s_add_u32 s90, s89, 24576
    s_sub_u32 s66, s90, 28672
    s_cselect_b32 s90, s90, s66
    s_add_u32 s90, s90, s76
    buffer_load_dwordx4 v[112:115], v1, s[36:39], s90 offen sc1
    s_waitcnt vmcnt(11)
    v_mfma_f32_32x32x16_bf16 v[160:175], a[24:27], v[68:71], v[160:175]
    v_fma_f32 v129, v129, v14, v33
    v_fma_f32 v130, v130, v14, v34
    v_fma_f32 v131, v131, v14, v35
    v_cvt_pk_bf16_f32 v128, v128, v129
    v_cvt_pk_bf16_f32 v129, v130, v131
    v_mfma_f32_32x32x16_bf16 v[176:191], a[28:31], v[68:71], v[176:191]
    buffer_load_dwordx4 v[64:67], v1, s[36:39], s90 offen offset:1024 sc1
    s_waitcnt vmcnt(11)
    v_mfma_f32_32x32x16_bf16 v[160:175], a[32:35], v[72:75], v[160:175]
    v_add_f32 v132, v132, v196
    v_add_f32 v133, v133, v197
    v_add_f32 v134, v134, v198
    v_add_f32 v135, v135, v199
    v_add_f32 v132, v132, v204
    v_mfma_f32_32x32x16_bf16 v[176:191], a[36:39], v[72:75], v[176:191]
    buffer_load_dwordx4 v[68:71], v1, s[36:39], s90 offen offset:2048 sc1
    s_waitcnt vmcnt(11)
    v_mfma_f32_32x32x16_bf16 v[160:175], a[40:43], v[76:79], v[160:175]
    v_add_f32 v133, v133, v205
    v_add_f32 v134, v134, v206
    v_add_f32 v135, v135, v207
    v_add_f32 v132, v132, v212
    v_add_f32 v133, v133, v213
    v_mfma_f32_32x32x16_bf16 v[176:191], a[44:47], v[76:79], v[176:191]
    buffer_load_dwordx4 v[72:75], v1, s[36:39], s90 offen offset:3072 sc1
    s_waitcnt vmcnt(11)
    v_mfma_f32_32x32x16_bf16 v[160:175], a[64:67], v[80:83], v[160:175]
    v_add_f32 v134, v134, v214
    v_add_f32 v135, v135, v215
    v_fma_f32 v132, v132, v14, v36
    v_fma_f32 v133, v133, v14, v37
    v_fma_f32 v134, v134, v14, v38
    v_mfma_f32_32x32x16_bf16 v[176:191], a[68:71], v[80:83], v[176:191]
    s_waitcnt vmcnt(10)
    v_mfma_f32_32x32x16_bf16 v[160:175], a[72:75], v[84:87], v[160:175]
    v_fma_f32 v135, v135, v14, v39
    v_cvt_pk_bf16_f32 v130, v132, v133
    v_cvt_pk_bf16_f32 v131, v134, v135
    v_mfma_f32_32x32x16_bf16 v[176:191], a[76:79], v[84:87], v[176:191]
    buffer_store_dwordx4 v[128:131], v5, s[32:35], s6 offen
    s_waitcnt vmcnt(10)
    v_mfma_f32_32x32x16_bf16 v[160:175], a[80:83], v[88:91], v[160:175]
    v_mfma_f32_32x32x16_bf16 v[176:191], a[84:87], v[88:91], v[176:191]
    s_waitcnt vmcnt(9)
    v_mfma_f32_32x32x16_bf16 v[160:175], a[88:91], v[92:95], v[160:175]
    v_mfma_f32_32x32x16_bf16 v[176:191], a[92:95], v[92:95], v[176:191]
    s_waitcnt vmcnt(8)
    v_mfma_f32_32x32x16_bf16 v[176:191], a[100:103], v[96:99], v[176:191]
    s_waitcnt vmcnt(7)
    v_mfma_f32_32x32x16_bf16 v[176:191], a[108:111], v[100:103], v[176:191]
    s_waitcnt vmcnt(6)
    v_mfma_f32_32x32x16_bf16 v[176:191], a[116:119], v[104:107], v[176:191]
    s_waitcnt vmcnt(5)
    v_mfma_f32_32x32x16_bf16 v[176:191], a[124:127], v[108:111], v[176:191]
    s_waitcnt vmcnt(4)
    v_mfma_f32_32x32x16_bf16 v[176:191], a[132:135], v[112:115], v[176:191]
    s_waitcnt vmcnt(3)
    v_mfma_f32_32x32x16_bf16 v[176:191], a[140:143], v[64:67], v[176:191]
    s_waitcnt vmcnt(2)
    v_mfma_f32_32x32x16_bf16 v[176:191], a[148:151], v[68:71], v[176:191]
    s_waitcnt vmcnt(1)
    v_mfma_f32_32x32x16_bf16 v[176:191], a[156:159], v[72:75], v[176:191]
    v_mfma_f32_32x32x16_bf16 v[160:175], a[96:99], v[96:99], v[160:175]
    v_mfma_f32_32x32x16_bf16 v[160:175], a[104:107], v[100:103], v[160:175]
    v_mfma_f32_32x32x16_bf16 v[160:175], a[112:115], v[104:107], v[160:175]
    s_nop 8
    ds_write_b128 v12, v[176:179] offset:36864
    v_mfma_f32_32x32x16_bf16 v[160:175], a[120:123], v[108:111], v[160:175]
    v_mfma_f32_32x32x16_bf16 v[160:175], a[128:131], v[112:115], v[160:175]
    ds_write_b128 v12, v[180:183] offset:37888
    v_mfma_f32_32x32x16_bf16 v[160:175], a[136:139], v[64:67], v[160:175]
    ds_write_b128 v13, v[184:187] offset:38912
    v_mfma_f32_32x32x16_bf16 v[160:175], a[144:147], v[68:71], v[160:175]
    v_mfma_f32_32x32x16_bf16 v[160:175], a[152:155], v[72:75], v[160:175]
    ds_write_b128 v13, v[188:191] offset:39936
    s_nop 10
    ds_write_b128 v11, v[168:171] offset:34816
    ds_write_b128 v11, v[172:175] offset:35840
    s_waitcnt lgkmcnt(0)
    s_barrier
    ds_read_b128 v[192:195], v10 offset:34816
    ds_read_b128 v[200:203], v10 offset:36864
    ds_read_b128 v[208:211], v10 offset:38912
    ds_read_b128 v[196:199], v10 offset:35840
    ds_read_b128 v[204:207], v10 offset:37888
    ds_read_b128 v[212:215], v10 offset:39936
    s_waitcnt lgkmcnt(5)
    v_add_f32 v160, v160, v192
    v_add_f32 v161, v161, v193
    v_add_f32 v162, v162, v194
    v_add_f32 v163, v163, v195
    s_waitcnt lgkmcnt(4)
    v_add_f32 v160, v160, v200
    v_add_f32 v161, v161, v201
    v_add_f32 v162, v162, v202
    v_add_f32 v163, v163, v203
    s_waitcnt lgkmcnt(3)
    v_add_f32 v160, v160, v208
    v_add_f32 v161, v161, v209
    v_add_f32 v162, v162, v210
    v_add_f32 v163, v163, v211
    v_fma_f32 v160, v160, v15, v40
    v_fma_f32 v161, v161, v15, v41
    v_fma_f32 v162, v162, v15, v42
    v_fma_f32 v163, v163, v15, v43
    v_cvt_pk_bf16_f32 v160, v160, v161
    v_cvt_pk_bf16_f32 v161, v162, v163
    s_waitcnt lgkmcnt(2)
    v_add_f32 v164, v164, v196
    v_add_f32 v165, v165, v197
    v_add_f32 v166, v166, v198
    v_add_f32 v167, v167, v199
    s_waitcnt lgkmcnt(1)
    v_add_f32 v164, v164, v204
    v_add_f32 v165, v165, v205
    v_add_f32 v166, v166, v206
    v_add_f32 v167, v167, v207
    s_waitcnt lgkmcnt(0)
    v_add_f32 v164, v164, v212
    v_add_f32 v165, v165, v213
    v_add_f32 v166, v166, v214
    v_add_f32 v167, v167, v215
    v_fma_f32 v164, v164, v15, v44
    v_fma_f32 v165, v165, v15, v45
    v_fma_f32 v166, v166, v15, v46
    v_fma_f32 v167, v167, v15, v47
    v_cvt_pk_bf16_f32 v162, v164, v165
    v_cvt_pk_bf16_f32 v163, v166, v167
    buffer_store_dwordx4 v[160:163], v5, s[32:35], s57 offen
    s_branch L_fin
L_hot_end:
L_rel_5:
    buffer_store_dwordx2 v[124:125], v2, s[36:39], s73 offen sc1
    s_branch L_reld_6
L_slow_10:
    s_nop 15
    v_mov_b32 v208, 0xff7fffff
    s_cmp_eq_u32 s80, 0
    s_cbranch_scc1 L_skip_11
    v_add_f32 v232, v48, v2
    v_add_f32 v233, v49, v2
    v_add_f32 v234, v50, v2
    v_add_f32 v235, v51, v2
    v_add_f32 v236, v52, v2
    v_add_f32 v237, v53, v2
    v_add_f32 v238, v54, v2
    v_add_f32 v239, v55, v2
    v_add_f32 v240, v56, v2
    v_add_f32 v241, v57, v2
    v_add_f32 v242, v58, v2
    v_add_f32 v243, v59, v2
    v_add_f32 v244, v60, v2
    v_add_f32 v245, v61, v2
    v_add_f32 v246, v62, v2
    v_add_f32 v247, v63, v2
    s_nop 1
    v_mfma_f32_32x32x16_bf16 v[216:231], a[64:67], v[200:203], v[232:247]
    s_nop 11
    v_max3_f32 v208, v216, v217, v208
    v_max3_f32 v208, v218, v219, v208
    v_max3_f32 v208, v220, v221, v208
    v_max3_f32 v208, v222, v223, v208
    v_max3_f32 v208, v224, v225, v208
    v_max3_f32 v208, v226, v227, v208
    v_max3_f32 v208, v228, v229, v208
    v_max3_f32 v208, v230, v231, v208
    s_nop 15
L_skip_11:
    s_cmp_eq_u32 s80, 0
    s_cbranch_scc1 L_skip_12
    v_mov_b32 v232, v2
    v_mov_b32 v233, v2
    v_mov_b32 v234, v2
    v_mov_b32 v235, v2
    v_mov_b32 v236, v2
    v_mov_b32 v237, v2
    v_mov_b32 v238, v2
    v_mov_b32 v239, v2
    v_mov_b32 v240, v2
    v_mov_b32 v241, v2
    v_mov_b32 v242, v2
    v_mov_b32 v243, v2
    v_mov_b32 v244, v2
    v_mov_b32 v245, v2
    v_mov_b32 v246, v2
    v_mov_b32 v247, v2
    s_nop 1
    v_mfma_f32_32x32x16_bf16 v[216:231], a[68:71], v[200:203], v[232:247]
    s_nop 11
    v_max3_f32 v208, v216, v217, v208
    v_max3_f32 v208, v218, v219, v208
    v_max3_f32 v208, v220, v221, v208
    v_max3_f32 v208, v222, v223, v208
    v_max3_f32 v208, v224, v225, v208
    v_max3_f32 v208, v226, v227, v208
    v_max3_f32 v208, v228, v229, v208
    v_max3_f32 v208, v230, v231, v208
    s_nop 15
L_skip_12:
    s_cmp_eq_u32 s81, 0
    s_cbranch_scc1 L_skip_13
    v_mov_b32 v232, v2
    v_mov_b32 v233, v2
    v_mov_b32 v234, v2
    v_mov_b32 v235, v2
    v_mov_b32 v236, v2
    v_mov_b32 v237, v2
    v_mov_b32 v238, v2
    v_mov_b32 v239, v2
    v_mov_b32 v240, v2
    v_mov_b32 v241, v2
    v_mov_b32 v242, v2
    v_mov_b32 v243, v2
    v_mov_b32 v244, v2
    v_mov_b32 v245, v2
    v_mov_b32 v246, v2
    v_mov_b32 v247, v2
    s_nop 1
    v_mfma_f32_32x32x16_bf16 v[216:231], a[72:75], v[200:203], v[232:247]
    s_nop 11
    v_max3_f32 v208, v216, v217, v208
    v_max3_f32 v208, v218, v219, v208
    v_max3_f32 v208, v220, v221, v208
    v_max3_f32 v208, v222, v223, v208
    v_max3_f32 v208, v224, v225, v208
    v_max3_f32 v208, v226, v227, v208
    v_max3_f32 v208, v228, v229, v208
    v_max3_f32 v208, v230, v231, v208
    s_nop 15
L_skip_13:
    s_cmp_eq_u32 s81, 0
    s_cbranch_scc1 L_skip_14
    v_mov_b32 v232, v2
    v_mov_b32 v233, v2
    v_mov_b32 v234, v2
    v_mov_b32 v235, v2
    v_mov_b32 v236, v2
    v_mov_b32 v237, v2
    v_mov_b32 v238, v2
    v_mov_b32 v239, v2
    v_mov_b32 v240, v2
    v_mov_b32 v241, v2
    v_mov_b32 v242, v2
    v_mov_b32 v243, v2
    v_mov_b32 v244, v2
    v_mov_b32 v245, v2
    v_mov_b32 v246, v2
    v_mov_b32 v247, v2
    s_nop 1
    v_mfma_f32_32x32x16_bf16 v[216:231], a[76:79], v[200:203], v[232:247]
    s_nop 11
    v_max3_f32 v208, v216, v217, v208
    v_max3_f32 v208, v218, v219, v208
    v_max3_f32 v208, v220, v221, v208
    v_max3_f32 v208, v222, v223, v208
    v_max3_f32 v208, v224, v225, v208
    v_max3_f32 v208, v226, v227, v208
    v_max3_f32 v208, v228, v229, v208
    v_max3_f32 v208, v230, v231, v208
    s_nop 15
L_skip_14:
    s_cmp_eq_u32 s82, 0
    s_cbranch_scc1 L_skip_15
    v_mov_b32 v232, v2
    v_mov_b32 v233, v2
    v_mov_b32 v234, v2
    v_mov_b32 v235, v2
    v_mov_b32 v236, v2
    v_mov_b32 v237, v2
    v_mov_b32 v238, v2
    v_mov_b32 v239, v2
    v_mov_b32 v240, v2
    v_mov_b32 v241, v2
    v_mov_b32 v242, v2
    v_mov_b32 v243, v2
    v_mov_b32 v244, v2
    v_mov_b32 v245, v2
    v_mov_b32 v246, v2
    v_mov_b32 v247, v2
    s_nop 1
    v_mfma_f32_32x32x16_bf16 v[216:231], a[80:83], v[200:203], v[232:247]
    s_nop 11
    v_max3_f32 v208, v216, v217, v208
    v_max3_f32 v208, v218, v219, v208
    v_max3_f32 v208, v220, v221, v208
    v_max3_f32 v208, v222, v223, v208
    v_max3_f32 v208, v224, v225, v208
    v_max3_f32 v208, v226, v227, v208
    v_max3_f32 v208, v228, v229, v208
    v_max3_f32 v208, v230, v231, v208
    s_nop 15
L_skip_15:
    s_cmp_eq_u32 s82, 0
    s_cbranch_scc1 L_skip_16
    v_mov_b32 v232, v2
    v_mov_b32 v233, v2
    v_mov_b32 v234, v2
    v_mov_b32 v235, v2
    v_mov_b32 v236, v2
    v_mov_b32 v237, v2
    v_mov_b32 v238, v2
    v_mov_b32 v239, v2
    v_mov_b32 v240, v2
    v_mov_b32 v241, v2
    v_mov_b32 v242, v2
    v_mov_b32 v243, v2
    v_mov_b32 v244, v2
    v_mov_b32 v245, v2
    v_mov_b32 v246, v2
    v_mov_b32 v247, v2
    s_nop 1
    v_mfma_f32_32x32x16_bf16 v[216:231], a[84:87], v[200:203], v[232:247]
    s_nop 11
    v_max3_f32 v208, v216, v217, v208
    v_max3_f32 v208, v218, v219, v208
    v_max3_f32 v208, v220, v221, v208
    v_max3_f32 v208, v222, v223, v208
    v_max3_f32 v208, v224, v225, v208
    v_max3_f32 v208, v226, v227, v208
    v_max3_f32 v208, v228, v229, v208
    v_max3_f32 v208, v230, v231, v208
    s_nop 15
L_skip_16:
    s_cmp_eq_u32 s83, 0
    s_cbranch_scc1 L_skip_17
    v_mov_b32 v232, v2
    v_mov_b32 v233, v2
    v_mov_b32 v234, v2
    v_mov_b32 v235, v2
    v_mov_b32 v236, v2
    v_mov_b32 v237, v2
    v_mov_b32 v238, v2
    v_mov_b32 v239, v2
    v_mov_b32 v240, v2
    v_mov_b32 v241, v2
    v_mov_b32 v242, v2
    v_mov_b32 v243, v2
    v_mov_b32 v244, v2
    v_mov_b32 v245, v2
    v_mov_b32 v246, v2
    v_mov_b32 v247, v2
    s_nop 1
    v_mfma_f32_32x32x16_bf16 v[216:231], a[88:91], v[200:203], v[232:247]
    s_nop 11
    v_max3_f32 v208, v216, v217, v208
    v_max3_f32 v208, v218, v219, v208
    v_max3_f32 v208, v220, v221, v208
    v_max3_f32 v208, v222, v223, v208
    v_max3_f32 v208, v224, v225, v208
    v_max3_f32 v208, v226, v227, v208
    v_max3_f32 v208, v228, v229, v208
    v_max3_f32 v208, v230, v231, v208
    s_nop 15
L_skip_17:
    s_cmp_eq_u32 s83, 0
    s_cbranch_scc1 L_skip_18
    v_mov_b32 v232, v2
    v_mov_b32 v233, v2
    v_mov_b32 v234, v2
    v_mov_b32 v235, v2
    v_mov_b32 v236, v2
    v_mov_b32 v237, v2
    v_mov_b32 v238, v2
    v_mov_b32 v239, v2
    v_mov_b32 v240, v2
    v_mov_b32 v241, v2
    v_mov_b32 v242, v2
    v_mov_b32 v243, v2
    v_mov_b32 v244, v2
    v_mov_b32 v245, v2
    v_mov_b32 v246, v2
    v_mov_b32 v247, v2
    s_nop 1
    v_mfma_f32_32x32x16_bf16 v[216:231], a[92:95], v[200:203], v[232:247]
    s_nop 11
    v_max3_f32 v208, v216, v217, v208
    v_max3_f32 v208, v218, v219, v208
    v_max3_f32 v208, v220, v221, v208
    v_max3_f32 v208, v222, v223, v208
    v_max3_f32 v208, v224, v225, v208
    v_max3_f32 v208, v226, v227, v208
    v_max3_f32 v208, v228, v229, v208
    v_max3_f32 v208, v230, v231, v208
    s_nop 15
L_skip_18:
    v_add_f32 v232, v32, v2
    v_add_f32 v233, v33, v2
    v_add_f32 v234, v34, v2
    v_add_f32 v235, v35, v2
    v_add_f32 v236, v36, v2
    v_add_f32 v237, v37, v2
    v_add_f32 v238, v38, v2
    v_add_f32 v239, v39, v2
    v_add_f32 v240, v40, v2
    v_add_f32 v241, v41, v2
    v_add_f32 v242, v42, v2
    v_add_f32 v243, v43, v2
    v_add_f32 v244, v44, v2
    v_add_f32 v245, v45, v2
    v_add_f32 v246, v46, v2
    v_add_f32 v247, v47, v2
    s_nop 1
    v_mfma_f32_32x32x16_bf16 v[216:231], a[96:99], v[200:203], v[232:247]
    s_nop 11
    v_max3_f32 v208, v216, v217, v208
    v_max3_f32 v208, v218, v219, v208
    v_max3_f32 v208, v220, v221, v208
    v_max3_f32 v208, v222, v223, v208
    v_max3_f32 v208, v224, v225, v208
    v_max3_f32 v208, v226, v227, v208
    v_max3_f32 v208, v228, v229, v208
    v_max3_f32 v208, v230, v231, v208
    v_mov_b32 v209, v208
    s_nop 1
    v_permlane32_swap_b32 v208, v209
    v_max_f32 v208, v208, v209
    v_sub_f32 v208, 0, v208
    v_mov_b32 v160, 0
    v_mov_b32 v161, 0
    v_mov_b32 v162, 0
    v_mov_b32 v163, 0
    v_mov_b32 v164, 0
    v_mov_b32 v165, 0
    v_mov_b32 v166, 0
    v_mov_b32 v167, 0
    v_mov_b32 v168, 0
    v_mov_b32 v169, 0
    v_mov_b32 v170, 0
    v_mov_b32 v171, 0
    v_mov_b32 v172, 0
    v_mov_b32 v173, 0
    v_mov_b32 v174, 0
    v_mov_b32 v175, 0
    s_cmp_eq_u32 s80, 0
    s_cbranch_scc1 L_skip_19
    v_add_f32 v232, v48, v208
    v_add_f32 v233, v49, v208
    v_add_f32 v234, v50, v208
    v_add_f32 v235, v51, v208
    v_add_f32 v236, v52, v208
    v_add_f32 v237, v53, v208
    v_add_f32 v238, v54, v208
    v_add_f32 v239, v55, v208
    v_add_f32 v240, v56, v208
    v_add_f32 v241, v57, v208
    v_add_f32 v242, v58, v208
    v_add_f32 v243, v59, v208
    v_add_f32 v244, v60, v208
    v_add_f32 v245, v61, v208
    v_add_f32 v246, v62, v208
    v_add_f32 v247, v63, v208
    s_nop 1
    v_mfma_f32_32x32x16_bf16 v[216:231], a[64:67], v[200:203], v[232:247]
    s_nop 11
    v_exp_f32 v216, v216
    v_exp_f32 v217, v217
    v_exp_f32 v218, v218
    v_exp_f32 v219, v219
    v_exp_f32 v220, v220
    v_exp_f32 v221, v221
    v_exp_f32 v222, v222
    v_exp_f32 v223, v223
    v_exp_f32 v224, v224
    v_exp_f32 v225, v225
    v_exp_f32 v226, v226
    v_exp_f32 v227, v227
    v_exp_f32 v228, v228
    v_exp_f32 v229, v229
    v_exp_f32 v230, v230
    v_exp_f32 v231, v231
    v_cvt_pk_bf16_f32 v248, v216, v217
    v_cvt_pk_bf16_f32 v249, v218, v219
    v_cvt_pk_bf16_f32 v250, v220, v221
    v_cvt_pk_bf16_f32 v251, v222, v223
    v_cvt_pk_bf16_f32 v252, v224, v225
    v_cvt_pk_bf16_f32 v253, v226, v227
    v_cvt_pk_bf16_f32 v254, v228, v229
    v_cvt_pk_bf16_f32 v255, v230, v231
    v_mfma_f32_32x32x16_bf16 v[160:175], a[104:107], v[248:251], v[160:175]
    s_nop 0
    v_mfma_f32_32x32x16_bf16 v[160:175], a[108:111], v[252:255], v[160:175]
    s_nop 15
L_skip_19:
    s_cmp_eq_u32 s80, 0
    s_cbranch_scc1 L_skip_20
    v_mov_b32 v232, v208
    v_mov_b32 v233, v208
    v_mov_b32 v234, v208
    v_mov_b32 v235, v208
    v_mov_b32 v236, v208
    v_mov_b32 v237, v208
    v_mov_b32 v238, v208
    v_mov_b32 v239, v208
    v_mov_b32 v240, v208
    v_mov_b32 v241, v208
    v_mov_b32 v242, v208
    v_mov_b32 v243, v208
    v_mov_b32 v244, v208
    v_mov_b32 v245, v208
    v_mov_b32 v246, v208
    v_mov_b32 v247, v208
    s_nop 1
    v_mfma_f32_32x32x16_bf16 v[216:231], a[68:71], v[200:203], v[232:247]
    s_nop 11
    v_exp_f32 v216, v216
    v_exp_f32 v217, v217
    v_exp_f32 v218, v218
    v_exp_f32 v219, v219
    v_exp_f32 v220, v220
    v_exp_f32 v221, v221
    v_exp_f32 v222, v222
    v_exp_f32 v223, v223
    v_exp_f32 v224, v224
    v_exp_f32 v225, v225
    v_exp_f32 v226, v226
    v_exp_f32 v227, v227
    v_exp_f32 v228, v228
    v_exp_f32 v229, v229
    v_exp_f32 v230, v230
    v_exp_f32 v231, v231
    v_cvt_pk_bf16_f32 v248, v216, v217
    v_cvt_pk_bf16_f32 v249, v218, v219
    v_cvt_pk_bf16_f32 v250, v220, v221
    v_cvt_pk_bf16_f32 v251, v222, v223
    v_cvt_pk_bf16_f32 v252, v224, v225
    v_cvt_pk_bf16_f32 v253, v226, v227
    v_cvt_pk_bf16_f32 v254, v228, v229
    v_cvt_pk_bf16_f32 v255, v230, v231
    v_mfma_f32_32x32x16_bf16 v[160:175], a[112:115], v[248:251], v[160:175]
    s_nop 0
    v_mfma_f32_32x32x16_bf16 v[160:175], a[116:119], v[252:255], v[160:175]
    s_nop 15
L_skip_20:
    s_cmp_eq_u32 s81, 0
    s_cbranch_scc1 L_skip_21
    v_mov_b32 v232, v208
    v_mov_b32 v233, v208
    v_mov_b32 v234, v208
    v_mov_b32 v235, v208
    v_mov_b32 v236, v208
    v_mov_b32 v237, v208
    v_mov_b32 v238, v208
    v_mov_b32 v239, v208
    v_mov_b32 v240, v208
    v_mov_b32 v241, v208
    v_mov_b32 v242, v208
    v_mov_b32 v243, v208
    v_mov_b32 v244, v208
    v_mov_b32 v245, v208
    v_mov_b32 v246, v208
    v_mov_b32 v247, v208
    s_nop 1
    v_mfma_f32_32x32x16_bf16 v[216:231], a[72:75], v[200:203], v[232:247]
    s_nop 11
    v_exp_f32 v216, v216
    v_exp_f32 v217, v217
    v_exp_f32 v218, v218
    v_exp_f32 v219, v219
    v_exp_f32 v220, v220
    v_exp_f32 v221, v221
    v_exp_f32 v222, v222
    v_exp_f32 v223, v223
    v_exp_f32 v224, v224
    v_exp_f32 v225, v225
    v_exp_f32 v226, v226
    v_exp_f32 v227, v227
    v_exp_f32 v228, v228
    v_exp_f32 v229, v229
    v_exp_f32 v230, v230
    v_exp_f32 v231, v231
    v_cvt_pk_bf16_f32 v248, v216, v217
    v_cvt_pk_bf16_f32 v249, v218, v219
    v_cvt_pk_bf16_f32 v250, v220, v221
    v_cvt_pk_bf16_f32 v251, v222, v223
    v_cvt_pk_bf16_f32 v252, v224, v225
    v_cvt_pk_bf16_f32 v253, v226, v227
    v_cvt_pk_bf16_f32 v254, v228, v229
    v_cvt_pk_bf16_f32 v255, v230, v231
    v_mfma_f32_32x32x16_bf16 v[160:175], a[120:123], v[248:251], v[160:175]
    s_nop 0
    v_mfma_f32_32x32x16_bf16 v[160:175], a[124:127], v[252:255], v[160:175]
    s_nop 15
L_skip_21:
    s_cmp_eq_u32 s81, 0
    s_cbranch_scc1 L_skip_22
    v_mov_b32 v232, v208
    v_mov_b32 v233, v208
    v_mov_b32 v234, v208
    v_mov_b32 v235, v208
    v_mov_b32 v236, v208
    v_mov_b32 v237, v208
    v_mov_b32 v238, v208
    v_mov_b32 v239, v208
    v_mov_b32 v240, v208
    v_mov_b32 v241, v208
    v_mov_b32 v242, v208
    v_mov_b32 v243, v208
    v_mov_b32 v244, v208
    v_mov_b32 v245, v208
    v_mov_b32 v246, v208
    v_mov_b32 v247, v208
    s_nop 1
    v_mfma_f32_32x32x16_bf16 v[216:231], a[76:79], v[200:203], v[232:247]
    s_nop 11
    v_exp_f32 v216, v216
    v_exp_f32 v217, v217
    v_exp_f32 v218, v218
    v_exp_f32 v219, v219
    v_exp_f32 v220, v220
    v_exp_f32 v221, v221
    v_exp_f32 v222, v222
    v_exp_f32 v223, v223
    v_exp_f32 v224, v224
    v_exp_f32 v225, v225
    v_exp_f32 v226, v226
    v_exp_f32 v227, v227
    v_exp_f32 v228, v228
    v_exp_f32 v229, v229
    v_exp_f32 v230, v230
    v_exp_f32 v231, v231
    v_cvt_pk_bf16_f32 v248, v216, v217
    v_cvt_pk_bf16_f32 v249, v218, v219
    v_cvt_pk_bf16_f32 v250, v220, v221
    v_cvt_pk_bf16_f32 v251, v222, v223
    v_cvt_pk_bf16_f32 v252, v224, v225
    v_cvt_pk_bf16_f32 v253, v226, v227
    v_cvt_pk_bf16_f32 v254, v228, v229
    v_cvt_pk_bf16_f32 v255, v230, v231
    v_mfma_f32_32x32x16_bf16 v[160:175], a[128:131], v[248:251], v[160:175]
    s_nop 0
    v_mfma_f32_32x32x16_bf16 v[160:175], a[132:135], v[252:255], v[160:175]
    s_nop 15
L_skip_22:
    s_cmp_eq_u32 s82, 0
    s_cbranch_scc1 L_skip_23
    v_mov_b32 v232, v208
    v_mov_b32 v233, v208
    v_mov_b32 v234, v208
    v_mov_b32 v235, v208
    v_mov_b32 v236, v208
    v_mov_b32 v237, v208
    v_mov_b32 v238, v208
    v_mov_b32 v239, v208
    v_mov_b32 v240, v208
    v_mov_b32 v241, v208
    v_mov_b32 v242, v208
    v_mov_b32 v243, v208
    v_mov_b32 v244, v208
    v_mov_b32 v245, v208
    v_mov_b32 v246, v208
    v_mov_b32 v247, v208
    s_nop 1
    v_mfma_f32_32x32x16_bf16 v[216:231], a[80:83], v[200:203], v[232:247]
    s_nop 11
    v_exp_f32 v216, v216
    v_exp_f32 v217, v217
    v_exp_f32 v218, v218
    v_exp_f32 v219, v219
    v_exp_f32 v220, v220
    v_exp_f32 v221, v221
    v_exp_f32 v222, v222
    v_exp_f32 v223, v223
    v_exp_f32 v224, v224
    v_exp_f32 v225, v225
    v_exp_f32 v226, v226
    v_exp_f32 v227, v227
    v_exp_f32 v228, v228
    v_exp_f32 v229, v229
    v_exp_f32 v230, v230
    v_exp_f32 v231, v231
    v_cvt_pk_bf16_f32 v248, v216, v217
    v_cvt_pk_bf16_f32 v249, v218, v219
    v_cvt_pk_bf16_f32 v250, v220, v221
    v_cvt_pk_bf16_f32 v251, v222, v223
    v_cvt_pk_bf16_f32 v252, v224, v225
    v_cvt_pk_bf16_f32 v253, v226, v227
    v_cvt_pk_bf16_f32 v254, v228, v229
    v_cvt_pk_bf16_f32 v255, v230, v231
    v_mfma_f32_32x32x16_bf16 v[160:175], a[136:139], v[248:251], v[160:175]
    s_nop 0
    v_mfma_f32_32x32x16_bf16 v[160:175], a[140:143], v[252:255], v[160:175]
    s_nop 15
L_skip_23:
    s_cmp_eq_u32 s82, 0
    s_cbranch_scc1 L_skip_24
    v_mov_b32 v232, v208
    v_mov_b32 v233, v208
    v_mov_b32 v234, v208
    v_mov_b32 v235, v208
    v_mov_b32 v236, v208
    v_mov_b32 v237, v208
    v_mov_b32 v238, v208
    v_mov_b32 v239, v208
    v_mov_b32 v240, v208
    v_mov_b32 v241, v208
    v_mov_b32 v242, v208
    v_mov_b32 v243, v208
    v_mov_b32 v244, v208
    v_mov_b32 v245, v208
    v_mov_b32 v246, v208
    v_mov_b32 v247, v208
    s_nop 1
    v_mfma_f32_32x32x16_bf16 v[216:231], a[84:87], v[200:203], v[232:247]
    s_nop 11
    v_exp_f32 v216, v216
    v_exp_f32 v217, v217
    v_exp_f32 v218, v218
    v_exp_f32 v219, v219
    v_exp_f32 v220, v220
    v_exp_f32 v221, v221
    v_exp_f32 v222, v222
    v_exp_f32 v223, v223
    v_exp_f32 v224, v224
    v_exp_f32 v225, v225
    v_exp_f32 v226, v226
    v_exp_f32 v227, v227
    v_exp_f32 v228, v228
    v_exp_f32 v229, v229
    v_exp_f32 v230, v230
    v_exp_f32 v231, v231
    v_cvt_pk_bf16_f32 v248, v216, v217
    v_cvt_pk_bf16_f32 v249, v218, v219
    v_cvt_pk_bf16_f32 v250, v220, v221
    v_cvt_pk_bf16_f32 v251, v222, v223
    v_cvt_pk_bf16_f32 v252, v224, v225
    v_cvt_pk_bf16_f32 v253, v226, v227
    v_cvt_pk_bf16_f32 v254, v228, v229
    v_cvt_pk_bf16_f32 v255, v230, v231
    v_mfma_f32_32x32x16_bf16 v[160:175], a[144:147], v[248:251], v[160:175]
    s_nop 0
    v_mfma_f32_32x32x16_bf16 v[160:175], a[148:151], v[252:255], v[160:175]
    s_nop 15
L_skip_24:
    s_cmp_eq_u32 s83, 0
    s_cbranch_scc1 L_skip_25
    v_mov_b32 v232, v208
    v_mov_b32 v233, v208
    v_mov_b32 v234, v208
    v_mov_b32 v235, v208
    v_mov_b32 v236, v208
    v_mov_b32 v237, v208
    v_mov_b32 v238, v208
    v_mov_b32 v239, v208
    v_mov_b32 v240, v208
    v_mov_b32 v241, v208
    v_mov_b32 v242, v208
    v_mov_b32 v243, v208
    v_mov_b32 v244, v208
    v_mov_b32 v245, v208
    v_mov_b32 v246, v208
    v_mov_b32 v247, v208
    s_nop 1
    v_mfma_f32_32x32x16_bf16 v[216:231], a[88:91], v[200:203], v[232:247]
    s_nop 11
    v_exp_f32 v216, v216
    v_exp_f32 v217, v217
    v_exp_f32 v218, v218
    v_exp_f32 v219, v219
    v_exp_f32 v220, v220
    v_exp_f32 v221, v221
    v_exp_f32 v222, v222
    v_exp_f32 v223, v223
    v_exp_f32 v224, v224
    v_exp_f32 v225, v225
    v_exp_f32 v226, v226
    v_exp_f32 v227, v227
    v_exp_f32 v228, v228
    v_exp_f32 v229, v229
    v_exp_f32 v230, v230
    v_exp_f32 v231, v231
    v_cvt_pk_bf16_f32 v248, v216, v217
    v_cvt_pk_bf16_f32 v249, v218, v219
    v_cvt_pk_bf16_f32 v250, v220, v221
    v_cvt_pk_bf16_f32 v251, v222, v223
    v_cvt_pk_bf16_f32 v252, v224, v225
    v_cvt_pk_bf16_f32 v253, v226, v227
    v_cvt_pk_bf16_f32 v254, v228, v229
    v_cvt_pk_bf16_f32 v255, v230, v231
    v_mfma_f32_32x32x16_bf16 v[160:175], a[152:155], v[248:251], v[160:175]
    s_nop 0
    v_mfma_f32_32x32x16_bf16 v[160:175], a[156:159], v[252:255], v[160:175]
    s_nop 15
L_skip_25:
    s_cmp_eq_u32 s83, 0
    s_cbranch_scc1 L_skip_26
    v_mov_b32 v232, v208
    v_mov_b32 v233, v208
    v_mov_b32 v234, v208
    v_mov_b32 v235, v208
    v_mov_b32 v236, v208
    v_mov_b32 v237, v208
    v_mov_b32 v238, v208
    v_mov_b32 v239, v208
    v_mov_b32 v240, v208
    v_mov_b32 v241, v208
    v_mov_b32 v242, v208
    v_mov_b32 v243, v208
    v_mov_b32 v244, v208
    v_mov_b32 v245, v208
    v_mov_b32 v246, v208
    v_mov_b32 v247, v208
    s_nop 1
    v_mfma_f32_32x32x16_bf16 v[216:231], a[92:95], v[200:203], v[232:247]
    s_nop 11
    v_exp_f32 v216, v216
    v_exp_f32 v217, v217
    v_exp_f32 v218, v218
    v_exp_f32 v219, v219
    v_exp_f32 v220, v220
    v_exp_f32 v221, v221
    v_exp_f32 v222, v222
    v_exp_f32 v223, v223
    v_exp_f32 v224, v224
    v_exp_f32 v225, v225
    v_exp_f32 v226, v226
    v_exp_f32 v227, v227
    v_exp_f32 v228, v228
    v_exp_f32 v229, v229
    v_exp_f32 v230, v230
    v_exp_f32 v231, v231
    v_cvt_pk_bf16_f32 v248, v216, v217
    v_cvt_pk_bf16_f32 v249, v218, v219
    v_cvt_pk_bf16_f32 v250, v220, v221
    v_cvt_pk_bf16_f32 v251, v222, v223
    v_cvt_pk_bf16_f32 v252, v224, v225
    v_cvt_pk_bf16_f32 v253, v226, v227
    v_cvt_pk_bf16_f32 v254, v228, v229
    v_cvt_pk_bf16_f32 v255, v230, v231
    v_mfma_f32_32x32x16_bf16 v[160:175], a[160:163], v[248:251], v[160:175]
    s_nop 0
    v_mfma_f32_32x32x16_bf16 v[160:175], a[164:167], v[252:255], v[160:175]
    s_nop 15
L_skip_26:
    v_add_f32 v232, v32, v208
    v_add_f32 v233, v33, v208
    v_add_f32 v234, v34, v208
    v_add_f32 v235, v35, v208
    v_add_f32 v236, v36, v208
    v_add_f32 v237, v37, v208
    v_add_f32 v238, v38, v208
    v_add_f32 v239, v39, v208
    v_add_f32 v240, v40, v208
    v_add_f32 v241, v41, v208
    v_add_f32 v242, v42, v208
    v_add_f32 v243, v43, v208
    v_add_f32 v244, v44, v208
    v_add_f32 v245, v45, v208
    v_add_f32 v246, v46, v208
    v_add_f32 v247, v47, v208
    s_nop 1
    v_mfma_f32_32x32x16_bf16 v[216:231], a[96:99], v[200:203], v[232:247]
    s_nop 11
    v_exp_f32 v216, v216
    v_exp_f32 v217, v217
    v_exp_f32 v218, v218
    v_exp_f32 v219, v219
    v_exp_f32 v220, v220
    v_exp_f32 v221, v221
    v_exp_f32 v222, v222
    v_exp_f32 v223, v223
    v_exp_f32 v224, v224
    v_exp_f32 v225, v225
    v_exp_f32 v226, v226
    v_exp_f32 v227, v227
    v_exp_f32 v228, v228
    v_exp_f32 v229, v229
    v_exp_f32 v230, v230
    v_exp_f32 v231, v231
    v_cvt_pk_bf16_f32 v248, v216, v217
    v_cvt_pk_bf16_f32 v249, v218, v219
    v_cvt_pk_bf16_f32 v250, v220, v221
    v_cvt_pk_bf16_f32 v251, v222, v223
    v_cvt_pk_bf16_f32 v252, v224, v225
    v_cvt_pk_bf16_f32 v253, v226, v227
    v_cvt_pk_bf16_f32 v254, v228, v229
    v_cvt_pk_bf16_f32 v255, v230, v231
    v_mfma_f32_32x32x16_bf16 v[160:175], a[168:171], v[248:251], v[160:175]
    s_nop 0
    v_mfma_f32_32x32x16_bf16 v[160:175], a[172:175], v[252:255], v[160:175]
    s_nop 15
    s_branch L_att_9
L_slow_28:
    s_nop 15
    v_mov_b32 v208, 0xff7fffff
    s_cmp_eq_u32 s80, 0
    s_cbranch_scc1 L_skip_29
    v_add_f32 v232, v48, v2
    v_add_f32 v233, v49, v2
    v_add_f32 v234, v50, v2
    v_add_f32 v235, v51, v2
    v_add_f32 v236, v52, v2
    v_add_f32 v237, v53, v2
    v_add_f32 v238, v54, v2
    v_add_f32 v239, v55, v2
    v_add_f32 v240, v56, v2
    v_add_f32 v241, v57, v2
    v_add_f32 v242, v58, v2
    v_add_f32 v243, v59, v2
    v_add_f32 v244, v60, v2
    v_add_f32 v245, v61, v2
    v_add_f32 v246, v62, v2
    v_add_f32 v247, v63, v2
    s_nop 1
    v_mfma_f32_32x32x16_bf16 v[216:231], a[68:71], v[204:207], v[232:247]
    s_nop 11
    v_max3_f32 v208, v216, v217, v208
    v_max3_f32 v208, v218, v219, v208
    v_max3_f32 v208, v220, v221, v208
    v_max3_f32 v208, v222, v223, v208
    v_max3_f32 v208, v224, v225, v208
    v_max3_f32 v208, v226, v227, v208
    v_max3_f32 v208, v228, v229, v208
    v_max3_f32 v208, v230, v231, v208
    s_nop 15
L_skip_29:
    s_cmp_eq_u32 s81, 0
    s_cbranch_scc1 L_skip_30
    v_mov_b32 v232, v2
    v_mov_b32 v233, v2
    v_mov_b32 v234, v2
    v_mov_b32 v235, v2
    v_mov_b32 v236, v2
    v_mov_b32 v237, v2
    v_mov_b32 v238, v2
    v_mov_b32 v239, v2
    v_mov_b32 v240, v2
    v_mov_b32 v241, v2
    v_mov_b32 v242, v2
    v_mov_b32 v243, v2
    v_mov_b32 v244, v2
    v_mov_b32 v245, v2
    v_mov_b32 v246, v2
    v_mov_b32 v247, v2
    s_nop 1
    v_mfma_f32_32x32x16_bf16 v[216:231], a[72:75], v[204:207], v[232:247]
    s_nop 11
    v_max3_f32 v208, v216, v217, v208
    v_max3_f32 v208, v218, v219, v208
    v_max3_f32 v208, v220, v221, v208
    v_max3_f32 v208, v222, v223, v208
    v_max3_f32 v208, v224, v225, v208
    v_max3_f32 v208, v226, v227, v208
    v_max3_f32 v208, v228, v229, v208
    v_max3_f32 v208, v230, v231, v208
    s_nop 15
L_skip_30:
    s_cmp_eq_u32 s81, 0
    s_cbranch_scc1 L_skip_31
    v_mov_b32 v232, v2
    v_mov_b32 v233, v2
    v_mov_b32 v234, v2
    v_mov_b32 v235, v2
    v_mov_b32 v236, v2
    v_mov_b32 v237, v2
    v_mov_b32 v238, v2
    v_mov_b32 v239, v2
    v_mov_b32 v240, v2
    v_mov_b32 v241, v2
    v_mov_b32 v242, v2
    v_mov_b32 v243, v2
    v_mov_b32 v244, v2
    v_mov_b32 v245, v2
    v_mov_b32 v246, v2
    v_mov_b32 v247, v2
    s_nop 1
    v_mfma_f32_32x32x16_bf16 v[216:231], a[76:79], v[204:207], v[232:247]
    s_nop 11
    v_max3_f32 v208, v216, v217, v208
    v_max3_f32 v208, v218, v219, v208
    v_max3_f32 v208, v220, v221, v208
    v_max3_f32 v208, v222, v223, v208
    v_max3_f32 v208, v224, v225, v208
    v_max3_f32 v208, v226, v227, v208
    v_max3_f32 v208, v228, v229, v208
    v_max3_f32 v208, v230, v231, v208
    s_nop 15
L_skip_31:
    s_cmp_eq_u32 s82, 0
    s_cbranch_scc1 L_skip_32
    v_mov_b32 v232, v2
    v_mov_b32 v233, v2
    v_mov_b32 v234, v2
    v_mov_b32 v235, v2
    v_mov_b32 v236, v2
    v_mov_b32 v237, v2
    v_mov_b32 v238, v2
    v_mov_b32 v239, v2
    v_mov_b32 v240, v2
    v_mov_b32 v241, v2
    v_mov_b32 v242, v2
    v_mov_b32 v243, v2
    v_mov_b32 v244, v2
    v_mov_b32 v245, v2
    v_mov_b32 v246, v2
    v_mov_b32 v247, v2
    s_nop 1
    v_mfma_f32_32x32x16_bf16 v[216:231], a[80:83], v[204:207], v[232:247]
    s_nop 11
    v_max3_f32 v208, v216, v217, v208
    v_max3_f32 v208, v218, v219, v208
    v_max3_f32 v208, v220, v221, v208
    v_max3_f32 v208, v222, v223, v208
    v_max3_f32 v208, v224, v225, v208
    v_max3_f32 v208, v226, v227, v208
    v_max3_f32 v208, v228, v229, v208
    v_max3_f32 v208, v230, v231, v208
    s_nop 15
L_skip_32:
    s_cmp_eq_u32 s82, 0
    s_cbranch_scc1 L_skip_33
    v_mov_b32 v232, v2
    v_mov_b32 v233, v2
    v_mov_b32 v234, v2
    v_mov_b32 v235, v2
    v_mov_b32 v236, v2
    v_mov_b32 v237, v2
    v_mov_b32 v238, v2
    v_mov_b32 v239, v2
    v_mov_b32 v240, v2
    v_mov_b32 v241, v2
    v_mov_b32 v242, v2
    v_mov_b32 v243, v2
    v_mov_b32 v244, v2
    v_mov_b32 v245, v2
    v_mov_b32 v246, v2
    v_mov_b32 v247, v2
    s_nop 1
    v_mfma_f32_32x32x16_bf16 v[216:231], a[84:87], v[204:207], v[232:247]
    s_nop 11
    v_max3_f32 v208, v216, v217, v208
    v_max3_f32 v208, v218, v219, v208
    v_max3_f32 v208, v220, v221, v208
    v_max3_f32 v208, v222, v223, v208
    v_max3_f32 v208, v224, v225, v208
    v_max3_f32 v208, v226, v227, v208
    v_max3_f32 v208, v228, v229, v208
    v_max3_f32 v208, v230, v231, v208
    s_nop 15
L_skip_33:
    s_cmp_eq_u32 s83, 0
    s_cbranch_scc1 L_skip_34
    v_mov_b32 v232, v2
    v_mov_b32 v233, v2
    v_mov_b32 v234, v2
    v_mov_b32 v235, v2
    v_mov_b32 v236, v2
    v_mov_b32 v237, v2
    v_mov_b32 v238, v2
    v_mov_b32 v239, v2
    v_mov_b32 v240, v2
    v_mov_b32 v241, v2
    v_mov_b32 v242, v2
    v_mov_b32 v243, v2
    v_mov_b32 v244, v2
    v_mov_b32 v245, v2
    v_mov_b32 v246, v2
    v_mov_b32 v247, v2
    s_nop 1
    v_mfma_f32_32x32x16_bf16 v[216:231], a[88:91], v[204:207], v[232:247]
    s_nop 11
    v_max3_f32 v208, v216, v217, v208
    v_max3_f32 v208, v218, v219, v208
    v_max3_f32 v208, v220, v221, v208
    v_max3_f32 v208, v222, v223, v208
    v_max3_f32 v208, v224, v225, v208
    v_max3_f32 v208, v226, v227, v208
    v_max3_f32 v208, v228, v229, v208
    v_max3_f32 v208, v230, v231, v208
    s_nop 15
L_skip_34:
    s_cmp_eq_u32 s83, 0
    s_cbranch_scc1 L_skip_35
    v_mov_b32 v232, v2
    v_mov_b32 v233, v2
    v_mov_b32 v234, v2
    v_mov_b32 v235, v2
    v_mov_b32 v236, v2
    v_mov_b32 v237, v2
    v_mov_b32 v238, v2
    v_mov_b32 v239, v2
    v_mov_b32 v240, v2
    v_mov_b32 v241, v2
    v_mov_b32 v242, v2
    v_mov_b32 v243, v2
    v_mov_b32 v244, v2
    v_mov_b32 v245, v2
    v_mov_b32 v246, v2
    v_mov_b32 v247, v2
    s_nop 1
    v_mfma_f32_32x32x16_bf16 v[216:231], a[92:95], v[204:207], v[232:247]
    s_nop 11
    v_max3_f32 v208, v216, v217, v208
    v_max3_f32 v208, v218, v219, v208
    v_max3_f32 v208, v220, v221, v208
    v_max3_f32 v208, v222, v223, v208
    v_max3_f32 v208, v224, v225, v208
    v_max3_f32 v208, v226, v227, v208
    v_max3_f32 v208, v228, v229, v208
    v_max3_f32 v208, v230, v231, v208
    s_nop 15
L_skip_35:
    v_mov_b32 v232, v2
    v_mov_b32 v233, v2
    v_mov_b32 v234, v2
    v_mov_b32 v235, v2
    v_mov_b32 v236, v2
    v_mov_b32 v237, v2
    v_mov_b32 v238, v2
    v_mov_b32 v239, v2
    v_mov_b32 v240, v2
    v_mov_b32 v241, v2
    v_mov_b32 v242, v2
    v_mov_b32 v243, v2
    v_mov_b32 v244, v2
    v_mov_b32 v245, v2
    v_mov_b32 v246, v2
    v_mov_b32 v247, v2
    s_nop 1
    v_mfma_f32_32x32x16_bf16 v[216:231], a[96:99], v[204:207], v[232:247]
    s_nop 11
    v_max3_f32 v208, v216, v217, v208
    v_max3_f32 v208, v218, v219, v208
    v_max3_f32 v208, v220, v221, v208
    v_max3_f32 v208, v222, v223, v208
    v_max3_f32 v208, v224, v225, v208
    v_max3_f32 v208, v226, v227, v208
    v_max3_f32 v208, v228, v229, v208
    v_max3_f32 v208, v230, v231, v208
    v_add_f32 v232, v32, v2
    v_add_f32 v233, v33, v2
    v_add_f32 v234, v34, v2
    v_add_f32 v235, v35, v2
    v_add_f32 v236, v36, v2
    v_add_f32 v237, v37, v2
    v_add_f32 v238, v38, v2
    v_add_f32 v239, v39, v2
    v_add_f32 v240, v40, v2
    v_add_f32 v241, v41, v2
    v_add_f32 v242, v42, v2
    v_add_f32 v243, v43, v2
    v_add_f32 v244, v44, v2
    v_add_f32 v245, v45, v2
    v_add_f32 v246, v46, v2
    v_add_f32 v247, v47, v2
    s_nop 1
    v_mfma_f32_32x32x16_bf16 v[216:231], a[100:103], v[204:207], v[232:247]
    s_nop 11
    v_max3_f32 v208, v216, v217, v208
    v_max3_f32 v208, v218, v219, v208
    v_max3_f32 v208, v220, v221, v208
    v_max3_f32 v208, v222, v223, v208
    v_max3_f32 v208, v224, v225, v208
    v_max3_f32 v208, v226, v227, v208
    v_max3_f32 v208, v228, v229, v208
    v_max3_f32 v208, v230, v231, v208
    v_mov_b32 v209, v208
    s_nop 1
    v_permlane32_swap_b32 v208, v209
    v_max_f32 v208, v208, v209
    v_sub_f32 v208, 0, v208
    v_mov_b32 v176, 0
    v_mov_b32 v177, 0
    v_mov_b32 v178, 0
    v_mov_b32 v179, 0
    v_mov_b32 v180, 0
    v_mov_b32 v181, 0
    v_mov_b32 v182, 0
    v_mov_b32 v183, 0
    v_mov_b32 v184, 0
    v_mov_b32 v185, 0
    v_mov_b32 v186, 0
    v_mov_b32 v187, 0
    v_mov_b32 v188, 0
    v_mov_b32 v189, 0
    v_mov_b32 v190, 0
    v_mov_b32 v191, 0
    s_cmp_eq_u32 s80, 0
    s_cbranch_scc1 L_skip_36
    v_add_f32 v232, v48, v208
    v_add_f32 v233, v49, v208
    v_add_f32 v234, v50, v208
    v_add_f32 v235, v51, v208
    v_add_f32 v236, v52, v208
    v_add_f32 v237, v53, v208
    v_add_f32 v238, v54, v208
    v_add_f32 v239, v55, v208
    v_add_f32 v240, v56, v208
    v_add_f32 v241, v57, v208
    v_add_f32 v242, v58, v208
    v_add_f32 v243, v59, v208
    v_add_f32 v244, v60, v208
    v_add_f32 v245, v61, v208
    v_add_f32 v246, v62, v208
    v_add_f32 v247, v63, v208
    s_nop 1
    v_mfma_f32_32x32x16_bf16 v[216:231], a[68:71], v[204:207], v[232:247]
    s_nop 11
    v_exp_f32 v216, v216
    v_exp_f32 v217, v217
    v_exp_f32 v218, v218
    v_exp_f32 v219, v219
    v_exp_f32 v220, v220
    v_exp_f32 v221, v221
    v_exp_f32 v222, v222
    v_exp_f32 v223, v223
    v_exp_f32 v224, v224
    v_exp_f32 v225, v225
    v_exp_f32 v226, v226
    v_exp_f32 v227, v227
    v_exp_f32 v228, v228
    v_exp_f32 v229, v229
    v_exp_f32 v230, v230
    v_exp_f32 v231, v231
    v_cvt_pk_bf16_f32 v248, v216, v217
    v_cvt_pk_bf16_f32 v249, v218, v219
    v_cvt_pk_bf16_f32 v250, v220, v221
    v_cvt_pk_bf16_f32 v251, v222, v223
    v_cvt_pk_bf16_f32 v252, v224, v225
    v_cvt_pk_bf16_f32 v253, v226, v227
    v_cvt_pk_bf16_f32 v254, v228, v229
    v_cvt_pk_bf16_f32 v255, v230, v231
    v_mfma_f32_32x32x16_bf16 v[176:191], a[112:115], v[248:251], v[176:191]
    s_nop 0
    v_mfma_f32_32x32x16_bf16 v[176:191], a[116:119], v[252:255], v[176:191]
    s_nop 15
L_skip_36:
    s_cmp_eq_u32 s81, 0
    s_cbranch_scc1 L_skip_37
    v_mov_b32 v232, v208
    v_mov_b32 v233, v208
    v_mov_b32 v234, v208
    v_mov_b32 v235, v208
    v_mov_b32 v236, v208
    v_mov_b32 v237, v208
    v_mov_b32 v238, v208
    v_mov_b32 v239, v208
    v_mov_b32 v240, v208
    v_mov_b32 v241, v208
    v_mov_b32 v242, v208
    v_mov_b32 v243, v208
    v_mov_b32 v244, v208
    v_mov_b32 v245, v208
    v_mov_b32 v246, v208
    v_mov_b32 v247, v208
    s_nop 1
    v_mfma_f32_32x32x16_bf16 v[216:231], a[72:75], v[204:207], v[232:247]
    s_nop 11
    v_exp_f32 v216, v216
    v_exp_f32 v217, v217
    v_exp_f32 v218, v218
    v_exp_f32 v219, v219
    v_exp_f32 v220, v220
    v_exp_f32 v221, v221
    v_exp_f32 v222, v222
    v_exp_f32 v223, v223
    v_exp_f32 v224, v224
    v_exp_f32 v225, v225
    v_exp_f32 v226, v226
    v_exp_f32 v227, v227
    v_exp_f32 v228, v228
    v_exp_f32 v229, v229
    v_exp_f32 v230, v230
    v_exp_f32 v231, v231
    v_cvt_pk_bf16_f32 v248, v216, v217
    v_cvt_pk_bf16_f32 v249, v218, v219
    v_cvt_pk_bf16_f32 v250, v220, v221
    v_cvt_pk_bf16_f32 v251, v222, v223
    v_cvt_pk_bf16_f32 v252, v224, v225
    v_cvt_pk_bf16_f32 v253, v226, v227
    v_cvt_pk_bf16_f32 v254, v228, v229
    v_cvt_pk_bf16_f32 v255, v230, v231
    v_mfma_f32_32x32x16_bf16 v[176:191], a[120:123], v[248:251], v[176:191]
    s_nop 0
    v_mfma_f32_32x32x16_bf16 v[176:191], a[124:127], v[252:255], v[176:191]
    s_nop 15
L_skip_37:
    s_cmp_eq_u32 s81, 0
    s_cbranch_scc1 L_skip_38
    v_mov_b32 v232, v208
    v_mov_b32 v233, v208
    v_mov_b32 v234, v208
    v_mov_b32 v235, v208
    v_mov_b32 v236, v208
    v_mov_b32 v237, v208
    v_mov_b32 v238, v208
    v_mov_b32 v239, v208
    v_mov_b32 v240, v208
    v_mov_b32 v241, v208
    v_mov_b32 v242, v208
    v_mov_b32 v243, v208
    v_mov_b32 v244, v208
    v_mov_b32 v245, v208
    v_mov_b32 v246, v208
    v_mov_b32 v247, v208
    s_nop 1
    v_mfma_f32_32x32x16_bf16 v[216:231], a[76:79], v[204:207], v[232:247]
    s_nop 11
    v_exp_f32 v216, v216
    v_exp_f32 v217, v217
    v_exp_f32 v218, v218
    v_exp_f32 v219, v219
    v_exp_f32 v220, v220
    v_exp_f32 v221, v221
    v_exp_f32 v222, v222
    v_exp_f32 v223, v223
    v_exp_f32 v224, v224
    v_exp_f32 v225, v225
    v_exp_f32 v226, v226
    v_exp_f32 v227, v227
    v_exp_f32 v228, v228
    v_exp_f32 v229, v229
    v_exp_f32 v230, v230
    v_exp_f32 v231, v231
    v_cvt_pk_bf16_f32 v248, v216, v217
    v_cvt_pk_bf16_f32 v249, v218, v219
    v_cvt_pk_bf16_f32 v250, v220, v221
    v_cvt_pk_bf16_f32 v251, v222, v223
    v_cvt_pk_bf16_f32 v252, v224, v225
    v_cvt_pk_bf16_f32 v253, v226, v227
    v_cvt_pk_bf16_f32 v254, v228, v229
    v_cvt_pk_bf16_f32 v255, v230, v231
    v_mfma_f32_32x32x16_bf16 v[176:191], a[128:131], v[248:251], v[176:191]
    s_nop 0
    v_mfma_f32_32x32x16_bf16 v[176:191], a[132:135], v[252:255], v[176:191]
    s_nop 15
L_skip_38:
    s_cmp_eq_u32 s82, 0
    s_cbranch_scc1 L_skip_39
    v_mov_b32 v232, v208
    v_mov_b32 v233, v208
    v_mov_b32 v234, v208
    v_mov_b32 v235, v208
    v_mov_b32 v236, v208
    v_mov_b32 v237, v208
    v_mov_b32 v238, v208
    v_mov_b32 v239, v208
    v_mov_b32 v240, v208
    v_mov_b32 v241, v208
    v_mov_b32 v242, v208
    v_mov_b32 v243, v208
    v_mov_b32 v244, v208
    v_mov_b32 v245, v208
    v_mov_b32 v246, v208
    v_mov_b32 v247, v208
    s_nop 1
    v_mfma_f32_32x32x16_bf16 v[216:231], a[80:83], v[204:207], v[232:247]
    s_nop 11
    v_exp_f32 v216, v216
    v_exp_f32 v217, v217
    v_exp_f32 v218, v218
    v_exp_f32 v219, v219
    v_exp_f32 v220, v220
    v_exp_f32 v221, v221
    v_exp_f32 v222, v222
    v_exp_f32 v223, v223
    v_exp_f32 v224, v224
    v_exp_f32 v225, v225
    v_exp_f32 v226, v226
    v_exp_f32 v227, v227
    v_exp_f32 v228, v228
    v_exp_f32 v229, v229
    v_exp_f32 v230, v230
    v_exp_f32 v231, v231
    v_cvt_pk_bf16_f32 v248, v216, v217
    v_cvt_pk_bf16_f32 v249, v218, v219
    v_cvt_pk_bf16_f32 v250, v220, v221
    v_cvt_pk_bf16_f32 v251, v222, v223
    v_cvt_pk_bf16_f32 v252, v224, v225
    v_cvt_pk_bf16_f32 v253, v226, v227
    v_cvt_pk_bf16_f32 v254, v228, v229
    v_cvt_pk_bf16_f32 v255, v230, v231
    v_mfma_f32_32x32x16_bf16 v[176:191], a[136:139], v[248:251], v[176:191]
    s_nop 0
    v_mfma_f32_32x32x16_bf16 v[176:191], a[140:143], v[252:255], v[176:191]
    s_nop 15
L_skip_39:
    s_cmp_eq_u32 s82, 0
    s_cbranch_scc1 L_skip_40
    v_mov_b32 v232, v208
    v_mov_b32 v233, v208
    v_mov_b32 v234, v208
    v_mov_b32 v235, v208
    v_mov_b32 v236, v208
    v_mov_b32 v237, v208
    v_mov_b32 v238, v208
    v_mov_b32 v239, v208
    v_mov_b32 v240, v208
    v_mov_b32 v241, v208
    v_mov_b32 v242, v208
    v_mov_b32 v243, v208
    v_mov_b32 v244, v208
    v_mov_b32 v245, v208
    v_mov_b32 v246, v208
    v_mov_b32 v247, v208
    s_nop 1
    v_mfma_f32_32x32x16_bf16 v[216:231], a[84:87], v[204:207], v[232:247]
    s_nop 11
    v_exp_f32 v216, v216
    v_exp_f32 v217, v217
    v_exp_f32 v218, v218
    v_exp_f32 v219, v219
    v_exp_f32 v220, v220
    v_exp_f32 v221, v221
    v_exp_f32 v222, v222
    v_exp_f32 v223, v223
    v_exp_f32 v224, v224
    v_exp_f32 v225, v225
    v_exp_f32 v226, v226
    v_exp_f32 v227, v227
    v_exp_f32 v228, v228
    v_exp_f32 v229, v229
    v_exp_f32 v230, v230
    v_exp_f32 v231, v231
    v_cvt_pk_bf16_f32 v248, v216, v217
    v_cvt_pk_bf16_f32 v249, v218, v219
    v_cvt_pk_bf16_f32 v250, v220, v221
    v_cvt_pk_bf16_f32 v251, v222, v223
    v_cvt_pk_bf16_f32 v252, v224, v225
    v_cvt_pk_bf16_f32 v253, v226, v227
    v_cvt_pk_bf16_f32 v254, v228, v229
    v_cvt_pk_bf16_f32 v255, v230, v231
    v_mfma_f32_32x32x16_bf16 v[176:191], a[144:147], v[248:251], v[176:191]
    s_nop 0
    v_mfma_f32_32x32x16_bf16 v[176:191], a[148:151], v[252:255], v[176:191]
    s_nop 15
L_skip_40:
    s_cmp_eq_u32 s83, 0
    s_cbranch_scc1 L_skip_41
    v_mov_b32 v232, v208
    v_mov_b32 v233, v208
    v_mov_b32 v234, v208
    v_mov_b32 v235, v208
    v_mov_b32 v236, v208
    v_mov_b32 v237, v208
    v_mov_b32 v238, v208
    v_mov_b32 v239, v208
    v_mov_b32 v240, v208
    v_mov_b32 v241, v208
    v_mov_b32 v242, v208
    v_mov_b32 v243, v208
    v_mov_b32 v244, v208
    v_mov_b32 v245, v208
    v_mov_b32 v246, v208
    v_mov_b32 v247, v208
    s_nop 1
    v_mfma_f32_32x32x16_bf16 v[216:231], a[88:91], v[204:207], v[232:247]
    s_nop 11
    v_exp_f32 v216, v216
    v_exp_f32 v217, v217
    v_exp_f32 v218, v218
    v_exp_f32 v219, v219
    v_exp_f32 v220, v220
    v_exp_f32 v221, v221
    v_exp_f32 v222, v222
    v_exp_f32 v223, v223
    v_exp_f32 v224, v224
    v_exp_f32 v225, v225
    v_exp_f32 v226, v226
    v_exp_f32 v227, v227
    v_exp_f32 v228, v228
    v_exp_f32 v229, v229
    v_exp_f32 v230, v230
    v_exp_f32 v231, v231
    v_cvt_pk_bf16_f32 v248, v216, v217
    v_cvt_pk_bf16_f32 v249, v218, v219
    v_cvt_pk_bf16_f32 v250, v220, v221
    v_cvt_pk_bf16_f32 v251, v222, v223
    v_cvt_pk_bf16_f32 v252, v224, v225
    v_cvt_pk_bf16_f32 v253, v226, v227
    v_cvt_pk_bf16_f32 v254, v228, v229
    v_cvt_pk_bf16_f32 v255, v230, v231
    v_mfma_f32_32x32x16_bf16 v[176:191], a[152:155], v[248:251], v[176:191]
    s_nop 0
    v_mfma_f32_32x32x16_bf16 v[176:191], a[156:159], v[252:255], v[176:191]
    s_nop 15
L_skip_41:
    s_cmp_eq_u32 s83, 0
    s_cbranch_scc1 L_skip_42
    v_mov_b32 v232, v208
    v_mov_b32 v233, v208
    v_mov_b32 v234, v208
    v_mov_b32 v235, v208
    v_mov_b32 v236, v208
    v_mov_b32 v237, v208
    v_mov_b32 v238, v208
    v_mov_b32 v239, v208
    v_mov_b32 v240, v208
    v_mov_b32 v241, v208
    v_mov_b32 v242, v208
    v_mov_b32 v243, v208
    v_mov_b32 v244, v208
    v_mov_b32 v245, v208
    v_mov_b32 v246, v208
    v_mov_b32 v247, v208
    s_nop 1
    v_mfma_f32_32x32x16_bf16 v[216:231], a[92:95], v[204:207], v[232:247]
    s_nop 11
    v_exp_f32 v216, v216
    v_exp_f32 v217, v217
    v_exp_f32 v218, v218
    v_exp_f32 v219, v219
    v_exp_f32 v220, v220
    v_exp_f32 v221, v221
    v_exp_f32 v222, v222
    v_exp_f32 v223, v223
    v_exp_f32 v224, v224
    v_exp_f32 v225, v225
    v_exp_f32 v226, v226
    v_exp_f32 v227, v227
    v_exp_f32 v228, v228
    v_exp_f32 v229, v229
    v_exp_f32 v230, v230
    v_exp_f32 v231, v231
    v_cvt_pk_bf16_f32 v248, v216, v217
    v_cvt_pk_bf16_f32 v249, v218, v219
    v_cvt_pk_bf16_f32 v250, v220, v221
    v_cvt_pk_bf16_f32 v251, v222, v223
    v_cvt_pk_bf16_f32 v252, v224, v225
    v_cvt_pk_bf16_f32 v253, v226, v227
    v_cvt_pk_bf16_f32 v254, v228, v229
    v_cvt_pk_bf16_f32 v255, v230, v231
    v_mfma_f32_32x32x16_bf16 v[176:191], a[160:163], v[248:251], v[176:191]
    s_nop 0
    v_mfma_f32_32x32x16_bf16 v[176:191], a[164:167], v[252:255], v[176:191]
    s_nop 15
L_skip_42:
    v_mov_b32 v232, v208
    v_mov_b32 v233, v208
    v_mov_b32 v234, v208
    v_mov_b32 v235, v208
    v_mov_b32 v236, v208
    v_mov_b32 v237, v208
    v_mov_b32 v238, v208
    v_mov_b32 v239, v208
    v_mov_b32 v240, v208
    v_mov_b32 v241, v208
    v_mov_b32 v242, v208
    v_mov_b32 v243, v208
    v_mov_b32 v244, v208
    v_mov_b32 v245, v208
    v_mov_b32 v246, v208
    v_mov_b32 v247, v208
    s_nop 1
    v_mfma_f32_32x32x16_bf16 v[216:231], a[96:99], v[204:207], v[232:247]
    s_nop 11
    v_exp_f32 v216, v216
    v_exp_f32 v217, v217
    v_exp_f32 v218, v218
    v_exp_f32 v219, v219
    v_exp_f32 v220, v220
    v_exp_f32 v221, v221
    v_exp_f32 v222, v222
    v_exp_f32 v223, v223
    v_exp_f32 v224, v224
    v_exp_f32 v225, v225
    v_exp_f32 v226, v226
    v_exp_f32 v227, v227
    v_exp_f32 v228, v228
    v_exp_f32 v229, v229
    v_exp_f32 v230, v230
    v_exp_f32 v231, v231
    v_cvt_pk_bf16_f32 v248, v216, v217
    v_cvt_pk_bf16_f32 v249, v218, v219
    v_cvt_pk_bf16_f32 v250, v220, v221
    v_cvt_pk_bf16_f32 v251, v222, v223
    v_cvt_pk_bf16_f32 v252, v224, v225
    v_cvt_pk_bf16_f32 v253, v226, v227
    v_cvt_pk_bf16_f32 v254, v228, v229
    v_cvt_pk_bf16_f32 v255, v230, v231
    v_mfma_f32_32x32x16_bf16 v[176:191], a[168:171], v[248:251], v[176:191]
    s_nop 0
    v_mfma_f32_32x32x16_bf16 v[176:191], a[172:175], v[252:255], v[176:191]
    v_add_f32 v232, v32, v208
    v_add_f32 v233, v33, v208
    v_add_f32 v234, v34, v208
    v_add_f32 v235, v35, v208
    v_add_f32 v236, v36, v208
    v_add_f32 v237, v37, v208
    v_add_f32 v238, v38, v208
    v_add_f32 v239, v39, v208
    v_add_f32 v240, v40, v208
    v_add_f32 v241, v41, v208
    v_add_f32 v242, v42, v208
    v_add_f32 v243, v43, v208
    v_add_f32 v244, v44, v208
    v_add_f32 v245, v45, v208
    v_add_f32 v246, v46, v208
    v_add_f32 v247, v47, v208
    s_nop 1
    v_mfma_f32_32x32x16_bf16 v[216:231], a[100:103], v[204:207], v[232:247]
    s_nop 11
    v_exp_f32 v216, v216
    v_exp_f32 v217, v217
    v_exp_f32 v218, v218
    v_exp_f32 v219, v219
    v_exp_f32 v220, v220
    v_exp_f32 v221, v221
    v_exp_f32 v222, v222
    v_exp_f32 v223, v223
    v_exp_f32 v224, v224
    v_exp_f32 v225, v225
    v_exp_f32 v226, v226
    v_exp_f32 v227, v227
    v_exp_f32 v228, v228
    v_exp_f32 v229, v229
    v_exp_f32 v230, v230
    v_exp_f32 v231, v231
    v_cvt_pk_bf16_f32 v248, v216, v217
    v_cvt_pk_bf16_f32 v249, v218, v219
    v_cvt_pk_bf16_f32 v250, v220, v221
    v_cvt_pk_bf16_f32 v251, v222, v223
    v_cvt_pk_bf16_f32 v252, v224, v225
    v_cvt_pk_bf16_f32 v253, v226, v227
    v_cvt_pk_bf16_f32 v254, v228, v229
    v_cvt_pk_bf16_f32 v255, v230, v231
    v_mfma_f32_32x32x16_bf16 v[176:191], a[176:179], v[248:251], v[176:191]
    s_nop 0
    v_mfma_f32_32x32x16_bf16 v[176:191], a[180:183], v[252:255], v[176:191]
    s_nop 15
    s_branch L_att_27
L_rel_43:
    buffer_store_dwordx2 v[124:125], v2, s[36:39], s73 offen offset:256 sc1
    s_branch L_reld_44
L_rel_47:
    buffer_store_dwordx2 v[124:125], v2, s[36:39], s73 offen offset:512 sc1
    s_branch L_reld_48
L_rel_53:
    buffer_store_dwordx2 v[124:125], v2, s[36:39], s73 offen offset:768 sc1
    s_branch L_reld_54
L_rel_57:
    buffer_store_dwordx2 v[124:125], v2, s[36:39], s5 offen offset:1024 sc1
    s_branch L_reld_58
L_rel_61:
    buffer_store_dwordx2 v[124:125], v2, s[36:39], s5 offen offset:1280 sc1
    s_branch L_reld_62
L_fin_63:
    s_cmp_eq_u32 s40, 0
    s_cbranch_scc1 L_fin_65
    s_lshl_b32 s54, s40, 7
    s_add_u32 s54, s54, 15798144
    v_mov_b32 v20, s48
    v_mov_b32 v21, s49
    buffer_store_dwordx2 v[20:21], v2, s[36:39], s54 offen sc1
L_fin_65:
    s_cmp_lg_u32 s40, 7
    s_cbranch_scc1 L_fin_64
    s_mov_b32 s54, 15799168
    buffer_store_dwordx2 v[124:125], v2, s[36:39], s54 offen sc1
    s_branch L_fin_64
L_rel_68:
    buffer_store_dwordx2 v[124:125], v2, s[36:39], s73 offen offset:768 sc1
    s_branch L_reld_69
L_rel_72:
    buffer_store_dwordx2 v[124:125], v2, s[36:39], s5 offen sc1
    s_branch L_reld_73
L_abort:
    s_endpgm
.section .rodata,"a"
.p2align 6
.amdhsa_kernel sequential_preLN__sliding_block__glu_gated_bilinear__prompt_kernel
  .amdhsa_next_free_vgpr 512
  .amdhsa_next_free_sgpr 102
  .amdhsa_accum_offset 256
  .amdhsa_group_segment_fixed_size 0
  .amdhsa_kernarg_size 80
  .amdhsa_user_sgpr_count 2
  .amdhsa_user_sgpr_kernarg_segment_ptr 1
  .amdhsa_system_sgpr_workgroup_id_x 1
.end_amdhsa_kernel
```
